```python
import torch

def _softmax(x, axis=-1):
    return torch.softmax(x, dim=axis)
def _gelu(x):
    return torch.nn.functional.gelu(x, approximate="tanh")
def _silu(x):
    return torch.nn.functional.silu(x)
def _sigmoid(x):
    return torch.sigmoid(x)
def _layernorm(x, axis=-1, eps=1e-5):
    m = x.mean(dim=axis, keepdim=True)
    v = x.var(dim=axis, keepdim=True, unbiased=False)
    return (x - m) / torch.sqrt(v + eps)
def _scatter_add(tgt, idx, src, axis=0):
    return tgt.clone().index_add_(axis, idx, src)
def _segment_sum(src, seg, n):
    out = torch.zeros((n,) + src.shape[1:], dtype=src.dtype)
    return out.index_add_(0, seg, src)
def _pad(x, pw):
    flat = tuple(v for pair in reversed(pw) for v in pair)
    return torch.nn.functional.pad(x, flat)

kernel_name = 'gated_mix__linear_attn_block__mixer_s_mlp__prompt'

def setup_inputs():

    _w = (lambda a: (lambda t: t.to(torch.bfloat16) if t.is_floating_point() else t)(torch.as_tensor(a)))
    def _A_setup():
        B, S, D = 1, 2048, 512
        return {
            "x": _w((lambda *s: torch.randn(*s, dtype=torch.bfloat16) * 0.05)(B, S, D)),
            "wqkv": _w((lambda *s: torch.randn(*s, dtype=torch.bfloat16) * 3.2)(D, 3 * D)),
            "wo": _w((lambda *s: torch.randn(*s, dtype=torch.bfloat16) * 1.6)(D, D)),
        }
    _A_in = _A_setup()

    def _B_setup():
        B, S, D, F = 1, 2048, 512, 1792
        return {
            "x":  _w((lambda *s: torch.randn(*s, dtype=torch.bfloat16) * 0.05)(B, S, D)),
            "w1": _w((lambda *s: torch.randn(*s, dtype=torch.bfloat16) * 3.2)(D, D) * (D ** -0.5)),
            "w2": _w((lambda *s: torch.randn(*s, dtype=torch.bfloat16) * 3.2)(D, D) * (D ** -0.5)),
            "w3": _w((lambda *s: torch.randn(*s, dtype=torch.bfloat16) * 3.2)(D, F) * (D ** -0.5)),
            "w4": _w((lambda *s: torch.randn(*s, dtype=torch.bfloat16) * 1.6)(F, D) * (F ** -0.5)),
        }
    _B_in = _B_setup()

    return {
        "A_x": _A_in["x"],
        "A_wqkv": _A_in["wqkv"],
        "A_wo": _A_in["wo"],
        "B_x": _B_in["x"],
        "B_w1": _B_in["w1"],
        "B_w2": _B_in["w2"],
        "B_w3": _B_in["w3"],
        "B_w4": _B_in["w4"],
        "gate_w": _w((lambda *s: torch.randn(*s, dtype=torch.bfloat16) * 0.05)(512) * 16.0),
    }

def reference(A_x, A_wqkv, A_wo, B_x, B_w1, B_w2, B_w3, B_w4, gate_w):
    def _A_ref(x, wqkv, wo):
        B, S, D = x.shape
        H = 32; Dh = D // H
        qkv = (lambda x, *d: x.permute(*d))((x @ wqkv).reshape(B, S, 3, H, Dh), 2, 0, 3, 1, 4)
        q, k, v = qkv[0], qkv[1], qkv[2]
        phi = lambda t: torch.where(t > 0, t + 1, torch.exp(t)) + 1e-6
        pq, pk = phi(q), phi(k)
        kv = torch.einsum("bhsd,bhse->bhde", pk, v)
        z = torch.einsum("bhsd->bhd", pk)
        num = torch.einsum("bhqd,bhde->bhqe", pq, kv)
        den = torch.einsum("bhqd,bhd->bhq", pq, z)[..., None] + 1e-6
        o = num / den
        return (lambda x, *d: x.permute(*d))(o, 0, 2, 1, 3).reshape(B, S, D) @ wo

    def _B_ref(x, w1, w2, w3, w4):
        B, S, D = x.shape
        h = _gelu(_layernorm(x, axis=-1) @ w1)
        c = D // 4
        g0 = _pad(h[:, :, 0*c:1*c], ((0, 0), (1, 0), (0, 0)))[:, :S, :]
        g1 = _pad(h[:, :, 1*c:2*c], ((0, 0), (0, 1), (0, 0)))[:, 1:, :]
        g2 = _pad(h[:, :, 2*c:3*c], ((0, 0), (2, 0), (0, 0)))[:, :S, :]
        g3 = _pad(h[:, :, 3*c:   ], ((0, 0), (0, 2), (0, 0)))[:, 2:, :]
        hs = torch.concatenate([g0, g1, g2, g3], axis=-1) @ w2
        x1 = x + hs
        h2 = _gelu(_layernorm(x1, axis=-1) @ w3) @ w4
        return x1 + h2

    x = A_x
    g = _sigmoid((x * gate_w).sum(-1, keepdims=True))
    a = _A_ref(x, A_wqkv, A_wo)
    b = _B_ref(x, B_w1, B_w2, B_w3, B_w4)
    return g * a + (1 - g) * b
```

```asm
; @launch grid=(256,1,1) block=(256,1,1) lds=163840
.amdgcn_target "amdgcn-amd-amdhsa--gfx950"
.text
.globl gated_mix__linear_attn_block__mixer_s_mlp__prompt_kernel
.p2align 8
.type gated_mix__linear_attn_block__mixer_s_mlp__prompt_kernel,@function
gated_mix__linear_attn_block__mixer_s_mlp__prompt_kernel:
    s_cmp_ge_u32 s2, 256
    s_cbranch_scc1 L_end
    s_getpc_b64 s[4:5]
L_pc_1:
    v_lshlrev_b32 v4, 7, v0
    v_min_u32 v5, L_end-L_pc_1-4, v4
    global_load_dword v255, v5, s[4:5]
    v_add_u32 v4, 32768, v4
    v_min_u32 v5, L_end-L_pc_1-4, v4
    global_load_dword v255, v5, s[4:5]
    s_load_dwordx16 s[8:23], s[0:1], 0
    s_load_dwordx8 s[24:31], s[0:1], 64
    v_and_b32 v1, 63, v0
    v_lshrrev_b32 v4, 6, v0
    s_and_b32 s78, s2, 7
    s_lshr_b32 s53, s2, 3
    v_readfirstlane_b32 s48, v4
    s_lshr_b32 s54, s78, 1
    s_lshl_b32 s54, s54, 2
    s_lshr_b32 s56, s53, 2
    s_and_b32 s56, s56, 3
    s_add_u32 s76, s54, s56
    v_lshrrev_b32 v4, 3, v1
    v_and_b32 v5, 7, v1
    v_lshrrev_b32 v6, 1, v4
    v_xor_b32 v8, v5, v6
    v_lshlrev_b32 v8, 4, v8
    v_lshl_add_u32 v52, v4, 10, v8
    v_xor_b32 v7, 64, v52
    v_add_u32 v53, 7168, v7
    v_add_u32 v54, 14336, v52
    v_add_u32 v55, 21504, v7
    s_lshl_b32 s64, s76, 17
    s_lshl_b32 s52, s48, 15
    s_add_u32 s64, s64, s52
    s_lshl_b32 s66, s48, 12
    s_and_b32 s68, s76, 3
    s_lshl_b32 s68, s68, 1
    s_waitcnt lgkmcnt(0)
    s_mov_b32 s32, s8
    s_and_b32 s33, s9, 0xffff
    s_mov_b32 s34, 0x200000
    s_mov_b32 s35, 0x20000
    s_add_u32 s55, s68, 0
    s_and_b32 s55, s55, 7
    s_add_u32 m0, s66, 0
    s_lshl_b32 s53, s55, 7
    s_add_u32 s53, s53, s64
    buffer_load_dwordx4 v52, s[32:35], s53 offen offset:0 lds
    buffer_load_dwordx4 v53, s[32:35], s53 offen offset:1024 lds
    buffer_load_dwordx4 v54, s[32:35], s53 offen offset:2048 lds
    buffer_load_dwordx4 v55, s[32:35], s53 offen offset:3072 lds
    v_and_b32 v2, 15, v1
    v_lshrrev_b32 v3, 4, v1
    v_lshlrev_b32 v27, 4, v1
    s_lshr_b32 s53, s2, 3
    s_lshr_b32 s54, s78, 1
    s_lshl_b32 s54, s54, 3
    s_lshr_b32 s55, s53, 2
    s_add_u32 s54, s54, s55
    s_and_b32 s55, s78, 1
    s_lshl_b32 s55, s55, 2
    s_and_b32 s56, s53, 3
    s_add_u32 s55, s55, s56
    s_lshr_b32 s49, s54, 1
    s_and_b32 s54, s54, 1
    s_lshl_b32 s54, s54, 3
    s_add_u32 s50, s54, s55
    s_lshr_b32 s75, s53, 4
    s_mov_b32 s77, s55
    s_lshr_b32 s54, s78, 1
    s_lshl_b32 s54, s54, 2
    s_lshr_b32 s56, s53, 3
    s_add_u32 s3, s54, s56
    s_and_b32 s54, s78, 1
    s_lshl_b32 s54, s54, 3
    s_and_b32 s56, s53, 7
    s_add_u32 s51, s54, s56
    s_mov_b32 s40, s30
    s_and_b32 s41, s31, 0xffff
    s_mov_b32 s42, 0x1000000
    s_mov_b32 s43, 0x20000
    s_cmp_lg_u32 s2, 0
    s_cbranch_scc1 L_nozero
    v_mov_b32 v4, 0
    v_mov_b32 v5, 0
    v_mov_b32 v6, 0
    v_mov_b32 v7, 0
    v_lshlrev_b32 v8, 4, v0
    s_mov_b32 s52, 0xf00000
    buffer_store_dwordx4 v[4:7], v8, s[40:43], s52 offen sc1
    s_mov_b32 s52, 0xf01000
    buffer_store_dwordx4 v[4:7], v8, s[40:43], s52 offen sc1
    s_mov_b32 s52, 0xf02000
    buffer_store_dwordx4 v[4:7], v8, s[40:43], s52 offen sc1
    s_mov_b32 s52, 0xf03000
    buffer_store_dwordx4 v[4:7], v8, s[40:43], s52 offen sc1
    s_mov_b32 s52, 0xf04000
    buffer_store_dwordx4 v[4:7], v8, s[40:43], s52 offen sc1
    s_mov_b32 s52, 0xf05000
    buffer_store_dwordx4 v[4:7], v8, s[40:43], s52 offen sc1
    s_mov_b32 s52, 0xf06000
    buffer_store_dwordx4 v[4:7], v8, s[40:43], s52 offen sc1
    s_mov_b32 s52, 0xf07000
    buffer_store_dwordx4 v[4:7], v8, s[40:43], s52 offen sc1
    s_mov_b32 s52, 0xf08000
    buffer_store_dwordx4 v[4:7], v8, s[40:43], s52 offen sc1
    s_mov_b32 s52, 0xf09000
    buffer_store_dwordx4 v[4:7], v8, s[40:43], s52 offen sc1
    s_mov_b32 s52, 0xf0a000
    buffer_store_dwordx4 v[4:7], v8, s[40:43], s52 offen sc1
    s_nop 1
L_nozero:
    s_cmp_eq_u32 s75, 1
    s_cbranch_scc1 L_roleA
    s_mov_b32 s36, s16
    s_and_b32 s37, s17, 0xffff
    s_mov_b32 s38, 0x80000
    s_mov_b32 s39, 0x20000
    s_lshl_b32 s67, s48, 11
    s_mul_i32 s65, s48, 16384
    s_lshl_b32 s52, s77, 7
    s_add_u32 s65, s65, s52
    v_lshrrev_b32 v4, 3, v1
    v_and_b32 v5, 7, v1
    v_and_b32 v6, 2, v4
    v_xor_b32 v6, v5, v6
    v_mul_u32_u24 v7, 1024, v4
    v_lshl_add_u32 v56, v6, 4, v7
    v_xor_b32 v6, 4, v6
    v_lshl_add_u32 v57, v6, 4, v7
    v_add_u32 v57, 7168, v57
    s_add_u32 s55, s68, 0
    s_and_b32 s55, s55, 7
    s_mul_i32 s55, s55, 65536
    s_add_u32 s55, s55, s65
    s_add_u32 m0, s67, 16384
    s_add_u32 s54, s55, 0
    buffer_load_dwordx4 v56, s[36:39], s54 offen offset:0 lds
    buffer_load_dwordx4 v57, s[36:39], s54 offen offset:1024 lds
    s_add_u32 s55, s68, 1
    s_and_b32 s55, s55, 7
    s_add_u32 m0, s66, 24576
    s_lshl_b32 s53, s55, 7
    s_add_u32 s53, s53, s64
    buffer_load_dwordx4 v52, s[32:35], s53 offen offset:0 lds
    buffer_load_dwordx4 v53, s[32:35], s53 offen offset:1024 lds
    buffer_load_dwordx4 v54, s[32:35], s53 offen offset:2048 lds
    buffer_load_dwordx4 v55, s[32:35], s53 offen offset:3072 lds
    s_add_u32 s55, s68, 1
    s_and_b32 s55, s55, 7
    s_mul_i32 s55, s55, 65536
    s_add_u32 s55, s55, s65
    s_add_u32 m0, s67, 40960
    s_add_u32 s54, s55, 0
    buffer_load_dwordx4 v56, s[36:39], s54 offen offset:0 lds
    buffer_load_dwordx4 v57, s[36:39], s54 offen offset:1024 lds
    s_add_u32 s55, s68, 2
    s_and_b32 s55, s55, 7
    s_add_u32 m0, s66, 49152
    s_lshl_b32 s53, s55, 7
    s_add_u32 s53, s53, s64
    buffer_load_dwordx4 v52, s[32:35], s53 offen offset:0 lds
    buffer_load_dwordx4 v53, s[32:35], s53 offen offset:1024 lds
    buffer_load_dwordx4 v54, s[32:35], s53 offen offset:2048 lds
    buffer_load_dwordx4 v55, s[32:35], s53 offen offset:3072 lds
    s_add_u32 s55, s68, 2
    s_and_b32 s55, s55, 7
    s_mul_i32 s55, s55, 65536
    s_add_u32 s55, s55, s65
    s_add_u32 m0, s67, 65536
    s_add_u32 s54, s55, 0
    buffer_load_dwordx4 v56, s[36:39], s54 offen offset:0 lds
    buffer_load_dwordx4 v57, s[36:39], s54 offen offset:1024 lds
    s_add_u32 s55, s68, 3
    s_and_b32 s55, s55, 7
    s_add_u32 m0, s66, 73728
    s_lshl_b32 s53, s55, 7
    s_add_u32 s53, s53, s64
    buffer_load_dwordx4 v52, s[32:35], s53 offen offset:0 lds
    buffer_load_dwordx4 v53, s[32:35], s53 offen offset:1024 lds
    buffer_load_dwordx4 v54, s[32:35], s53 offen offset:2048 lds
    buffer_load_dwordx4 v55, s[32:35], s53 offen offset:3072 lds
    s_add_u32 s55, s68, 3
    s_and_b32 s55, s55, 7
    s_mul_i32 s55, s55, 65536
    s_add_u32 s55, s55, s65
    s_add_u32 m0, s67, 90112
    s_add_u32 s54, s55, 0
    buffer_load_dwordx4 v56, s[36:39], s54 offen offset:0 lds
    buffer_load_dwordx4 v57, s[36:39], s54 offen offset:1024 lds
    v_lshrrev_b32 v4, 2, v1
    v_and_b32 v4, 3, v4
    v_and_b32 v5, 1, v3
    v_lshlrev_b32 v5, 1, v5
    v_lshrrev_b32 v7, 1, v4
    v_or_b32 v5, v5, v7
    v_lshl_add_u32 v6, v3, 3, v4
    v_lshlrev_b32 v6, 7, v6
    v_and_b32 v7, 3, v1
    v_lshl_add_u32 v6, v7, 3, v6
    s_and_b32 s55, s48, 1
    s_lshl_b32 s55, s55, 1
    v_xor_b32 v5, s55, v5
    v_xor_b32 v7, 0, v5
    v_lshl_add_u32 v16, v7, 5, v6
    v_xor_b32 v7, 1, v5
    v_lshl_add_u32 v17, v7, 5, v6
    v_xor_b32 v7, 2, v5
    v_lshl_add_u32 v18, v7, 5, v6
    v_xor_b32 v7, 3, v5
    v_lshl_add_u32 v19, v7, 5, v6
    v_lshrrev_b32 v4, 1, v2
    v_xor_b32 v4, v3, v4
    v_lshlrev_b32 v4, 4, v4
    v_lshl_add_u32 v4, v2, 7, v4
    v_add_u32 v24, s66, v4
    v_xor_b32 v25, 64, v24
    v_mov_b32 v144, 0
    v_mov_b32 v145, 0
    v_mov_b32 v146, 0
    v_mov_b32 v147, 0
    v_mov_b32 v148, 0
    v_mov_b32 v149, 0
    v_mov_b32 v150, 0
    v_mov_b32 v151, 0
    v_mov_b32 v152, 0
    v_mov_b32 v153, 0
    v_mov_b32 v154, 0
    v_mov_b32 v155, 0
    v_mov_b32 v156, 0
    v_mov_b32 v157, 0
    v_mov_b32 v158, 0
    v_mov_b32 v159, 0
    v_mov_b32 v160, 0
    v_mov_b32 v161, 0
    v_mov_b32 v162, 0
    v_mov_b32 v163, 0
    v_mov_b32 v164, 0
    v_mov_b32 v165, 0
    v_mov_b32 v166, 0
    v_mov_b32 v167, 0
    v_mov_b32 v60, 0x3f803f80
    v_mov_b32 v61, 0x3f803f80
    v_mov_b32 v62, 0x3f803f80
    v_mov_b32 v63, 0x3f803f80
    s_waitcnt vmcnt(18)
    s_barrier
    s_cmp_lg_u32 s2, 0
    s_cbranch_scc1 L_pub_2
    s_cmp_lg_u32 s48, 0
    s_cbranch_scc1 L_pub_2
    s_mov_b32 s44, s28
    s_and_b32 s45, s29, 0xffff
    s_mov_b32 s46, 0x100
    s_mov_b32 s47, 0x20000
    v_mov_b32 v4, 128
    v_mov_b32 v5, 1
    s_mov_b64 exec, 1
    buffer_store_dword v5, v4, s[44:47], 0 offen sc1
    s_mov_b64 exec, -1
L_pub_2:
    ds_read_b128 v[64:67], v24 offset:0
    ds_read_b128 v[68:71], v24 offset:2048
    ds_read_b64_tr_b16 v[28:29], v16 offset:16384
    ds_read_b64_tr_b16 v[30:31], v16 offset:16896
    ds_read_b64_tr_b16 v[32:33], v17 offset:16384
    ds_read_b64_tr_b16 v[34:35], v17 offset:16896
    ds_read_b64_tr_b16 v[36:37], v18 offset:16384
    ds_read_b64_tr_b16 v[38:39], v18 offset:16896
    s_waitcnt lgkmcnt(6)
    s_waitcnt lgkmcnt(4)
    v_mfma_f32_16x16x32_bf16 v[80:83], v[28:31], v[64:67], 0
    ds_read_b64_tr_b16 v[40:41], v19 offset:16384
    v_mfma_f32_16x16x32_bf16 v[96:99], v[28:31], v[68:71], 0
    v_mfma_f32_16x16x32_bf16 v[160:163], v[28:31], v[60:63], v[160:163]
    ds_read_b64_tr_b16 v[42:43], v19 offset:16896
    ds_read_b128 v[72:75], v25 offset:0
    ds_read_b128 v[76:79], v25 offset:2048
    s_waitcnt lgkmcnt(6)
    v_mfma_f32_16x16x32_bf16 v[84:87], v[32:35], v[64:67], 0
    ds_read_b64_tr_b16 v[44:45], v16 offset:20480
    v_mfma_f32_16x16x32_bf16 v[100:103], v[32:35], v[68:71], 0
    v_mfma_f32_16x16x32_bf16 v[164:167], v[32:35], v[60:63], v[164:167]
    ds_read_b64_tr_b16 v[46:47], v16 offset:20992
    s_waitcnt lgkmcnt(6)
    v_mfma_f32_16x16x32_bf16 v[88:91], v[36:39], v[64:67], 0
    ds_read_b64_tr_b16 v[48:49], v17 offset:20480
    v_mfma_f32_16x16x32_bf16 v[104:107], v[36:39], v[68:71], 0
    v_mfma_f32_16x16x32_bf16 v[144:147], v[60:63], v[64:67], v[144:147]
    v_mfma_f32_16x16x32_bf16 v[152:155], v[64:67], v[64:67], v[152:155]
    ds_read_b64_tr_b16 v[50:51], v17 offset:20992
    s_waitcnt lgkmcnt(6)
    v_mfma_f32_16x16x32_bf16 v[92:95], v[40:43], v[64:67], 0
    ds_read_b64_tr_b16 v[28:29], v18 offset:20480
    v_mfma_f32_16x16x32_bf16 v[108:111], v[40:43], v[68:71], 0
    v_mfma_f32_16x16x32_bf16 v[148:151], v[60:63], v[68:71], v[148:151]
    v_mfma_f32_16x16x32_bf16 v[156:159], v[68:71], v[68:71], v[156:159]
    ds_read_b64_tr_b16 v[30:31], v18 offset:20992
    s_waitcnt vmcnt(12)
    s_barrier
    s_waitcnt lgkmcnt(6)
    s_waitcnt lgkmcnt(4)
    v_mfma_f32_16x16x32_bf16 v[80:83], v[44:47], v[72:75], v[80:83]
    ds_read_b64_tr_b16 v[32:33], v19 offset:20480
    v_mfma_f32_16x16x32_bf16 v[96:99], v[44:47], v[76:79], v[96:99]
    v_mfma_f32_16x16x32_bf16 v[160:163], v[44:47], v[60:63], v[160:163]
    ds_read_b64_tr_b16 v[34:35], v19 offset:20992
    s_add_u32 s55, s68, 4
    s_and_b32 s55, s55, 7
    s_add_u32 m0, s66, 98304
    s_lshl_b32 s53, s55, 7
    s_add_u32 s53, s53, s64
    buffer_load_dwordx4 v52, s[32:35], s53 offen offset:0 lds
    buffer_load_dwordx4 v53, s[32:35], s53 offen offset:1024 lds
    buffer_load_dwordx4 v54, s[32:35], s53 offen offset:2048 lds
    buffer_load_dwordx4 v55, s[32:35], s53 offen offset:3072 lds
    ds_read_b128 v[64:67], v24 offset:24576
    ds_read_b128 v[68:71], v24 offset:26624
    s_waitcnt lgkmcnt(6)
    v_mfma_f32_16x16x32_bf16 v[84:87], v[48:51], v[72:75], v[84:87]
    ds_read_b64_tr_b16 v[36:37], v16 offset:40960
    v_mfma_f32_16x16x32_bf16 v[100:103], v[48:51], v[76:79], v[100:103]
    v_mfma_f32_16x16x32_bf16 v[164:167], v[48:51], v[60:63], v[164:167]
    ds_read_b64_tr_b16 v[38:39], v16 offset:41472
    s_add_u32 s55, s68, 4
    s_and_b32 s55, s55, 7
    s_mul_i32 s55, s55, 65536
    s_add_u32 s55, s55, s65
    s_add_u32 m0, s67, 114688
    s_add_u32 s54, s55, 0
    buffer_load_dwordx4 v56, s[36:39], s54 offen offset:0 lds
    buffer_load_dwordx4 v57, s[36:39], s54 offen offset:1024 lds
    s_waitcnt lgkmcnt(6)
    v_mfma_f32_16x16x32_bf16 v[88:91], v[28:31], v[72:75], v[88:91]
    ds_read_b64_tr_b16 v[40:41], v17 offset:40960
    v_mfma_f32_16x16x32_bf16 v[104:107], v[28:31], v[76:79], v[104:107]
    v_mfma_f32_16x16x32_bf16 v[144:147], v[60:63], v[72:75], v[144:147]
    v_mfma_f32_16x16x32_bf16 v[152:155], v[72:75], v[72:75], v[152:155]
    ds_read_b64_tr_b16 v[42:43], v17 offset:41472
    s_waitcnt lgkmcnt(6)
    v_mfma_f32_16x16x32_bf16 v[92:95], v[32:35], v[72:75], v[92:95]
    ds_read_b64_tr_b16 v[44:45], v18 offset:40960
    v_mfma_f32_16x16x32_bf16 v[108:111], v[32:35], v[76:79], v[108:111]
    v_mfma_f32_16x16x32_bf16 v[148:151], v[60:63], v[76:79], v[148:151]
    v_mfma_f32_16x16x32_bf16 v[156:159], v[76:79], v[76:79], v[156:159]
    ds_read_b64_tr_b16 v[46:47], v18 offset:41472
    s_waitcnt lgkmcnt(6)
    s_waitcnt lgkmcnt(4)
    v_mfma_f32_16x16x32_bf16 v[80:83], v[36:39], v[64:67], v[80:83]
    ds_read_b64_tr_b16 v[48:49], v19 offset:40960
    v_mfma_f32_16x16x32_bf16 v[96:99], v[36:39], v[68:71], v[96:99]
    v_mfma_f32_16x16x32_bf16 v[160:163], v[36:39], v[60:63], v[160:163]
    ds_read_b64_tr_b16 v[50:51], v19 offset:41472
    ds_read_b128 v[72:75], v25 offset:24576
    ds_read_b128 v[76:79], v25 offset:26624
    s_waitcnt lgkmcnt(6)
    v_mfma_f32_16x16x32_bf16 v[84:87], v[40:43], v[64:67], v[84:87]
    ds_read_b64_tr_b16 v[28:29], v16 offset:45056
    v_mfma_f32_16x16x32_bf16 v[100:103], v[40:43], v[68:71], v[100:103]
    v_mfma_f32_16x16x32_bf16 v[164:167], v[40:43], v[60:63], v[164:167]
    ds_read_b64_tr_b16 v[30:31], v16 offset:45568
    s_waitcnt lgkmcnt(6)
    v_mfma_f32_16x16x32_bf16 v[88:91], v[44:47], v[64:67], v[88:91]
    ds_read_b64_tr_b16 v[32:33], v17 offset:45056
    v_mfma_f32_16x16x32_bf16 v[104:107], v[44:47], v[68:71], v[104:107]
    v_mfma_f32_16x16x32_bf16 v[144:147], v[60:63], v[64:67], v[144:147]
    v_mfma_f32_16x16x32_bf16 v[152:155], v[64:67], v[64:67], v[152:155]
    ds_read_b64_tr_b16 v[34:35], v17 offset:45568
    s_waitcnt lgkmcnt(6)
    v_mfma_f32_16x16x32_bf16 v[92:95], v[48:51], v[64:67], v[92:95]
    ds_read_b64_tr_b16 v[36:37], v18 offset:45056
    v_mfma_f32_16x16x32_bf16 v[108:111], v[48:51], v[68:71], v[108:111]
    v_mfma_f32_16x16x32_bf16 v[148:151], v[60:63], v[68:71], v[148:151]
    v_mfma_f32_16x16x32_bf16 v[156:159], v[68:71], v[68:71], v[156:159]
    ds_read_b64_tr_b16 v[38:39], v18 offset:45568
    s_waitcnt vmcnt(12)
    s_barrier
    s_waitcnt lgkmcnt(6)
    s_waitcnt lgkmcnt(4)
    v_mfma_f32_16x16x32_bf16 v[80:83], v[28:31], v[72:75], v[80:83]
    ds_read_b64_tr_b16 v[40:41], v19 offset:45056
    v_mfma_f32_16x16x32_bf16 v[96:99], v[28:31], v[76:79], v[96:99]
    v_mfma_f32_16x16x32_bf16 v[160:163], v[28:31], v[60:63], v[160:163]
    ds_read_b64_tr_b16 v[42:43], v19 offset:45568
    s_add_u32 s55, s68, 5
    s_and_b32 s55, s55, 7
    s_add_u32 m0, s66, 122880
    s_lshl_b32 s53, s55, 7
    s_add_u32 s53, s53, s64
    buffer_load_dwordx4 v52, s[32:35], s53 offen offset:0 lds
    buffer_load_dwordx4 v53, s[32:35], s53 offen offset:1024 lds
    buffer_load_dwordx4 v54, s[32:35], s53 offen offset:2048 lds
    buffer_load_dwordx4 v55, s[32:35], s53 offen offset:3072 lds
    ds_read_b128 v[64:67], v24 offset:49152
    ds_read_b128 v[68:71], v24 offset:51200
    s_waitcnt lgkmcnt(6)
    v_mfma_f32_16x16x32_bf16 v[84:87], v[32:35], v[72:75], v[84:87]
    v_add_u32 v16, 65536, v16
    v_add_u32 v17, 65536, v17
    v_add_u32 v18, 65536, v18
    v_add_u32 v19, 65536, v19
    ds_read_b64_tr_b16 v[44:45], v16 offset:0
    v_mfma_f32_16x16x32_bf16 v[100:103], v[32:35], v[76:79], v[100:103]
    v_mfma_f32_16x16x32_bf16 v[164:167], v[32:35], v[60:63], v[164:167]
    ds_read_b64_tr_b16 v[46:47], v16 offset:512
    s_add_u32 s55, s68, 5
    s_and_b32 s55, s55, 7
    s_mul_i32 s55, s55, 65536
    s_add_u32 s55, s55, s65
    s_add_u32 m0, s67, 139264
    s_add_u32 s54, s55, 0
    buffer_load_dwordx4 v56, s[36:39], s54 offen offset:0 lds
    buffer_load_dwordx4 v57, s[36:39], s54 offen offset:1024 lds
    s_waitcnt lgkmcnt(6)
    v_mfma_f32_16x16x32_bf16 v[88:91], v[36:39], v[72:75], v[88:91]
    ds_read_b64_tr_b16 v[48:49], v17 offset:0
    v_mfma_f32_16x16x32_bf16 v[104:107], v[36:39], v[76:79], v[104:107]
    v_mfma_f32_16x16x32_bf16 v[144:147], v[60:63], v[72:75], v[144:147]
    v_mfma_f32_16x16x32_bf16 v[152:155], v[72:75], v[72:75], v[152:155]
    ds_read_b64_tr_b16 v[50:51], v17 offset:512
    s_waitcnt lgkmcnt(6)
    v_mfma_f32_16x16x32_bf16 v[92:95], v[40:43], v[72:75], v[92:95]
    ds_read_b64_tr_b16 v[28:29], v18 offset:0
    v_mfma_f32_16x16x32_bf16 v[108:111], v[40:43], v[76:79], v[108:111]
    v_mfma_f32_16x16x32_bf16 v[148:151], v[60:63], v[76:79], v[148:151]
    v_mfma_f32_16x16x32_bf16 v[156:159], v[76:79], v[76:79], v[156:159]
    ds_read_b64_tr_b16 v[30:31], v18 offset:512
    s_waitcnt lgkmcnt(6)
    s_waitcnt lgkmcnt(4)
    v_mfma_f32_16x16x32_bf16 v[80:83], v[44:47], v[64:67], v[80:83]
    ds_read_b64_tr_b16 v[32:33], v19 offset:0
    v_mfma_f32_16x16x32_bf16 v[96:99], v[44:47], v[68:71], v[96:99]
    v_mfma_f32_16x16x32_bf16 v[160:163], v[44:47], v[60:63], v[160:163]
    ds_read_b64_tr_b16 v[34:35], v19 offset:512
    ds_read_b128 v[72:75], v25 offset:49152
    ds_read_b128 v[76:79], v25 offset:51200
    s_waitcnt lgkmcnt(6)
    v_mfma_f32_16x16x32_bf16 v[84:87], v[48:51], v[64:67], v[84:87]
    ds_read_b64_tr_b16 v[36:37], v16 offset:4096
    v_mfma_f32_16x16x32_bf16 v[100:103], v[48:51], v[68:71], v[100:103]
    v_mfma_f32_16x16x32_bf16 v[164:167], v[48:51], v[60:63], v[164:167]
    ds_read_b64_tr_b16 v[38:39], v16 offset:4608
    s_waitcnt lgkmcnt(6)
    v_mfma_f32_16x16x32_bf16 v[88:91], v[28:31], v[64:67], v[88:91]
    ds_read_b64_tr_b16 v[40:41], v17 offset:4096
    v_mfma_f32_16x16x32_bf16 v[104:107], v[28:31], v[68:71], v[104:107]
    v_mfma_f32_16x16x32_bf16 v[144:147], v[60:63], v[64:67], v[144:147]
    v_mfma_f32_16x16x32_bf16 v[152:155], v[64:67], v[64:67], v[152:155]
    ds_read_b64_tr_b16 v[42:43], v17 offset:4608
    s_waitcnt lgkmcnt(6)
    v_mfma_f32_16x16x32_bf16 v[92:95], v[32:35], v[64:67], v[92:95]
    ds_read_b64_tr_b16 v[44:45], v18 offset:4096
    v_mfma_f32_16x16x32_bf16 v[108:111], v[32:35], v[68:71], v[108:111]
    v_mfma_f32_16x16x32_bf16 v[148:151], v[60:63], v[68:71], v[148:151]
    v_mfma_f32_16x16x32_bf16 v[156:159], v[68:71], v[68:71], v[156:159]
    ds_read_b64_tr_b16 v[46:47], v18 offset:4608
    s_waitcnt vmcnt(12)
    s_barrier
    s_waitcnt lgkmcnt(6)
    s_waitcnt lgkmcnt(4)
    v_mfma_f32_16x16x32_bf16 v[80:83], v[36:39], v[72:75], v[80:83]
    ds_read_b64_tr_b16 v[48:49], v19 offset:4096
    v_mfma_f32_16x16x32_bf16 v[96:99], v[36:39], v[76:79], v[96:99]
    v_mfma_f32_16x16x32_bf16 v[160:163], v[36:39], v[60:63], v[160:163]
    ds_read_b64_tr_b16 v[50:51], v19 offset:4608
    s_add_u32 s55, s68, 6
    s_and_b32 s55, s55, 7
    s_add_u32 m0, s66, 0
    s_lshl_b32 s53, s55, 7
    s_add_u32 s53, s53, s64
    buffer_load_dwordx4 v52, s[32:35], s53 offen offset:0 lds
    buffer_load_dwordx4 v53, s[32:35], s53 offen offset:1024 lds
    buffer_load_dwordx4 v54, s[32:35], s53 offen offset:2048 lds
    buffer_load_dwordx4 v55, s[32:35], s53 offen offset:3072 lds
    v_add_u32 v24, 65536, v24
    v_add_u32 v25, 65536, v25
    ds_read_b128 v[64:67], v24 offset:8192
    ds_read_b128 v[68:71], v24 offset:10240
    s_waitcnt lgkmcnt(6)
    v_mfma_f32_16x16x32_bf16 v[84:87], v[40:43], v[72:75], v[84:87]
    ds_read_b64_tr_b16 v[28:29], v16 offset:24576
    v_mfma_f32_16x16x32_bf16 v[100:103], v[40:43], v[76:79], v[100:103]
    v_mfma_f32_16x16x32_bf16 v[164:167], v[40:43], v[60:63], v[164:167]
    ds_read_b64_tr_b16 v[30:31], v16 offset:25088
    s_add_u32 s55, s68, 6
    s_and_b32 s55, s55, 7
    s_mul_i32 s55, s55, 65536
    s_add_u32 s55, s55, s65
    s_add_u32 m0, s67, 16384
    s_add_u32 s54, s55, 0
    buffer_load_dwordx4 v56, s[36:39], s54 offen offset:0 lds
    buffer_load_dwordx4 v57, s[36:39], s54 offen offset:1024 lds
    s_waitcnt lgkmcnt(6)
    v_mfma_f32_16x16x32_bf16 v[88:91], v[44:47], v[72:75], v[88:91]
    ds_read_b64_tr_b16 v[32:33], v17 offset:24576
    v_mfma_f32_16x16x32_bf16 v[104:107], v[44:47], v[76:79], v[104:107]
    v_mfma_f32_16x16x32_bf16 v[144:147], v[60:63], v[72:75], v[144:147]
    v_mfma_f32_16x16x32_bf16 v[152:155], v[72:75], v[72:75], v[152:155]
    ds_read_b64_tr_b16 v[34:35], v17 offset:25088
    s_waitcnt lgkmcnt(6)
    v_mfma_f32_16x16x32_bf16 v[92:95], v[48:51], v[72:75], v[92:95]
    ds_read_b64_tr_b16 v[36:37], v18 offset:24576
    v_mfma_f32_16x16x32_bf16 v[108:111], v[48:51], v[76:79], v[108:111]
    v_mfma_f32_16x16x32_bf16 v[148:151], v[60:63], v[76:79], v[148:151]
    v_mfma_f32_16x16x32_bf16 v[156:159], v[76:79], v[76:79], v[156:159]
    ds_read_b64_tr_b16 v[38:39], v18 offset:25088
    s_waitcnt lgkmcnt(6)
    s_waitcnt lgkmcnt(4)
    v_mfma_f32_16x16x32_bf16 v[80:83], v[28:31], v[64:67], v[80:83]
    ds_read_b64_tr_b16 v[40:41], v19 offset:24576
    v_mfma_f32_16x16x32_bf16 v[96:99], v[28:31], v[68:71], v[96:99]
    v_mfma_f32_16x16x32_bf16 v[160:163], v[28:31], v[60:63], v[160:163]
    ds_read_b64_tr_b16 v[42:43], v19 offset:25088
    ds_read_b128 v[72:75], v25 offset:8192
    ds_read_b128 v[76:79], v25 offset:10240
    s_waitcnt lgkmcnt(6)
    v_mfma_f32_16x16x32_bf16 v[84:87], v[32:35], v[64:67], v[84:87]
    ds_read_b64_tr_b16 v[44:45], v16 offset:28672
    v_mfma_f32_16x16x32_bf16 v[100:103], v[32:35], v[68:71], v[100:103]
    v_mfma_f32_16x16x32_bf16 v[164:167], v[32:35], v[60:63], v[164:167]
    ds_read_b64_tr_b16 v[46:47], v16 offset:29184
    s_waitcnt lgkmcnt(6)
    v_mfma_f32_16x16x32_bf16 v[88:91], v[36:39], v[64:67], v[88:91]
    ds_read_b64_tr_b16 v[48:49], v17 offset:28672
    v_mfma_f32_16x16x32_bf16 v[104:107], v[36:39], v[68:71], v[104:107]
    v_mfma_f32_16x16x32_bf16 v[144:147], v[60:63], v[64:67], v[144:147]
    v_mfma_f32_16x16x32_bf16 v[152:155], v[64:67], v[64:67], v[152:155]
    ds_read_b64_tr_b16 v[50:51], v17 offset:29184
    s_mov_b32 s96, s18
    s_and_b32 s97, s19, 0xffff
    s_mov_b32 s98, 0x80000
    s_mov_b32 s99, 0x20000
    s_lshl_b32 s7, s2, 2
    s_add_u32 s7, s7, s48
    s_mul_i32 s7, s7, 512
    v_lshlrev_b32 v238, 7, v1
    s_mov_b32 exec_lo, 0xf
    s_mov_b32 exec_hi, 0
    buffer_load_dword v255, v238, s[96:99], s7 offen
    s_mov_b64 exec, -1
    s_mov_b32 s96, s12
    s_and_b32 s97, s13, 0xffff
    s_mov_b32 s98, 0x80000
    s_mov_b32 s99, 0x20000
    s_lshl_b32 s7, s2, 2
    s_add_u32 s7, s7, s48
    s_mul_i32 s7, s7, 512
    v_lshlrev_b32 v238, 7, v1
    s_mov_b32 exec_lo, 0xf
    s_mov_b32 exec_hi, 0
    buffer_load_dword v255, v238, s[96:99], s7 offen
    s_mov_b64 exec, -1
    s_mov_b32 s96, s20
    s_and_b32 s97, s21, 0xffff
    s_mov_b32 s98, 0x1c0000
    s_mov_b32 s99, 0x20000
    s_lshl_b32 s7, s2, 2
    s_add_u32 s7, s7, s48
    s_mul_i32 s7, s7, 1792
    v_lshlrev_b32 v238, 7, v1
    s_mov_b32 exec_lo, 0x3fff
    s_mov_b32 exec_hi, 0
    buffer_load_dword v255, v238, s[96:99], s7 offen
    s_mov_b64 exec, -1
    s_mov_b32 s96, s22
    s_and_b32 s97, s23, 0xffff
    s_mov_b32 s98, 0x1c0000
    s_mov_b32 s99, 0x20000
    s_lshl_b32 s7, s2, 2
    s_add_u32 s7, s7, s48
    s_mul_i32 s7, s7, 1792
    v_lshlrev_b32 v238, 7, v1
    s_mov_b32 exec_lo, 0x3fff
    s_mov_b32 exec_hi, 0
    buffer_load_dword v255, v238, s[96:99], s7 offen
    s_mov_b64 exec, -1
    s_waitcnt lgkmcnt(6)
    v_mfma_f32_16x16x32_bf16 v[92:95], v[40:43], v[64:67], v[92:95]
    ds_read_b64_tr_b16 v[28:29], v18 offset:28672
    v_mfma_f32_16x16x32_bf16 v[108:111], v[40:43], v[68:71], v[108:111]
    v_mfma_f32_16x16x32_bf16 v[148:151], v[60:63], v[68:71], v[148:151]
    v_mfma_f32_16x16x32_bf16 v[156:159], v[68:71], v[68:71], v[156:159]
    ds_read_b64_tr_b16 v[30:31], v18 offset:29184
    s_waitcnt vmcnt(16)
    s_barrier
    s_waitcnt lgkmcnt(6)
    s_waitcnt lgkmcnt(4)
    v_mfma_f32_16x16x32_bf16 v[80:83], v[44:47], v[72:75], v[80:83]
    ds_read_b64_tr_b16 v[32:33], v19 offset:28672
    v_mfma_f32_16x16x32_bf16 v[96:99], v[44:47], v[76:79], v[96:99]
    v_mfma_f32_16x16x32_bf16 v[160:163], v[44:47], v[60:63], v[160:163]
    ds_read_b64_tr_b16 v[34:35], v19 offset:29184
    s_add_u32 s55, s68, 7
    s_and_b32 s55, s55, 7
    s_add_u32 m0, s66, 24576
    s_lshl_b32 s53, s55, 7
    s_add_u32 s53, s53, s64
    buffer_load_dwordx4 v52, s[32:35], s53 offen offset:0 lds
    buffer_load_dwordx4 v53, s[32:35], s53 offen offset:1024 lds
    buffer_load_dwordx4 v54, s[32:35], s53 offen offset:2048 lds
    buffer_load_dwordx4 v55, s[32:35], s53 offen offset:3072 lds
    ds_read_b128 v[64:67], v24 offset:32768
    ds_read_b128 v[68:71], v24 offset:34816
    s_waitcnt lgkmcnt(6)
    v_mfma_f32_16x16x32_bf16 v[84:87], v[48:51], v[72:75], v[84:87]
    ds_read_b64_tr_b16 v[36:37], v16 offset:49152
    v_mfma_f32_16x16x32_bf16 v[100:103], v[48:51], v[76:79], v[100:103]
    v_mfma_f32_16x16x32_bf16 v[164:167], v[48:51], v[60:63], v[164:167]
    ds_read_b64_tr_b16 v[38:39], v16 offset:49664
    s_add_u32 s55, s68, 7
    s_and_b32 s55, s55, 7
    s_mul_i32 s55, s55, 65536
    s_add_u32 s55, s55, s65
    s_add_u32 m0, s67, 40960
    s_add_u32 s54, s55, 0
    buffer_load_dwordx4 v56, s[36:39], s54 offen offset:0 lds
    buffer_load_dwordx4 v57, s[36:39], s54 offen offset:1024 lds
    s_waitcnt lgkmcnt(6)
    v_mfma_f32_16x16x32_bf16 v[88:91], v[28:31], v[72:75], v[88:91]
    ds_read_b64_tr_b16 v[40:41], v17 offset:49152
    v_mfma_f32_16x16x32_bf16 v[104:107], v[28:31], v[76:79], v[104:107]
    v_mfma_f32_16x16x32_bf16 v[144:147], v[60:63], v[72:75], v[144:147]
    v_mfma_f32_16x16x32_bf16 v[152:155], v[72:75], v[72:75], v[152:155]
    ds_read_b64_tr_b16 v[42:43], v17 offset:49664
    s_waitcnt lgkmcnt(6)
    v_mfma_f32_16x16x32_bf16 v[92:95], v[32:35], v[72:75], v[92:95]
    ds_read_b64_tr_b16 v[44:45], v18 offset:49152
    v_mfma_f32_16x16x32_bf16 v[108:111], v[32:35], v[76:79], v[108:111]
    v_mfma_f32_16x16x32_bf16 v[148:151], v[60:63], v[76:79], v[148:151]
    v_mfma_f32_16x16x32_bf16 v[156:159], v[76:79], v[76:79], v[156:159]
    ds_read_b64_tr_b16 v[46:47], v18 offset:49664
    s_waitcnt lgkmcnt(6)
    s_waitcnt lgkmcnt(4)
    v_mfma_f32_16x16x32_bf16 v[80:83], v[36:39], v[64:67], v[80:83]
    ds_read_b64_tr_b16 v[48:49], v19 offset:49152
    v_mfma_f32_16x16x32_bf16 v[96:99], v[36:39], v[68:71], v[96:99]
    v_mfma_f32_16x16x32_bf16 v[160:163], v[36:39], v[60:63], v[160:163]
    ds_read_b64_tr_b16 v[50:51], v19 offset:49664
    ds_read_b128 v[72:75], v25 offset:32768
    ds_read_b128 v[76:79], v25 offset:34816
    s_waitcnt lgkmcnt(6)
    v_mfma_f32_16x16x32_bf16 v[84:87], v[40:43], v[64:67], v[84:87]
    ds_read_b64_tr_b16 v[28:29], v16 offset:53248
    v_mfma_f32_16x16x32_bf16 v[100:103], v[40:43], v[68:71], v[100:103]
    v_mfma_f32_16x16x32_bf16 v[164:167], v[40:43], v[60:63], v[164:167]
    ds_read_b64_tr_b16 v[30:31], v16 offset:53760
    s_waitcnt lgkmcnt(6)
    v_mfma_f32_16x16x32_bf16 v[88:91], v[44:47], v[64:67], v[88:91]
    ds_read_b64_tr_b16 v[32:33], v17 offset:53248
    v_mfma_f32_16x16x32_bf16 v[104:107], v[44:47], v[68:71], v[104:107]
    v_mfma_f32_16x16x32_bf16 v[144:147], v[60:63], v[64:67], v[144:147]
    v_mfma_f32_16x16x32_bf16 v[152:155], v[64:67], v[64:67], v[152:155]
    ds_read_b64_tr_b16 v[34:35], v17 offset:53760
    s_waitcnt lgkmcnt(6)
    v_mfma_f32_16x16x32_bf16 v[92:95], v[48:51], v[64:67], v[92:95]
    ds_read_b64_tr_b16 v[36:37], v18 offset:53248
    v_mfma_f32_16x16x32_bf16 v[108:111], v[48:51], v[68:71], v[108:111]
    v_mfma_f32_16x16x32_bf16 v[148:151], v[60:63], v[68:71], v[148:151]
    v_mfma_f32_16x16x32_bf16 v[156:159], v[68:71], v[68:71], v[156:159]
    ds_read_b64_tr_b16 v[38:39], v18 offset:53760
    s_waitcnt vmcnt(16)
    s_barrier
    s_waitcnt lgkmcnt(6)
    s_waitcnt lgkmcnt(4)
    v_mfma_f32_16x16x32_bf16 v[80:83], v[28:31], v[72:75], v[80:83]
    ds_read_b64_tr_b16 v[40:41], v19 offset:53248
    v_mfma_f32_16x16x32_bf16 v[96:99], v[28:31], v[76:79], v[96:99]
    v_mfma_f32_16x16x32_bf16 v[160:163], v[28:31], v[60:63], v[160:163]
    ds_read_b64_tr_b16 v[42:43], v19 offset:53760
    ds_read_b128 v[64:67], v24 offset:57344
    ds_read_b128 v[68:71], v24 offset:59392
    s_waitcnt lgkmcnt(6)
    v_mfma_f32_16x16x32_bf16 v[84:87], v[32:35], v[72:75], v[84:87]
    v_add_u32 v16, 65536, v16
    v_add_u32 v17, 65536, v17
    v_add_u32 v18, 65536, v18
    v_add_u32 v19, 65536, v19
    ds_read_b64_tr_b16 v[44:45], v16 offset:8192
    v_mfma_f32_16x16x32_bf16 v[100:103], v[32:35], v[76:79], v[100:103]
    v_mfma_f32_16x16x32_bf16 v[164:167], v[32:35], v[60:63], v[164:167]
    ds_read_b64_tr_b16 v[46:47], v16 offset:8704
    s_waitcnt lgkmcnt(6)
    v_mfma_f32_16x16x32_bf16 v[88:91], v[36:39], v[72:75], v[88:91]
    ds_read_b64_tr_b16 v[48:49], v17 offset:8192
    v_mfma_f32_16x16x32_bf16 v[104:107], v[36:39], v[76:79], v[104:107]
    v_mfma_f32_16x16x32_bf16 v[144:147], v[60:63], v[72:75], v[144:147]
    v_mfma_f32_16x16x32_bf16 v[152:155], v[72:75], v[72:75], v[152:155]
    ds_read_b64_tr_b16 v[50:51], v17 offset:8704
    s_waitcnt lgkmcnt(6)
    v_mfma_f32_16x16x32_bf16 v[92:95], v[40:43], v[72:75], v[92:95]
    ds_read_b64_tr_b16 v[28:29], v18 offset:8192
    v_mfma_f32_16x16x32_bf16 v[108:111], v[40:43], v[76:79], v[108:111]
    v_mfma_f32_16x16x32_bf16 v[148:151], v[60:63], v[76:79], v[148:151]
    v_mfma_f32_16x16x32_bf16 v[156:159], v[76:79], v[76:79], v[156:159]
    ds_read_b64_tr_b16 v[30:31], v18 offset:8704
    s_mov_b32 s44, s28
    s_and_b32 s45, s29, 0xffff
    s_mov_b32 s46, 0x100
    s_mov_b32 s47, 0x20000
    v_mov_b32 v232, 128
    buffer_load_dword v234, v232, s[44:47], 0 offen sc1
    s_waitcnt lgkmcnt(6)
    s_waitcnt lgkmcnt(4)
    v_mfma_f32_16x16x32_bf16 v[80:83], v[44:47], v[64:67], v[80:83]
    ds_read_b64_tr_b16 v[32:33], v19 offset:8192
    v_mfma_f32_16x16x32_bf16 v[96:99], v[44:47], v[68:71], v[96:99]
    v_mfma_f32_16x16x32_bf16 v[160:163], v[44:47], v[60:63], v[160:163]
    ds_read_b64_tr_b16 v[34:35], v19 offset:8704
    ds_read_b128 v[72:75], v25 offset:57344
    ds_read_b128 v[76:79], v25 offset:59392
    s_waitcnt lgkmcnt(6)
    v_mfma_f32_16x16x32_bf16 v[84:87], v[48:51], v[64:67], v[84:87]
    ds_read_b64_tr_b16 v[36:37], v16 offset:12288
    v_mfma_f32_16x16x32_bf16 v[100:103], v[48:51], v[68:71], v[100:103]
    v_mfma_f32_16x16x32_bf16 v[164:167], v[48:51], v[60:63], v[164:167]
    ds_read_b64_tr_b16 v[38:39], v16 offset:12800
    s_waitcnt lgkmcnt(6)
    v_mfma_f32_16x16x32_bf16 v[88:91], v[28:31], v[64:67], v[88:91]
    ds_read_b64_tr_b16 v[40:41], v17 offset:12288
    v_mfma_f32_16x16x32_bf16 v[104:107], v[28:31], v[68:71], v[104:107]
    v_mfma_f32_16x16x32_bf16 v[144:147], v[60:63], v[64:67], v[144:147]
    v_mfma_f32_16x16x32_bf16 v[152:155], v[64:67], v[64:67], v[152:155]
    ds_read_b64_tr_b16 v[42:43], v17 offset:12800
    s_waitcnt lgkmcnt(6)
    v_mfma_f32_16x16x32_bf16 v[92:95], v[32:35], v[64:67], v[92:95]
    ds_read_b64_tr_b16 v[44:45], v18 offset:12288
    v_mfma_f32_16x16x32_bf16 v[108:111], v[32:35], v[68:71], v[108:111]
    v_mfma_f32_16x16x32_bf16 v[148:151], v[60:63], v[68:71], v[148:151]
    v_mfma_f32_16x16x32_bf16 v[156:159], v[68:71], v[68:71], v[156:159]
    ds_read_b64_tr_b16 v[46:47], v18 offset:12800
    s_waitcnt vmcnt(11)
    s_barrier
    s_waitcnt lgkmcnt(6)
    s_waitcnt lgkmcnt(4)
    v_mfma_f32_16x16x32_bf16 v[80:83], v[36:39], v[72:75], v[80:83]
    ds_read_b64_tr_b16 v[48:49], v19 offset:12288
    v_mfma_f32_16x16x32_bf16 v[96:99], v[36:39], v[76:79], v[96:99]
    v_mfma_f32_16x16x32_bf16 v[160:163], v[36:39], v[60:63], v[160:163]
    ds_read_b64_tr_b16 v[50:51], v19 offset:12800
    v_subrev_u32 v24, 65536, v24
    v_subrev_u32 v25, 65536, v25
    ds_read_b128 v[64:67], v24 offset:0
    ds_read_b128 v[68:71], v24 offset:2048
    s_waitcnt lgkmcnt(6)
    v_mfma_f32_16x16x32_bf16 v[84:87], v[40:43], v[72:75], v[84:87]
    v_subrev_u32 v16, 131072, v16
    v_subrev_u32 v17, 131072, v17
    v_subrev_u32 v18, 131072, v18
    v_subrev_u32 v19, 131072, v19
    ds_read_b64_tr_b16 v[28:29], v16 offset:16384
    v_mfma_f32_16x16x32_bf16 v[100:103], v[40:43], v[76:79], v[100:103]
    v_mfma_f32_16x16x32_bf16 v[164:167], v[40:43], v[60:63], v[164:167]
    ds_read_b64_tr_b16 v[30:31], v16 offset:16896
    s_waitcnt lgkmcnt(6)
    v_mfma_f32_16x16x32_bf16 v[88:91], v[44:47], v[72:75], v[88:91]
    ds_read_b64_tr_b16 v[32:33], v17 offset:16384
    v_mfma_f32_16x16x32_bf16 v[104:107], v[44:47], v[76:79], v[104:107]
    v_mfma_f32_16x16x32_bf16 v[144:147], v[60:63], v[72:75], v[144:147]
    v_mfma_f32_16x16x32_bf16 v[152:155], v[72:75], v[72:75], v[152:155]
    ds_read_b64_tr_b16 v[34:35], v17 offset:16896
    s_waitcnt lgkmcnt(6)
    v_mfma_f32_16x16x32_bf16 v[92:95], v[48:51], v[72:75], v[92:95]
    ds_read_b64_tr_b16 v[36:37], v18 offset:16384
    v_mfma_f32_16x16x32_bf16 v[108:111], v[48:51], v[76:79], v[108:111]
    v_mfma_f32_16x16x32_bf16 v[148:151], v[60:63], v[76:79], v[148:151]
    v_mfma_f32_16x16x32_bf16 v[156:159], v[76:79], v[76:79], v[156:159]
    ds_read_b64_tr_b16 v[38:39], v18 offset:16896
    s_waitcnt lgkmcnt(6)
    s_waitcnt lgkmcnt(4)
    v_mfma_f32_16x16x32_bf16 v[80:83], v[28:31], v[64:67], v[80:83]
    ds_read_b64_tr_b16 v[40:41], v19 offset:16384
    v_mfma_f32_16x16x32_bf16 v[96:99], v[28:31], v[68:71], v[96:99]
    v_mfma_f32_16x16x32_bf16 v[160:163], v[28:31], v[60:63], v[160:163]
    ds_read_b64_tr_b16 v[42:43], v19 offset:16896
    ds_read_b128 v[72:75], v25 offset:0
    ds_read_b128 v[76:79], v25 offset:2048
    s_waitcnt lgkmcnt(6)
    v_mfma_f32_16x16x32_bf16 v[84:87], v[32:35], v[64:67], v[84:87]
    ds_read_b64_tr_b16 v[44:45], v16 offset:20480
    v_mfma_f32_16x16x32_bf16 v[100:103], v[32:35], v[68:71], v[100:103]
    v_mfma_f32_16x16x32_bf16 v[164:167], v[32:35], v[60:63], v[164:167]
    ds_read_b64_tr_b16 v[46:47], v16 offset:20992
    s_waitcnt lgkmcnt(6)
    v_mfma_f32_16x16x32_bf16 v[88:91], v[36:39], v[64:67], v[88:91]
    ds_read_b64_tr_b16 v[48:49], v17 offset:20480
    v_mfma_f32_16x16x32_bf16 v[104:107], v[36:39], v[68:71], v[104:107]
    v_mfma_f32_16x16x32_bf16 v[144:147], v[60:63], v[64:67], v[144:147]
    v_mfma_f32_16x16x32_bf16 v[152:155], v[64:67], v[64:67], v[152:155]
    ds_read_b64_tr_b16 v[50:51], v17 offset:20992
    s_waitcnt lgkmcnt(6)
    v_mfma_f32_16x16x32_bf16 v[92:95], v[40:43], v[64:67], v[92:95]
    ds_read_b64_tr_b16 v[28:29], v18 offset:20480
    v_mfma_f32_16x16x32_bf16 v[108:111], v[40:43], v[68:71], v[108:111]
    v_mfma_f32_16x16x32_bf16 v[148:151], v[60:63], v[68:71], v[148:151]
    v_mfma_f32_16x16x32_bf16 v[156:159], v[68:71], v[68:71], v[156:159]
    ds_read_b64_tr_b16 v[30:31], v18 offset:20992
    s_waitcnt vmcnt(1)
    s_barrier
    s_waitcnt lgkmcnt(6)
    s_waitcnt lgkmcnt(4)
    v_mfma_f32_16x16x32_bf16 v[80:83], v[44:47], v[72:75], v[80:83]
    ds_read_b64_tr_b16 v[32:33], v19 offset:20480
    v_mfma_f32_16x16x32_bf16 v[96:99], v[44:47], v[76:79], v[96:99]
    v_mfma_f32_16x16x32_bf16 v[160:163], v[44:47], v[60:63], v[160:163]
    ds_read_b64_tr_b16 v[34:35], v19 offset:20992
    ds_read_b128 v[64:67], v24 offset:24576
    ds_read_b128 v[68:71], v24 offset:26624
    s_waitcnt lgkmcnt(6)
    v_mfma_f32_16x16x32_bf16 v[84:87], v[48:51], v[72:75], v[84:87]
    ds_read_b64_tr_b16 v[36:37], v16 offset:40960
    v_mfma_f32_16x16x32_bf16 v[100:103], v[48:51], v[76:79], v[100:103]
    v_mfma_f32_16x16x32_bf16 v[164:167], v[48:51], v[60:63], v[164:167]
    ds_read_b64_tr_b16 v[38:39], v16 offset:41472
    s_waitcnt lgkmcnt(6)
    v_mfma_f32_16x16x32_bf16 v[88:91], v[28:31], v[72:75], v[88:91]
    ds_read_b64_tr_b16 v[40:41], v17 offset:40960
    v_mfma_f32_16x16x32_bf16 v[104:107], v[28:31], v[76:79], v[104:107]
    v_mfma_f32_16x16x32_bf16 v[144:147], v[60:63], v[72:75], v[144:147]
    v_mfma_f32_16x16x32_bf16 v[152:155], v[72:75], v[72:75], v[152:155]
    ds_read_b64_tr_b16 v[42:43], v17 offset:41472
    s_waitcnt lgkmcnt(6)
    v_mfma_f32_16x16x32_bf16 v[92:95], v[32:35], v[72:75], v[92:95]
    ds_read_b64_tr_b16 v[44:45], v18 offset:40960
    v_mfma_f32_16x16x32_bf16 v[108:111], v[32:35], v[76:79], v[108:111]
    v_mfma_f32_16x16x32_bf16 v[148:151], v[60:63], v[76:79], v[148:151]
    v_mfma_f32_16x16x32_bf16 v[156:159], v[76:79], v[76:79], v[156:159]
    ds_read_b64_tr_b16 v[46:47], v18 offset:41472
    s_waitcnt lgkmcnt(6)
    s_waitcnt lgkmcnt(4)
    v_mfma_f32_16x16x32_bf16 v[80:83], v[36:39], v[64:67], v[80:83]
    ds_read_b64_tr_b16 v[48:49], v19 offset:40960
    v_mfma_f32_16x16x32_bf16 v[96:99], v[36:39], v[68:71], v[96:99]
    v_mfma_f32_16x16x32_bf16 v[160:163], v[36:39], v[60:63], v[160:163]
    ds_read_b64_tr_b16 v[50:51], v19 offset:41472
    ds_read_b128 v[72:75], v25 offset:24576
    ds_read_b128 v[76:79], v25 offset:26624
    s_waitcnt lgkmcnt(6)
    v_mfma_f32_16x16x32_bf16 v[84:87], v[40:43], v[64:67], v[84:87]
    ds_read_b64_tr_b16 v[28:29], v16 offset:45056
    v_mfma_f32_16x16x32_bf16 v[100:103], v[40:43], v[68:71], v[100:103]
    v_mfma_f32_16x16x32_bf16 v[164:167], v[40:43], v[60:63], v[164:167]
    ds_read_b64_tr_b16 v[30:31], v16 offset:45568
    s_waitcnt lgkmcnt(6)
    v_mfma_f32_16x16x32_bf16 v[88:91], v[44:47], v[64:67], v[88:91]
    ds_read_b64_tr_b16 v[32:33], v17 offset:45056
    v_mfma_f32_16x16x32_bf16 v[104:107], v[44:47], v[68:71], v[104:107]
    v_mfma_f32_16x16x32_bf16 v[144:147], v[60:63], v[64:67], v[144:147]
    v_mfma_f32_16x16x32_bf16 v[152:155], v[64:67], v[64:67], v[152:155]
    ds_read_b64_tr_b16 v[34:35], v17 offset:45568
    s_waitcnt lgkmcnt(6)
    v_mfma_f32_16x16x32_bf16 v[92:95], v[48:51], v[64:67], v[92:95]
    ds_read_b64_tr_b16 v[36:37], v18 offset:45056
    v_mfma_f32_16x16x32_bf16 v[108:111], v[48:51], v[68:71], v[108:111]
    v_mfma_f32_16x16x32_bf16 v[148:151], v[60:63], v[68:71], v[148:151]
    v_mfma_f32_16x16x32_bf16 v[156:159], v[68:71], v[68:71], v[156:159]
    ds_read_b64_tr_b16 v[38:39], v18 offset:45568
    s_waitcnt lgkmcnt(6)
    s_waitcnt lgkmcnt(4)
    v_mfma_f32_16x16x32_bf16 v[80:83], v[28:31], v[72:75], v[80:83]
    ds_read_b64_tr_b16 v[40:41], v19 offset:45056
    v_mfma_f32_16x16x32_bf16 v[96:99], v[28:31], v[76:79], v[96:99]
    v_mfma_f32_16x16x32_bf16 v[160:163], v[28:31], v[60:63], v[160:163]
    ds_read_b64_tr_b16 v[42:43], v19 offset:45568
    s_waitcnt lgkmcnt(4)
    v_mfma_f32_16x16x32_bf16 v[84:87], v[32:35], v[72:75], v[84:87]
    v_mfma_f32_16x16x32_bf16 v[100:103], v[32:35], v[76:79], v[100:103]
    v_mfma_f32_16x16x32_bf16 v[164:167], v[32:35], v[60:63], v[164:167]
    s_waitcnt lgkmcnt(2)
    v_mfma_f32_16x16x32_bf16 v[88:91], v[36:39], v[72:75], v[88:91]
    v_mfma_f32_16x16x32_bf16 v[104:107], v[36:39], v[76:79], v[104:107]
    v_mfma_f32_16x16x32_bf16 v[144:147], v[60:63], v[72:75], v[144:147]
    v_mfma_f32_16x16x32_bf16 v[152:155], v[72:75], v[72:75], v[152:155]
    s_waitcnt lgkmcnt(0)
    v_mfma_f32_16x16x32_bf16 v[92:95], v[40:43], v[72:75], v[92:95]
    v_mfma_f32_16x16x32_bf16 v[108:111], v[40:43], v[76:79], v[108:111]
    v_mfma_f32_16x16x32_bf16 v[148:151], v[60:63], v[76:79], v[148:151]
    v_mfma_f32_16x16x32_bf16 v[156:159], v[76:79], v[76:79], v[156:159]
    s_barrier
    s_mov_b32 s60, 400000
    s_waitcnt vmcnt(0)
    s_branch L_rdyc_5
L_rdy_3:
    buffer_load_dword v234, v232, s[44:47], 0 offen sc1
    s_waitcnt vmcnt(0)
L_rdyc_5:
    v_cmp_ne_u32 vcc, 0, v234
    s_nop 3
    s_cmp_eq_u64 vcc, -1
    s_cbranch_scc1 L_rdyo_4
    s_sub_u32 s60, s60, 1
    s_cmp_eq_u32 s60, 0
    s_cbranch_scc1 L_rdyo_4
    s_branch L_rdy_3
L_rdyo_4:
    s_lshl_b32 s67, s76, 3
    s_lshl_b32 s52, s48, 1
    s_add_u32 s67, s67, s52
    v_lshlrev_b32 v4, 10, v2
    v_lshl_add_u32 v4, v3, 3, v4
    s_lshl_b32 s52, s67, 14
    s_lshl_b32 s53, s77, 7
    s_add_u32 s52, s52, s53
    s_add_u32 s53, s52, 16384
    buffer_load_dwordx2 v[112:113], v4, s[32:35], s52 offen offset:0
    buffer_load_dwordx2 v[114:115], v4, s[32:35], s52 offen offset:32
    buffer_load_dwordx2 v[116:117], v4, s[32:35], s52 offen offset:64
    buffer_load_dwordx2 v[118:119], v4, s[32:35], s52 offen offset:96
    buffer_load_dwordx2 v[120:121], v4, s[32:35], s53 offen offset:0
    buffer_load_dwordx2 v[122:123], v4, s[32:35], s53 offen offset:32
    buffer_load_dwordx2 v[124:125], v4, s[32:35], s53 offen offset:64
    buffer_load_dwordx2 v[126:127], v4, s[32:35], s53 offen offset:96
    v_lshrrev_b32 v4, 3, v1
    v_and_b32 v5, 7, v1
    v_and_b32 v6, 6, v4
    v_xor_b32 v5, v5, v6
    v_lshlrev_b32 v5, 4, v5
    v_mul_u32_u24 v4, 1024, v4
    v_add_u32 v20, v4, v5
    v_add_u32 v21, 7168, v20
    v_add_u32 v22, 14336, v20
    v_add_u32 v23, 21504, v20
    s_mov_b32 s36, s18
    s_and_b32 s37, s19, 0xffff
    s_mov_b32 s38, 0x80000
    s_mov_b32 s39, 0x20000
    s_lshl_b32 s52, s77, 7
    s_lshl_b32 s53, s48, 17
    s_add_u32 s64, s52, s53
    s_lshl_b32 s66, s48, 14
    s_and_b32 s55, s48, 1
    s_lshl_b32 s52, s55, 7
    s_add_u32 s52, s52, 147456
    v_lshlrev_b32 v4, 4, v3
    v_add_u32 v5, s52, v4
    v_add_u32 v4, 147456, v4
    v_cmp_eq_u32 vcc, 0, v2
    s_nop 3
    s_and_saveexec_b64 s[56:57], vcc
    ds_write_b128 v5, v[160:163]
    ds_write_b128 v5, v[164:167] offset:64
    s_mov_b64 exec, s[56:57]
    v_and_b32 v6, 1, v2
    v_and_b32 v7, 2, v2
    v_cmp_eq_u32 s[56:57], 1, v6
    v_cmp_eq_u32 s[58:59], 2, v7
    v_lshrrev_b32 v6, 2, v2
    v_lshl_add_u32 v6, v6, 4, v2
    v_lshlrev_b32 v6, 2, v6
    v_cndmask_b32 v168, v152, v153, s[56:57]
    v_cndmask_b32 v169, v154, v155, s[56:57]
    v_cndmask_b32 v168, v168, v169, s[58:59]
    ds_bpermute_b32 v172, v6, v168
    v_cndmask_b32 v170, v156, v157, s[56:57]
    v_cndmask_b32 v171, v158, v159, s[56:57]
    v_cndmask_b32 v170, v170, v171, s[58:59]
    ds_bpermute_b32 v173, v6, v170
    s_waitcnt lgkmcnt(0)
    s_barrier
    s_lshl_b32 s52, s55, 7
    v_add_u32 v8, s52, v4
    s_xor_b32 s52, s52, 128
    v_add_u32 v9, s52, v4
    ds_read_b128 v[192:195], v8 offset:0
    ds_read_b128 v[196:199], v8 offset:64
    ds_read_b128 v[200:203], v9 offset:0
    ds_read_b128 v[204:207], v9 offset:64
    v_mul_f32 v176, 0xbb000000, v144
    v_mul_f32 v174, 0x3b000000, v172
    v_fma_f32 v174, -v176, v176, v174
    v_max_f32 v174, 0, v174
    v_add_f32 v174, 0x3727c5ac, v174
    v_rsq_f32 v177, v174
    v_mul_f32 v178, 0xbb000000, v148
    v_mul_f32 v174, 0x3b000000, v173
    v_fma_f32 v174, -v178, v178, v174
    v_max_f32 v174, 0, v174
    v_add_f32 v174, 0x3727c5ac, v174
    v_rsq_f32 v179, v174
    v_mov_b32 v180, 0xbdd2d3e8
    v_mov_b32 v181, 0xbdd2d3e8
    v_mov_b32 v182, 0xc0135761
    v_mov_b32 v183, 0xc0135761
    v_mov_b32 v184, 0x3f800000
    v_mov_b32 v185, 0x3f800000
    s_lshl_b32 s53, s76, 3
    s_lshl_b32 s54, s48, 1
    s_add_u32 s53, s53, s54
    s_lshl_b32 s53, s53, 14
    s_add_u32 s53, s53, 2097152
    s_lshl_b32 s54, s77, 11
    s_add_u32 s53, s53, s54
    s_lshl_b32 s54, s55, 10
    s_add_u32 s56, s53, s54
    s_xor_b32 s54, s54, 1024
    s_add_u32 s57, s53, s54
    v_add_u32 v186, 16384, v27
    s_waitcnt lgkmcnt(0)
    v_pk_fma_f32 v[80:81], v[192:193], v[176:177], v[80:81] op_sel_hi:[1,0,1]
    v_pk_fma_f32 v[82:83], v[194:195], v[176:177], v[82:83] op_sel_hi:[1,0,1]
    v_pk_fma_f32 v[84:85], v[196:197], v[176:177], v[84:85] op_sel_hi:[1,0,1]
    v_pk_fma_f32 v[86:87], v[198:199], v[176:177], v[86:87] op_sel_hi:[1,0,1]
    v_pk_mul_f32 v[80:81], v[80:81], v[176:177] op_sel:[0,1] op_sel_hi:[1,1]
    v_pk_mul_f32 v[82:83], v[82:83], v[176:177] op_sel:[0,1] op_sel_hi:[1,1]
    v_pk_mul_f32 v[84:85], v[84:85], v[176:177] op_sel:[0,1] op_sel_hi:[1,1]
    v_pk_mul_f32 v[86:87], v[86:87], v[176:177] op_sel:[0,1] op_sel_hi:[1,1]
    v_pk_mul_f32 v[224:225], v[80:81], v[80:81]
    v_pk_mul_f32 v[226:227], v[82:83], v[82:83]
    v_pk_mul_f32 v[228:229], v[84:85], v[84:85]
    v_pk_mul_f32 v[230:231], v[86:87], v[86:87]
    v_pk_fma_f32 v[224:225], v[224:225], v[180:181], v[182:183]
    v_pk_fma_f32 v[226:227], v[226:227], v[180:181], v[182:183]
    v_pk_fma_f32 v[228:229], v[228:229], v[180:181], v[182:183]
    v_pk_fma_f32 v[230:231], v[230:231], v[180:181], v[182:183]
    s_add_u32 m0, s66, 0
    s_add_u32 s6, s64, 0
    buffer_load_dwordx4 v20, s[36:39], s6 offen offset:0 lds
    v_pk_mul_f32 v[224:225], v[224:225], v[80:81]
    v_pk_mul_f32 v[226:227], v[226:227], v[82:83]
    v_pk_mul_f32 v[228:229], v[228:229], v[84:85]
    v_pk_mul_f32 v[230:231], v[230:231], v[86:87]
    v_exp_f32 v224, v224
    v_exp_f32 v225, v225
    v_exp_f32 v226, v226
    v_exp_f32 v227, v227
    v_exp_f32 v228, v228
    v_exp_f32 v229, v229
    v_exp_f32 v230, v230
    v_exp_f32 v231, v231
    buffer_load_dwordx4 v21, s[36:39], s6 offen offset:1024 lds
    v_pk_add_f32 v[224:225], v[224:225], v[184:185]
    v_pk_add_f32 v[226:227], v[226:227], v[184:185]
    v_pk_add_f32 v[228:229], v[228:229], v[184:185]
    v_pk_add_f32 v[230:231], v[230:231], v[184:185]
    buffer_load_dwordx4 v22, s[36:39], s6 offen offset:2048 lds
    v_rcp_f32 v224, v224
    v_rcp_f32 v225, v225
    v_rcp_f32 v226, v226
    v_rcp_f32 v227, v227
    v_rcp_f32 v228, v228
    v_rcp_f32 v229, v229
    v_rcp_f32 v230, v230
    v_rcp_f32 v231, v231
    buffer_load_dwordx4 v23, s[36:39], s6 offen offset:3072 lds
    v_pk_mul_f32 v[80:81], v[80:81], v[224:225]
    v_pk_mul_f32 v[82:83], v[82:83], v[226:227]
    v_pk_mul_f32 v[84:85], v[84:85], v[228:229]
    v_pk_mul_f32 v[86:87], v[86:87], v[230:231]
    v_cvt_pk_bf16_f32 v232, v80, v81
    v_cvt_pk_bf16_f32 v233, v82, v83
    v_cvt_pk_bf16_f32 v234, v84, v85
    v_cvt_pk_bf16_f32 v235, v86, v87
    buffer_store_dwordx4 v[232:235], v27, s[40:43], s56 offen sc1
    v_pk_fma_f32 v[88:89], v[200:201], v[176:177], v[88:89] op_sel_hi:[1,0,1]
    v_pk_fma_f32 v[90:91], v[202:203], v[176:177], v[90:91] op_sel_hi:[1,0,1]
    v_pk_fma_f32 v[92:93], v[204:205], v[176:177], v[92:93] op_sel_hi:[1,0,1]
    v_pk_fma_f32 v[94:95], v[206:207], v[176:177], v[94:95] op_sel_hi:[1,0,1]
    v_pk_mul_f32 v[88:89], v[88:89], v[176:177] op_sel:[0,1] op_sel_hi:[1,1]
    v_pk_mul_f32 v[90:91], v[90:91], v[176:177] op_sel:[0,1] op_sel_hi:[1,1]
    v_pk_mul_f32 v[92:93], v[92:93], v[176:177] op_sel:[0,1] op_sel_hi:[1,1]
    v_pk_mul_f32 v[94:95], v[94:95], v[176:177] op_sel:[0,1] op_sel_hi:[1,1]
    v_pk_mul_f32 v[224:225], v[88:89], v[88:89]
    v_pk_mul_f32 v[226:227], v[90:91], v[90:91]
    v_pk_mul_f32 v[228:229], v[92:93], v[92:93]
    v_pk_mul_f32 v[230:231], v[94:95], v[94:95]
    v_pk_fma_f32 v[224:225], v[224:225], v[180:181], v[182:183]
    v_pk_fma_f32 v[226:227], v[226:227], v[180:181], v[182:183]
    v_pk_fma_f32 v[228:229], v[228:229], v[180:181], v[182:183]
    v_pk_fma_f32 v[230:231], v[230:231], v[180:181], v[182:183]
    s_add_u32 m0, s66, 4096
    s_add_u32 s6, s64, 32768
    buffer_load_dwordx4 v20, s[36:39], s6 offen offset:0 lds
    v_pk_mul_f32 v[224:225], v[224:225], v[88:89]
    v_pk_mul_f32 v[226:227], v[226:227], v[90:91]
    v_pk_mul_f32 v[228:229], v[228:229], v[92:93]
    v_pk_mul_f32 v[230:231], v[230:231], v[94:95]
    v_exp_f32 v224, v224
    v_exp_f32 v225, v225
    v_exp_f32 v226, v226
    v_exp_f32 v227, v227
    v_exp_f32 v228, v228
    v_exp_f32 v229, v229
    v_exp_f32 v230, v230
    v_exp_f32 v231, v231
    buffer_load_dwordx4 v21, s[36:39], s6 offen offset:1024 lds
    v_pk_add_f32 v[224:225], v[224:225], v[184:185]
    v_pk_add_f32 v[226:227], v[226:227], v[184:185]
    v_pk_add_f32 v[228:229], v[228:229], v[184:185]
    v_pk_add_f32 v[230:231], v[230:231], v[184:185]
    buffer_load_dwordx4 v22, s[36:39], s6 offen offset:2048 lds
    v_rcp_f32 v224, v224
    v_rcp_f32 v225, v225
    v_rcp_f32 v226, v226
    v_rcp_f32 v227, v227
    v_rcp_f32 v228, v228
    v_rcp_f32 v229, v229
    v_rcp_f32 v230, v230
    v_rcp_f32 v231, v231
    buffer_load_dwordx4 v23, s[36:39], s6 offen offset:3072 lds
    v_pk_mul_f32 v[88:89], v[88:89], v[224:225]
    v_pk_mul_f32 v[90:91], v[90:91], v[226:227]
    v_pk_mul_f32 v[92:93], v[92:93], v[228:229]
    v_pk_mul_f32 v[94:95], v[94:95], v[230:231]
    v_cvt_pk_bf16_f32 v236, v88, v89
    v_cvt_pk_bf16_f32 v237, v90, v91
    v_cvt_pk_bf16_f32 v238, v92, v93
    v_cvt_pk_bf16_f32 v239, v94, v95
    buffer_store_dwordx4 v[236:239], v27, s[40:43], s57 offen sc1
    v_pk_fma_f32 v[96:97], v[192:193], v[178:179], v[96:97] op_sel_hi:[1,0,1]
    v_pk_fma_f32 v[98:99], v[194:195], v[178:179], v[98:99] op_sel_hi:[1,0,1]
    v_pk_fma_f32 v[100:101], v[196:197], v[178:179], v[100:101] op_sel_hi:[1,0,1]
    v_pk_fma_f32 v[102:103], v[198:199], v[178:179], v[102:103] op_sel_hi:[1,0,1]
    v_pk_mul_f32 v[96:97], v[96:97], v[178:179] op_sel:[0,1] op_sel_hi:[1,1]
    v_pk_mul_f32 v[98:99], v[98:99], v[178:179] op_sel:[0,1] op_sel_hi:[1,1]
    v_pk_mul_f32 v[100:101], v[100:101], v[178:179] op_sel:[0,1] op_sel_hi:[1,1]
    v_pk_mul_f32 v[102:103], v[102:103], v[178:179] op_sel:[0,1] op_sel_hi:[1,1]
    v_pk_mul_f32 v[224:225], v[96:97], v[96:97]
    v_pk_mul_f32 v[226:227], v[98:99], v[98:99]
    v_pk_mul_f32 v[228:229], v[100:101], v[100:101]
    v_pk_mul_f32 v[230:231], v[102:103], v[102:103]
    v_pk_fma_f32 v[224:225], v[224:225], v[180:181], v[182:183]
    v_pk_fma_f32 v[226:227], v[226:227], v[180:181], v[182:183]
    v_pk_fma_f32 v[228:229], v[228:229], v[180:181], v[182:183]
    v_pk_fma_f32 v[230:231], v[230:231], v[180:181], v[182:183]
    s_add_u32 m0, s66, 8192
    s_add_u32 s6, s64, 65536
    buffer_load_dwordx4 v20, s[36:39], s6 offen offset:0 lds
    v_pk_mul_f32 v[224:225], v[224:225], v[96:97]
    v_pk_mul_f32 v[226:227], v[226:227], v[98:99]
    v_pk_mul_f32 v[228:229], v[228:229], v[100:101]
    v_pk_mul_f32 v[230:231], v[230:231], v[102:103]
    v_exp_f32 v224, v224
    v_exp_f32 v225, v225
    v_exp_f32 v226, v226
    v_exp_f32 v227, v227
    v_exp_f32 v228, v228
    v_exp_f32 v229, v229
    v_exp_f32 v230, v230
    v_exp_f32 v231, v231
    buffer_load_dwordx4 v21, s[36:39], s6 offen offset:1024 lds
    v_pk_add_f32 v[224:225], v[224:225], v[184:185]
    v_pk_add_f32 v[226:227], v[226:227], v[184:185]
    v_pk_add_f32 v[228:229], v[228:229], v[184:185]
    v_pk_add_f32 v[230:231], v[230:231], v[184:185]
    buffer_load_dwordx4 v22, s[36:39], s6 offen offset:2048 lds
    v_rcp_f32 v224, v224
    v_rcp_f32 v225, v225
    v_rcp_f32 v226, v226
    v_rcp_f32 v227, v227
    v_rcp_f32 v228, v228
    v_rcp_f32 v229, v229
    v_rcp_f32 v230, v230
    v_rcp_f32 v231, v231
    buffer_load_dwordx4 v23, s[36:39], s6 offen offset:3072 lds
    v_pk_mul_f32 v[96:97], v[96:97], v[224:225]
    v_pk_mul_f32 v[98:99], v[98:99], v[226:227]
    v_pk_mul_f32 v[100:101], v[100:101], v[228:229]
    v_pk_mul_f32 v[102:103], v[102:103], v[230:231]
    v_cvt_pk_bf16_f32 v232, v96, v97
    v_cvt_pk_bf16_f32 v233, v98, v99
    v_cvt_pk_bf16_f32 v234, v100, v101
    v_cvt_pk_bf16_f32 v235, v102, v103
    buffer_store_dwordx4 v[232:235], v186, s[40:43], s56 offen sc1
    v_pk_fma_f32 v[104:105], v[200:201], v[178:179], v[104:105] op_sel_hi:[1,0,1]
    v_pk_fma_f32 v[106:107], v[202:203], v[178:179], v[106:107] op_sel_hi:[1,0,1]
    v_pk_fma_f32 v[108:109], v[204:205], v[178:179], v[108:109] op_sel_hi:[1,0,1]
    v_pk_fma_f32 v[110:111], v[206:207], v[178:179], v[110:111] op_sel_hi:[1,0,1]
    v_pk_mul_f32 v[104:105], v[104:105], v[178:179] op_sel:[0,1] op_sel_hi:[1,1]
    v_pk_mul_f32 v[106:107], v[106:107], v[178:179] op_sel:[0,1] op_sel_hi:[1,1]
    v_pk_mul_f32 v[108:109], v[108:109], v[178:179] op_sel:[0,1] op_sel_hi:[1,1]
    v_pk_mul_f32 v[110:111], v[110:111], v[178:179] op_sel:[0,1] op_sel_hi:[1,1]
    v_pk_mul_f32 v[224:225], v[104:105], v[104:105]
    v_pk_mul_f32 v[226:227], v[106:107], v[106:107]
    v_pk_mul_f32 v[228:229], v[108:109], v[108:109]
    v_pk_mul_f32 v[230:231], v[110:111], v[110:111]
    v_pk_fma_f32 v[224:225], v[224:225], v[180:181], v[182:183]
    v_pk_fma_f32 v[226:227], v[226:227], v[180:181], v[182:183]
    v_pk_fma_f32 v[228:229], v[228:229], v[180:181], v[182:183]
    v_pk_fma_f32 v[230:231], v[230:231], v[180:181], v[182:183]
    s_add_u32 m0, s66, 12288
    s_add_u32 s6, s64, 98304
    buffer_load_dwordx4 v20, s[36:39], s6 offen offset:0 lds
    v_pk_mul_f32 v[224:225], v[224:225], v[104:105]
    v_pk_mul_f32 v[226:227], v[226:227], v[106:107]
    v_pk_mul_f32 v[228:229], v[228:229], v[108:109]
    v_pk_mul_f32 v[230:231], v[230:231], v[110:111]
    v_exp_f32 v224, v224
    v_exp_f32 v225, v225
    v_exp_f32 v226, v226
    v_exp_f32 v227, v227
    v_exp_f32 v228, v228
    v_exp_f32 v229, v229
    v_exp_f32 v230, v230
    v_exp_f32 v231, v231
    buffer_load_dwordx4 v21, s[36:39], s6 offen offset:1024 lds
    v_pk_add_f32 v[224:225], v[224:225], v[184:185]
    v_pk_add_f32 v[226:227], v[226:227], v[184:185]
    v_pk_add_f32 v[228:229], v[228:229], v[184:185]
    v_pk_add_f32 v[230:231], v[230:231], v[184:185]
    buffer_load_dwordx4 v22, s[36:39], s6 offen offset:2048 lds
    v_rcp_f32 v224, v224
    v_rcp_f32 v225, v225
    v_rcp_f32 v226, v226
    v_rcp_f32 v227, v227
    v_rcp_f32 v228, v228
    v_rcp_f32 v229, v229
    v_rcp_f32 v230, v230
    v_rcp_f32 v231, v231
    buffer_load_dwordx4 v23, s[36:39], s6 offen offset:3072 lds
    v_pk_mul_f32 v[104:105], v[104:105], v[224:225]
    v_pk_mul_f32 v[106:107], v[106:107], v[226:227]
    v_pk_mul_f32 v[108:109], v[108:109], v[228:229]
    v_pk_mul_f32 v[110:111], v[110:111], v[230:231]
    v_cvt_pk_bf16_f32 v236, v104, v105
    v_cvt_pk_bf16_f32 v237, v106, v107
    v_cvt_pk_bf16_f32 v238, v108, v109
    v_cvt_pk_bf16_f32 v239, v110, v111
    buffer_store_dwordx4 v[236:239], v186, s[40:43], s57 offen sc1
    s_and_b32 s55, s50, 7
    s_mov_b32 s36, s12
    s_and_b32 s37, s13, 0xffff
    s_mov_b32 s38, 0x80000
    s_mov_b32 s39, 0x20000
    s_lshl_b32 s52, s55, 7
    s_lshl_b32 s53, s48, 17
    s_add_u32 s64, s52, s53
    s_lshl_b32 s66, s48, 14
    s_add_u32 m0, s66, 65536
    s_add_u32 s6, s64, 0
    buffer_load_dwordx4 v20, s[36:39], s6 offen offset:0 lds
    buffer_load_dwordx4 v21, s[36:39], s6 offen offset:1024 lds
    buffer_load_dwordx4 v22, s[36:39], s6 offen offset:2048 lds
    buffer_load_dwordx4 v23, s[36:39], s6 offen offset:3072 lds
    s_add_u32 m0, s66, 69632
    s_add_u32 s6, s64, 32768
    buffer_load_dwordx4 v20, s[36:39], s6 offen offset:0 lds
    buffer_load_dwordx4 v21, s[36:39], s6 offen offset:1024 lds
    buffer_load_dwordx4 v22, s[36:39], s6 offen offset:2048 lds
    buffer_load_dwordx4 v23, s[36:39], s6 offen offset:3072 lds
    s_add_u32 m0, s66, 73728
    s_add_u32 s6, s64, 65536
    buffer_load_dwordx4 v20, s[36:39], s6 offen offset:0 lds
    buffer_load_dwordx4 v21, s[36:39], s6 offen offset:1024 lds
    buffer_load_dwordx4 v22, s[36:39], s6 offen offset:2048 lds
    buffer_load_dwordx4 v23, s[36:39], s6 offen offset:3072 lds
    s_add_u32 m0, s66, 77824
    s_add_u32 s6, s64, 98304
    buffer_load_dwordx4 v20, s[36:39], s6 offen offset:0 lds
    buffer_load_dwordx4 v21, s[36:39], s6 offen offset:1024 lds
    buffer_load_dwordx4 v22, s[36:39], s6 offen offset:2048 lds
    buffer_load_dwordx4 v23, s[36:39], s6 offen offset:3072 lds
    s_add_u32 s32, s30, 2097152
    s_addc_u32 s33, s31, 0
    s_and_b32 s33, s33, 0xffff
    s_mov_b32 s34, 0x200000
    s_mov_b32 s35, 0x20000
    s_lshl_b32 s52, s67, 4
    v_add_u32 v4, s52, v2
    v_lshlrev_b32 v5, 8, v3
    v_bfrev_b32 v10, 2
    v_add_u32 v6, -1, v4
    v_cmp_gt_u32 vcc, 2048, v6
    v_lshrrev_b32 v7, 4, v6
    v_lshlrev_b32 v7, 14, v7
    v_and_b32 v6, 15, v6
    v_lshl_add_u32 v7, v6, 4, v7
    v_add_u32 v7, v7, v5
    v_add_u32 v7, 0, v7
    v_cndmask_b32 v176, v10, v7, vcc
    v_add_u32 v6, 15, v4
    v_cmp_gt_u32 vcc, 2048, v6
    v_lshrrev_b32 v7, 4, v6
    v_lshlrev_b32 v7, 14, v7
    v_and_b32 v6, 15, v6
    v_lshl_add_u32 v7, v6, 4, v7
    v_add_u32 v7, v7, v5
    v_add_u32 v7, 0, v7
    v_cndmask_b32 v177, v10, v7, vcc
    v_add_u32 v6, 1, v4
    v_cmp_gt_u32 vcc, 2048, v6
    v_lshrrev_b32 v7, 4, v6
    v_lshlrev_b32 v7, 14, v7
    v_and_b32 v6, 15, v6
    v_lshl_add_u32 v7, v6, 4, v7
    v_add_u32 v7, v7, v5
    v_add_u32 v7, 4096, v7
    v_cndmask_b32 v178, v10, v7, vcc
    v_add_u32 v6, 17, v4
    v_cmp_gt_u32 vcc, 2048, v6
    v_lshrrev_b32 v7, 4, v6
    v_lshlrev_b32 v7, 14, v7
    v_and_b32 v6, 15, v6
    v_lshl_add_u32 v7, v6, 4, v7
    v_add_u32 v7, v7, v5
    v_add_u32 v7, 4096, v7
    v_cndmask_b32 v179, v10, v7, vcc
    v_add_u32 v6, -2, v4
    v_cmp_gt_u32 vcc, 2048, v6
    v_lshrrev_b32 v7, 4, v6
    v_lshlrev_b32 v7, 14, v7
    v_and_b32 v6, 15, v6
    v_lshl_add_u32 v7, v6, 4, v7
    v_add_u32 v7, v7, v5
    v_add_u32 v7, 8192, v7
    v_cndmask_b32 v180, v10, v7, vcc
    v_add_u32 v6, 14, v4
    v_cmp_gt_u32 vcc, 2048, v6
    v_lshrrev_b32 v7, 4, v6
    v_lshlrev_b32 v7, 14, v7
    v_and_b32 v6, 15, v6
    v_lshl_add_u32 v7, v6, 4, v7
    v_add_u32 v7, v7, v5
    v_add_u32 v7, 8192, v7
    v_cndmask_b32 v181, v10, v7, vcc
    v_add_u32 v6, 2, v4
    v_cmp_gt_u32 vcc, 2048, v6
    v_lshrrev_b32 v7, 4, v6
    v_lshlrev_b32 v7, 14, v7
    v_and_b32 v6, 15, v6
    v_lshl_add_u32 v7, v6, 4, v7
    v_add_u32 v7, v7, v5
    v_add_u32 v7, 12288, v7
    v_cndmask_b32 v182, v10, v7, vcc
    v_add_u32 v6, 18, v4
    v_cmp_gt_u32 vcc, 2048, v6
    v_lshrrev_b32 v7, 4, v6
    v_lshlrev_b32 v7, 14, v7
    v_and_b32 v6, 15, v6
    v_lshl_add_u32 v7, v6, 4, v7
    v_add_u32 v7, v7, v5
    v_add_u32 v7, 12288, v7
    v_cndmask_b32 v183, v10, v7, vcc
    v_cmp_gt_u32 vcc, 24, v1
    v_mov_b32 v9, 8
    s_nop 0
    v_cndmask_b32 v8, v9, v1, vcc
    v_lshrrev_b32 v9, 3, v8
    s_sub_u32 s52, s76, 1
    v_add_u32 v10, s52, v9
    v_cmp_gt_u32 vcc, 16, v10
    v_and_b32 v9, 7, v8
    v_add_u32 v9, 8, v9
    v_cndmask_b32 v8, v9, v8, vcc
    s_lshl_b32 s52, s76, 7
    s_add_u32 s52, s52, 15763456
    v_lshlrev_b32 v8, 2, v8
    v_add_u32 v184, s52, v8
    s_waitcnt vmcnt(16)
    s_barrier
    s_cmp_lg_u32 s48, 0
    s_cbranch_scc1 L_sig_6
    s_add_u32 s52, s76, 1
    v_sub_u32 v4, s52, v1
    v_cmp_gt_u32 vcc, 16, v4
    v_lshlrev_b32 v4, 7, v4
    v_lshl_add_u32 v4, v1, 5, v4
    s_lshl_b32 s52, s77, 2
    s_add_u32 s52, s52, 15763456
    v_add_u32 v4, s52, v4
    v_bfrev_b32 v6, 2
    v_cndmask_b32 v4, v6, v4, vcc
    v_mov_b32 v5, 1
    s_mov_b64 exec, 7
    buffer_store_dword v5, v4, s[40:43], 0 offen sc1
    s_mov_b64 exec, -1
L_sig_6:
    s_waitcnt vmcnt(0)
    s_barrier
    s_lshr_b32 s54, s48, 1
    s_lshl_b32 s54, s54, 15
    s_add_u32 s54, s54, 65536
    v_lshrrev_b32 v12, 2, v1
    v_and_b32 v12, 3, v12
    v_and_b32 v13, 1, v3
    v_lshlrev_b32 v13, 1, v13
    v_lshrrev_b32 v14, 1, v12
    v_or_b32 v13, v13, v14
    v_lshl_add_u32 v14, v3, 2, v12
    v_lshlrev_b32 v14, 7, v14
    v_and_b32 v15, 3, v1
    v_lshl_add_u32 v14, v15, 3, v14
    v_add_u32 v14, s54, v14
    v_xor_b32 v15, 0, v13
    v_lshl_add_u32 v16, v15, 5, v14
    v_xor_b32 v15, 1, v13
    v_lshl_add_u32 v17, v15, 5, v14
    v_xor_b32 v15, 2, v13
    v_lshl_add_u32 v18, v15, 5, v14
    v_xor_b32 v15, 3, v13
    v_lshl_add_u32 v19, v15, 5, v14
    ds_read_b64_tr_b16 a[128:129], v16 offset:0
    ds_read_b64_tr_b16 a[130:131], v16 offset:2048
    ds_read_b64_tr_b16 a[132:133], v17 offset:0
    ds_read_b64_tr_b16 a[134:135], v17 offset:2048
    ds_read_b64_tr_b16 a[136:137], v18 offset:0
    ds_read_b64_tr_b16 a[138:139], v18 offset:2048
    ds_read_b64_tr_b16 a[140:141], v19 offset:0
    ds_read_b64_tr_b16 a[142:143], v19 offset:2048
    ds_read_b64_tr_b16 a[144:145], v16 offset:4096
    ds_read_b64_tr_b16 a[146:147], v16 offset:6144
    ds_read_b64_tr_b16 a[148:149], v17 offset:4096
    ds_read_b64_tr_b16 a[150:151], v17 offset:6144
    s_waitcnt lgkmcnt(11)
    ds_read_b64_tr_b16 a[152:153], v18 offset:4096
    s_waitcnt lgkmcnt(11)
    ds_read_b64_tr_b16 a[154:155], v18 offset:6144
    s_waitcnt lgkmcnt(11)
    ds_read_b64_tr_b16 a[156:157], v19 offset:4096
    s_waitcnt lgkmcnt(11)
    ds_read_b64_tr_b16 a[158:159], v19 offset:6144
    s_waitcnt lgkmcnt(11)
    ds_read_b64_tr_b16 a[160:161], v16 offset:8192
    s_waitcnt lgkmcnt(11)
    ds_read_b64_tr_b16 a[162:163], v16 offset:10240
    s_waitcnt lgkmcnt(11)
    ds_read_b64_tr_b16 a[164:165], v17 offset:8192
    s_waitcnt lgkmcnt(11)
    ds_read_b64_tr_b16 a[166:167], v17 offset:10240
    s_waitcnt lgkmcnt(11)
    ds_read_b64_tr_b16 a[168:169], v18 offset:8192
    s_waitcnt lgkmcnt(11)
    ds_read_b64_tr_b16 a[170:171], v18 offset:10240
    s_waitcnt lgkmcnt(11)
    ds_read_b64_tr_b16 a[172:173], v19 offset:8192
    s_waitcnt lgkmcnt(11)
    ds_read_b64_tr_b16 a[174:175], v19 offset:10240
    s_waitcnt lgkmcnt(11)
    ds_read_b64_tr_b16 a[176:177], v16 offset:12288
    s_waitcnt lgkmcnt(11)
    ds_read_b64_tr_b16 a[178:179], v16 offset:14336
    s_waitcnt lgkmcnt(11)
    ds_read_b64_tr_b16 a[180:181], v17 offset:12288
    s_waitcnt lgkmcnt(11)
    ds_read_b64_tr_b16 a[182:183], v17 offset:14336
    s_waitcnt lgkmcnt(11)
    ds_read_b64_tr_b16 a[184:185], v18 offset:12288
    s_waitcnt lgkmcnt(11)
    ds_read_b64_tr_b16 a[186:187], v18 offset:14336
    s_waitcnt lgkmcnt(11)
    ds_read_b64_tr_b16 a[188:189], v19 offset:12288
    s_waitcnt lgkmcnt(11)
    ds_read_b64_tr_b16 a[190:191], v19 offset:14336
    s_waitcnt lgkmcnt(11)
    ds_read_b64_tr_b16 a[192:193], v16 offset:16384
    s_waitcnt lgkmcnt(11)
    ds_read_b64_tr_b16 a[194:195], v16 offset:18432
    s_waitcnt lgkmcnt(11)
    ds_read_b64_tr_b16 a[196:197], v17 offset:16384
    s_waitcnt lgkmcnt(11)
    ds_read_b64_tr_b16 a[198:199], v17 offset:18432
    s_waitcnt lgkmcnt(11)
    ds_read_b64_tr_b16 a[200:201], v18 offset:16384
    s_waitcnt lgkmcnt(11)
    ds_read_b64_tr_b16 a[202:203], v18 offset:18432
    s_waitcnt lgkmcnt(11)
    ds_read_b64_tr_b16 a[204:205], v19 offset:16384
    s_waitcnt lgkmcnt(11)
    ds_read_b64_tr_b16 a[206:207], v19 offset:18432
    s_waitcnt lgkmcnt(11)
    ds_read_b64_tr_b16 a[208:209], v16 offset:20480
    s_waitcnt lgkmcnt(11)
    ds_read_b64_tr_b16 a[210:211], v16 offset:22528
    s_waitcnt lgkmcnt(11)
    ds_read_b64_tr_b16 a[212:213], v17 offset:20480
    s_waitcnt lgkmcnt(11)
    ds_read_b64_tr_b16 a[214:215], v17 offset:22528
    s_waitcnt lgkmcnt(11)
    ds_read_b64_tr_b16 a[216:217], v18 offset:20480
    s_waitcnt lgkmcnt(11)
    ds_read_b64_tr_b16 a[218:219], v18 offset:22528
    s_waitcnt lgkmcnt(11)
    ds_read_b64_tr_b16 a[220:221], v19 offset:20480
    s_waitcnt lgkmcnt(11)
    ds_read_b64_tr_b16 a[222:223], v19 offset:22528
    s_waitcnt lgkmcnt(11)
    ds_read_b64_tr_b16 a[224:225], v16 offset:24576
    s_waitcnt lgkmcnt(11)
    ds_read_b64_tr_b16 a[226:227], v16 offset:26624
    s_waitcnt lgkmcnt(11)
    ds_read_b64_tr_b16 a[228:229], v17 offset:24576
    s_waitcnt lgkmcnt(11)
    ds_read_b64_tr_b16 a[230:231], v17 offset:26624
    s_waitcnt lgkmcnt(11)
    ds_read_b64_tr_b16 a[232:233], v18 offset:24576
    s_waitcnt lgkmcnt(11)
    ds_read_b64_tr_b16 a[234:235], v18 offset:26624
    s_waitcnt lgkmcnt(11)
    ds_read_b64_tr_b16 a[236:237], v19 offset:24576
    s_waitcnt lgkmcnt(11)
    ds_read_b64_tr_b16 a[238:239], v19 offset:26624
    s_waitcnt lgkmcnt(11)
    ds_read_b64_tr_b16 a[240:241], v16 offset:28672
    s_waitcnt lgkmcnt(11)
    ds_read_b64_tr_b16 a[242:243], v16 offset:30720
    s_waitcnt lgkmcnt(11)
    ds_read_b64_tr_b16 a[244:245], v17 offset:28672
    s_waitcnt lgkmcnt(11)
    ds_read_b64_tr_b16 a[246:247], v17 offset:30720
    s_waitcnt lgkmcnt(11)
    ds_read_b64_tr_b16 a[248:249], v18 offset:28672
    s_waitcnt lgkmcnt(11)
    ds_read_b64_tr_b16 a[250:251], v18 offset:30720
    s_waitcnt lgkmcnt(11)
    ds_read_b64_tr_b16 a[252:253], v19 offset:28672
    s_waitcnt lgkmcnt(11)
    ds_read_b64_tr_b16 a[254:255], v19 offset:30720
    s_waitcnt lgkmcnt(11)
    s_waitcnt lgkmcnt(0)
    v_lshrrev_b32 v4, 2, v1
    v_and_b32 v4, 3, v4
    v_and_b32 v5, 1, v3
    v_lshlrev_b32 v5, 1, v5
    v_lshrrev_b32 v6, 1, v4
    v_or_b32 v5, v5, v6
    v_lshl_add_u32 v6, v3, 2, v4
    v_lshlrev_b32 v6, 7, v6
    v_and_b32 v7, 3, v1
    v_lshl_add_u32 v6, v7, 3, v6
    v_xor_b32 v7, 0, v5
    v_lshl_add_u32 v16, v7, 5, v6
    v_xor_b32 v7, 1, v5
    v_lshl_add_u32 v17, v7, 5, v6
    v_xor_b32 v7, 2, v5
    v_lshl_add_u32 v18, v7, 5, v6
    v_xor_b32 v7, 3, v5
    v_lshl_add_u32 v19, v7, 5, v6
    s_cmp_lg_u32 s48, 0
    s_cbranch_scc1 L_wait_7
    s_mov_b32 s60, 400000
L_poll_8:
    buffer_load_dword v12, v184, s[40:43], 0 offen sc1
    s_waitcnt vmcnt(0)
    v_cmp_ne_u32 vcc, 0, v12
    s_nop 3
    s_cmp_eq_u64 vcc, -1
    s_cbranch_scc1 L_pout_9
    s_sub_u32 s60, s60, 1
    s_cmp_eq_u32 s60, 0
    s_cbranch_scc1 L_pout_9
    s_branch L_poll_8
L_pout_9:
L_wait_7:
    s_barrier
    buffer_load_dwordx4 a[0:3], v176, s[32:35], 0 offen offset:0 sc1
    buffer_load_dwordx4 a[4:7], v177, s[32:35], 0 offen offset:0 sc1
    buffer_load_dwordx4 a[8:11], v176, s[32:35], 0 offen offset:1024 sc1
    buffer_load_dwordx4 a[12:15], v177, s[32:35], 0 offen offset:1024 sc1
    buffer_load_dwordx4 a[16:19], v176, s[32:35], 0 offen offset:2048 sc1
    buffer_load_dwordx4 a[20:23], v177, s[32:35], 0 offen offset:2048 sc1
    buffer_load_dwordx4 a[24:27], v176, s[32:35], 0 offen offset:3072 sc1
    buffer_load_dwordx4 a[28:31], v177, s[32:35], 0 offen offset:3072 sc1
    buffer_load_dwordx4 a[32:35], v178, s[32:35], 0 offen offset:0 sc1
    buffer_load_dwordx4 a[36:39], v179, s[32:35], 0 offen offset:0 sc1
    buffer_load_dwordx4 a[40:43], v178, s[32:35], 0 offen offset:1024 sc1
    buffer_load_dwordx4 a[44:47], v179, s[32:35], 0 offen offset:1024 sc1
    buffer_load_dwordx4 a[48:51], v178, s[32:35], 0 offen offset:2048 sc1
    buffer_load_dwordx4 a[52:55], v179, s[32:35], 0 offen offset:2048 sc1
    buffer_load_dwordx4 a[56:59], v178, s[32:35], 0 offen offset:3072 sc1
    buffer_load_dwordx4 a[60:63], v179, s[32:35], 0 offen offset:3072 sc1
    ds_read_b64_tr_b16 v[28:29], v16 offset:0
    ds_read_b64_tr_b16 v[30:31], v16 offset:2048
    ds_read_b64_tr_b16 v[32:33], v17 offset:0
    ds_read_b64_tr_b16 v[34:35], v17 offset:2048
    ds_read_b64_tr_b16 v[36:37], v18 offset:0
    ds_read_b64_tr_b16 v[38:39], v18 offset:2048
    ds_read_b64_tr_b16 v[40:41], v19 offset:0
    ds_read_b64_tr_b16 v[42:43], v19 offset:2048
    ds_read_b64_tr_b16 v[44:45], v16 offset:4096
    ds_read_b64_tr_b16 v[46:47], v16 offset:6144
    s_waitcnt vmcnt(14)
    s_waitcnt lgkmcnt(8)
    v_mfma_f32_16x16x32_bf16 v[52:55], v[28:31], a[0:3], 0
    ds_read_b64_tr_b16 v[48:49], v17 offset:4096
    v_mfma_f32_16x16x32_bf16 v[68:71], v[28:31], a[4:7], 0
    ds_read_b64_tr_b16 v[50:51], v17 offset:6144
    buffer_load_dwordx4 a[64:67], v180, s[32:35], 0 offen offset:0 sc1
    buffer_load_dwordx4 a[68:71], v181, s[32:35], 0 offen offset:0 sc1
    s_waitcnt lgkmcnt(8)
    v_mfma_f32_16x16x32_bf16 v[56:59], v[32:35], a[0:3], 0
    ds_read_b64_tr_b16 v[28:29], v18 offset:4096
    v_mfma_f32_16x16x32_bf16 v[72:75], v[32:35], a[4:7], 0
    ds_read_b64_tr_b16 v[30:31], v18 offset:6144
    s_waitcnt lgkmcnt(8)
    v_mfma_f32_16x16x32_bf16 v[60:63], v[36:39], a[0:3], 0
    ds_read_b64_tr_b16 v[32:33], v19 offset:4096
    v_mfma_f32_16x16x32_bf16 v[76:79], v[36:39], a[4:7], 0
    ds_read_b64_tr_b16 v[34:35], v19 offset:6144
    s_waitcnt lgkmcnt(8)
    v_mfma_f32_16x16x32_bf16 v[64:67], v[40:43], a[0:3], 0
    ds_read_b64_tr_b16 v[36:37], v16 offset:8192
    v_mfma_f32_16x16x32_bf16 v[80:83], v[40:43], a[4:7], 0
    ds_read_b64_tr_b16 v[38:39], v16 offset:10240
    s_waitcnt vmcnt(14)
    s_waitcnt lgkmcnt(8)
    v_mfma_f32_16x16x32_bf16 v[52:55], v[44:47], a[8:11], v[52:55]
    ds_read_b64_tr_b16 v[40:41], v17 offset:8192
    v_mfma_f32_16x16x32_bf16 v[68:71], v[44:47], a[12:15], v[68:71]
    ds_read_b64_tr_b16 v[42:43], v17 offset:10240
    buffer_load_dwordx4 a[72:75], v180, s[32:35], 0 offen offset:1024 sc1
    buffer_load_dwordx4 a[76:79], v181, s[32:35], 0 offen offset:1024 sc1
    s_waitcnt lgkmcnt(8)
    v_mfma_f32_16x16x32_bf16 v[56:59], v[48:51], a[8:11], v[56:59]
    ds_read_b64_tr_b16 v[44:45], v18 offset:8192
    v_mfma_f32_16x16x32_bf16 v[72:75], v[48:51], a[12:15], v[72:75]
    ds_read_b64_tr_b16 v[46:47], v18 offset:10240
    s_waitcnt lgkmcnt(8)
    v_mfma_f32_16x16x32_bf16 v[60:63], v[28:31], a[8:11], v[60:63]
    ds_read_b64_tr_b16 v[48:49], v19 offset:8192
    v_mfma_f32_16x16x32_bf16 v[76:79], v[28:31], a[12:15], v[76:79]
    ds_read_b64_tr_b16 v[50:51], v19 offset:10240
    s_waitcnt lgkmcnt(8)
    v_mfma_f32_16x16x32_bf16 v[64:67], v[32:35], a[8:11], v[64:67]
    ds_read_b64_tr_b16 v[28:29], v16 offset:12288
    v_mfma_f32_16x16x32_bf16 v[80:83], v[32:35], a[12:15], v[80:83]
    ds_read_b64_tr_b16 v[30:31], v16 offset:14336
    s_waitcnt vmcnt(14)
    s_waitcnt lgkmcnt(8)
    v_mfma_f32_16x16x32_bf16 v[52:55], v[36:39], a[16:19], v[52:55]
    ds_read_b64_tr_b16 v[32:33], v17 offset:12288
    v_mfma_f32_16x16x32_bf16 v[68:71], v[36:39], a[20:23], v[68:71]
    ds_read_b64_tr_b16 v[34:35], v17 offset:14336
    buffer_load_dwordx4 a[80:83], v180, s[32:35], 0 offen offset:2048 sc1
    buffer_load_dwordx4 a[84:87], v181, s[32:35], 0 offen offset:2048 sc1
    s_waitcnt lgkmcnt(8)
    v_mfma_f32_16x16x32_bf16 v[56:59], v[40:43], a[16:19], v[56:59]
    ds_read_b64_tr_b16 v[36:37], v18 offset:12288
    v_mfma_f32_16x16x32_bf16 v[72:75], v[40:43], a[20:23], v[72:75]
    ds_read_b64_tr_b16 v[38:39], v18 offset:14336
    s_waitcnt lgkmcnt(8)
    v_mfma_f32_16x16x32_bf16 v[60:63], v[44:47], a[16:19], v[60:63]
    ds_read_b64_tr_b16 v[40:41], v19 offset:12288
    v_mfma_f32_16x16x32_bf16 v[76:79], v[44:47], a[20:23], v[76:79]
    ds_read_b64_tr_b16 v[42:43], v19 offset:14336
    s_waitcnt lgkmcnt(8)
    v_mfma_f32_16x16x32_bf16 v[64:67], v[48:51], a[16:19], v[64:67]
    ds_read_b64_tr_b16 v[44:45], v16 offset:16384
    v_mfma_f32_16x16x32_bf16 v[80:83], v[48:51], a[20:23], v[80:83]
    ds_read_b64_tr_b16 v[46:47], v16 offset:18432
    s_waitcnt vmcnt(14)
    s_waitcnt lgkmcnt(8)
    v_mfma_f32_16x16x32_bf16 v[52:55], v[28:31], a[24:27], v[52:55]
    ds_read_b64_tr_b16 v[48:49], v17 offset:16384
    v_mfma_f32_16x16x32_bf16 v[68:71], v[28:31], a[28:31], v[68:71]
    ds_read_b64_tr_b16 v[50:51], v17 offset:18432
    buffer_load_dwordx4 a[88:91], v180, s[32:35], 0 offen offset:3072 sc1
    buffer_load_dwordx4 a[92:95], v181, s[32:35], 0 offen offset:3072 sc1
    s_waitcnt lgkmcnt(8)
    v_mfma_f32_16x16x32_bf16 v[56:59], v[32:35], a[24:27], v[56:59]
    ds_read_b64_tr_b16 v[28:29], v18 offset:16384
    v_mfma_f32_16x16x32_bf16 v[72:75], v[32:35], a[28:31], v[72:75]
    ds_read_b64_tr_b16 v[30:31], v18 offset:18432
    s_waitcnt lgkmcnt(8)
    v_mfma_f32_16x16x32_bf16 v[60:63], v[36:39], a[24:27], v[60:63]
    ds_read_b64_tr_b16 v[32:33], v19 offset:16384
    v_mfma_f32_16x16x32_bf16 v[76:79], v[36:39], a[28:31], v[76:79]
    ds_read_b64_tr_b16 v[34:35], v19 offset:18432
    s_waitcnt lgkmcnt(8)
    v_mfma_f32_16x16x32_bf16 v[64:67], v[40:43], a[24:27], v[64:67]
    ds_read_b64_tr_b16 v[36:37], v16 offset:20480
    v_mfma_f32_16x16x32_bf16 v[80:83], v[40:43], a[28:31], v[80:83]
    ds_read_b64_tr_b16 v[38:39], v16 offset:22528
    s_waitcnt vmcnt(14)
    s_waitcnt lgkmcnt(8)
    v_mfma_f32_16x16x32_bf16 v[52:55], v[44:47], a[32:35], v[52:55]
    ds_read_b64_tr_b16 v[40:41], v17 offset:20480
    v_mfma_f32_16x16x32_bf16 v[68:71], v[44:47], a[36:39], v[68:71]
    ds_read_b64_tr_b16 v[42:43], v17 offset:22528
    buffer_load_dwordx4 a[96:99], v182, s[32:35], 0 offen offset:0 sc1
    buffer_load_dwordx4 a[100:103], v183, s[32:35], 0 offen offset:0 sc1
    s_waitcnt lgkmcnt(8)
    v_mfma_f32_16x16x32_bf16 v[56:59], v[48:51], a[32:35], v[56:59]
    ds_read_b64_tr_b16 v[44:45], v18 offset:20480
    v_mfma_f32_16x16x32_bf16 v[72:75], v[48:51], a[36:39], v[72:75]
    ds_read_b64_tr_b16 v[46:47], v18 offset:22528
    s_waitcnt lgkmcnt(8)
    v_mfma_f32_16x16x32_bf16 v[60:63], v[28:31], a[32:35], v[60:63]
    ds_read_b64_tr_b16 v[48:49], v19 offset:20480
    v_mfma_f32_16x16x32_bf16 v[76:79], v[28:31], a[36:39], v[76:79]
    ds_read_b64_tr_b16 v[50:51], v19 offset:22528
    s_waitcnt lgkmcnt(8)
    v_mfma_f32_16x16x32_bf16 v[64:67], v[32:35], a[32:35], v[64:67]
    ds_read_b64_tr_b16 v[28:29], v16 offset:24576
    v_mfma_f32_16x16x32_bf16 v[80:83], v[32:35], a[36:39], v[80:83]
    ds_read_b64_tr_b16 v[30:31], v16 offset:26624
    s_waitcnt vmcnt(14)
    s_waitcnt lgkmcnt(8)
    v_mfma_f32_16x16x32_bf16 v[52:55], v[36:39], a[40:43], v[52:55]
    ds_read_b64_tr_b16 v[32:33], v17 offset:24576
    v_mfma_f32_16x16x32_bf16 v[68:71], v[36:39], a[44:47], v[68:71]
    ds_read_b64_tr_b16 v[34:35], v17 offset:26624
    buffer_load_dwordx4 a[104:107], v182, s[32:35], 0 offen offset:1024 sc1
    buffer_load_dwordx4 a[108:111], v183, s[32:35], 0 offen offset:1024 sc1
    s_waitcnt lgkmcnt(8)
    v_mfma_f32_16x16x32_bf16 v[56:59], v[40:43], a[40:43], v[56:59]
    ds_read_b64_tr_b16 v[36:37], v18 offset:24576
    v_mfma_f32_16x16x32_bf16 v[72:75], v[40:43], a[44:47], v[72:75]
    ds_read_b64_tr_b16 v[38:39], v18 offset:26624
    s_waitcnt lgkmcnt(8)
    v_mfma_f32_16x16x32_bf16 v[60:63], v[44:47], a[40:43], v[60:63]
    ds_read_b64_tr_b16 v[40:41], v19 offset:24576
    v_mfma_f32_16x16x32_bf16 v[76:79], v[44:47], a[44:47], v[76:79]
    ds_read_b64_tr_b16 v[42:43], v19 offset:26624
    s_waitcnt lgkmcnt(8)
    v_mfma_f32_16x16x32_bf16 v[64:67], v[48:51], a[40:43], v[64:67]
    ds_read_b64_tr_b16 v[44:45], v16 offset:28672
    v_mfma_f32_16x16x32_bf16 v[80:83], v[48:51], a[44:47], v[80:83]
    ds_read_b64_tr_b16 v[46:47], v16 offset:30720
    s_waitcnt vmcnt(14)
    s_waitcnt lgkmcnt(8)
    v_mfma_f32_16x16x32_bf16 v[52:55], v[28:31], a[48:51], v[52:55]
    ds_read_b64_tr_b16 v[48:49], v17 offset:28672
    v_mfma_f32_16x16x32_bf16 v[68:71], v[28:31], a[52:55], v[68:71]
    ds_read_b64_tr_b16 v[50:51], v17 offset:30720
    buffer_load_dwordx4 a[112:115], v182, s[32:35], 0 offen offset:2048 sc1
    buffer_load_dwordx4 a[116:119], v183, s[32:35], 0 offen offset:2048 sc1
    s_waitcnt lgkmcnt(8)
    v_mfma_f32_16x16x32_bf16 v[56:59], v[32:35], a[48:51], v[56:59]
    ds_read_b64_tr_b16 v[28:29], v18 offset:28672
    v_mfma_f32_16x16x32_bf16 v[72:75], v[32:35], a[52:55], v[72:75]
    ds_read_b64_tr_b16 v[30:31], v18 offset:30720
    s_waitcnt lgkmcnt(8)
    v_mfma_f32_16x16x32_bf16 v[60:63], v[36:39], a[48:51], v[60:63]
    ds_read_b64_tr_b16 v[32:33], v19 offset:28672
    v_mfma_f32_16x16x32_bf16 v[76:79], v[36:39], a[52:55], v[76:79]
    ds_read_b64_tr_b16 v[34:35], v19 offset:30720
    s_waitcnt lgkmcnt(8)
    v_mfma_f32_16x16x32_bf16 v[64:67], v[40:43], a[48:51], v[64:67]
    ds_read_b64_tr_b16 v[36:37], v16 offset:32768
    v_mfma_f32_16x16x32_bf16 v[80:83], v[40:43], a[52:55], v[80:83]
    ds_read_b64_tr_b16 v[38:39], v16 offset:34816
    s_waitcnt vmcnt(14)
    s_waitcnt lgkmcnt(8)
    v_mfma_f32_16x16x32_bf16 v[52:55], v[44:47], a[56:59], v[52:55]
    ds_read_b64_tr_b16 v[40:41], v17 offset:32768
    v_mfma_f32_16x16x32_bf16 v[68:71], v[44:47], a[60:63], v[68:71]
    ds_read_b64_tr_b16 v[42:43], v17 offset:34816
    buffer_load_dwordx4 a[120:123], v182, s[32:35], 0 offen offset:3072 sc1
    buffer_load_dwordx4 a[124:127], v183, s[32:35], 0 offen offset:3072 sc1
    s_waitcnt lgkmcnt(8)
    v_mfma_f32_16x16x32_bf16 v[56:59], v[48:51], a[56:59], v[56:59]
    ds_read_b64_tr_b16 v[44:45], v18 offset:32768
    v_mfma_f32_16x16x32_bf16 v[72:75], v[48:51], a[60:63], v[72:75]
    ds_read_b64_tr_b16 v[46:47], v18 offset:34816
    s_waitcnt lgkmcnt(8)
    v_mfma_f32_16x16x32_bf16 v[60:63], v[28:31], a[56:59], v[60:63]
    ds_read_b64_tr_b16 v[48:49], v19 offset:32768
    v_mfma_f32_16x16x32_bf16 v[76:79], v[28:31], a[60:63], v[76:79]
    ds_read_b64_tr_b16 v[50:51], v19 offset:34816
    s_waitcnt lgkmcnt(8)
    v_mfma_f32_16x16x32_bf16 v[64:67], v[32:35], a[56:59], v[64:67]
    ds_read_b64_tr_b16 v[28:29], v16 offset:36864
    v_mfma_f32_16x16x32_bf16 v[80:83], v[32:35], a[60:63], v[80:83]
    ds_read_b64_tr_b16 v[30:31], v16 offset:38912
    s_waitcnt vmcnt(14)
    s_waitcnt lgkmcnt(8)
    v_mfma_f32_16x16x32_bf16 v[52:55], v[36:39], a[64:67], v[52:55]
    ds_read_b64_tr_b16 v[32:33], v17 offset:36864
    v_mfma_f32_16x16x32_bf16 v[68:71], v[36:39], a[68:71], v[68:71]
    ds_read_b64_tr_b16 v[34:35], v17 offset:38912
    s_waitcnt lgkmcnt(8)
    v_mfma_f32_16x16x32_bf16 v[56:59], v[40:43], a[64:67], v[56:59]
    ds_read_b64_tr_b16 v[36:37], v18 offset:36864
    v_mfma_f32_16x16x32_bf16 v[72:75], v[40:43], a[68:71], v[72:75]
    ds_read_b64_tr_b16 v[38:39], v18 offset:38912
    s_waitcnt lgkmcnt(8)
    v_mfma_f32_16x16x32_bf16 v[60:63], v[44:47], a[64:67], v[60:63]
    ds_read_b64_tr_b16 v[40:41], v19 offset:36864
    v_mfma_f32_16x16x32_bf16 v[76:79], v[44:47], a[68:71], v[76:79]
    ds_read_b64_tr_b16 v[42:43], v19 offset:38912
    s_waitcnt lgkmcnt(8)
    v_mfma_f32_16x16x32_bf16 v[64:67], v[48:51], a[64:67], v[64:67]
    ds_read_b64_tr_b16 v[44:45], v16 offset:40960
    v_mfma_f32_16x16x32_bf16 v[80:83], v[48:51], a[68:71], v[80:83]
    ds_read_b64_tr_b16 v[46:47], v16 offset:43008
    s_waitcnt vmcnt(12)
    s_waitcnt lgkmcnt(8)
    v_mfma_f32_16x16x32_bf16 v[52:55], v[28:31], a[72:75], v[52:55]
    ds_read_b64_tr_b16 v[48:49], v17 offset:40960
    v_mfma_f32_16x16x32_bf16 v[68:71], v[28:31], a[76:79], v[68:71]
    ds_read_b64_tr_b16 v[50:51], v17 offset:43008
    s_waitcnt lgkmcnt(8)
    v_mfma_f32_16x16x32_bf16 v[56:59], v[32:35], a[72:75], v[56:59]
    ds_read_b64_tr_b16 v[28:29], v18 offset:40960
    v_mfma_f32_16x16x32_bf16 v[72:75], v[32:35], a[76:79], v[72:75]
    ds_read_b64_tr_b16 v[30:31], v18 offset:43008
    s_waitcnt lgkmcnt(8)
    v_mfma_f32_16x16x32_bf16 v[60:63], v[36:39], a[72:75], v[60:63]
    ds_read_b64_tr_b16 v[32:33], v19 offset:40960
    v_mfma_f32_16x16x32_bf16 v[76:79], v[36:39], a[76:79], v[76:79]
    ds_read_b64_tr_b16 v[34:35], v19 offset:43008
    s_waitcnt lgkmcnt(8)
    v_mfma_f32_16x16x32_bf16 v[64:67], v[40:43], a[72:75], v[64:67]
    ds_read_b64_tr_b16 v[36:37], v16 offset:45056
    v_mfma_f32_16x16x32_bf16 v[80:83], v[40:43], a[76:79], v[80:83]
    ds_read_b64_tr_b16 v[38:39], v16 offset:47104
    s_waitcnt vmcnt(10)
    s_waitcnt lgkmcnt(8)
    v_mfma_f32_16x16x32_bf16 v[52:55], v[44:47], a[80:83], v[52:55]
    ds_read_b64_tr_b16 v[40:41], v17 offset:45056
    v_mfma_f32_16x16x32_bf16 v[68:71], v[44:47], a[84:87], v[68:71]
    ds_read_b64_tr_b16 v[42:43], v17 offset:47104
    s_waitcnt lgkmcnt(8)
    v_mfma_f32_16x16x32_bf16 v[56:59], v[48:51], a[80:83], v[56:59]
    ds_read_b64_tr_b16 v[44:45], v18 offset:45056
    v_mfma_f32_16x16x32_bf16 v[72:75], v[48:51], a[84:87], v[72:75]
    ds_read_b64_tr_b16 v[46:47], v18 offset:47104
    s_waitcnt lgkmcnt(8)
    v_mfma_f32_16x16x32_bf16 v[60:63], v[28:31], a[80:83], v[60:63]
    ds_read_b64_tr_b16 v[48:49], v19 offset:45056
    v_mfma_f32_16x16x32_bf16 v[76:79], v[28:31], a[84:87], v[76:79]
    ds_read_b64_tr_b16 v[50:51], v19 offset:47104
    s_waitcnt lgkmcnt(8)
    v_mfma_f32_16x16x32_bf16 v[64:67], v[32:35], a[80:83], v[64:67]
    ds_read_b64_tr_b16 v[28:29], v16 offset:49152
    v_mfma_f32_16x16x32_bf16 v[80:83], v[32:35], a[84:87], v[80:83]
    ds_read_b64_tr_b16 v[30:31], v16 offset:51200
    s_waitcnt vmcnt(8)
    s_waitcnt lgkmcnt(8)
    v_mfma_f32_16x16x32_bf16 v[52:55], v[36:39], a[88:91], v[52:55]
    ds_read_b64_tr_b16 v[32:33], v17 offset:49152
    v_mfma_f32_16x16x32_bf16 v[68:71], v[36:39], a[92:95], v[68:71]
    ds_read_b64_tr_b16 v[34:35], v17 offset:51200
    s_waitcnt lgkmcnt(8)
    v_mfma_f32_16x16x32_bf16 v[56:59], v[40:43], a[88:91], v[56:59]
    ds_read_b64_tr_b16 v[36:37], v18 offset:49152
    v_mfma_f32_16x16x32_bf16 v[72:75], v[40:43], a[92:95], v[72:75]
    ds_read_b64_tr_b16 v[38:39], v18 offset:51200
    s_waitcnt lgkmcnt(8)
    v_mfma_f32_16x16x32_bf16 v[60:63], v[44:47], a[88:91], v[60:63]
    ds_read_b64_tr_b16 v[40:41], v19 offset:49152
    v_mfma_f32_16x16x32_bf16 v[76:79], v[44:47], a[92:95], v[76:79]
    ds_read_b64_tr_b16 v[42:43], v19 offset:51200
    s_waitcnt lgkmcnt(8)
    v_mfma_f32_16x16x32_bf16 v[64:67], v[48:51], a[88:91], v[64:67]
    ds_read_b64_tr_b16 v[44:45], v16 offset:53248
    v_mfma_f32_16x16x32_bf16 v[80:83], v[48:51], a[92:95], v[80:83]
    ds_read_b64_tr_b16 v[46:47], v16 offset:55296
    s_waitcnt vmcnt(6)
    s_waitcnt lgkmcnt(8)
    v_mfma_f32_16x16x32_bf16 v[52:55], v[28:31], a[96:99], v[52:55]
    ds_read_b64_tr_b16 v[48:49], v17 offset:53248
    v_mfma_f32_16x16x32_bf16 v[68:71], v[28:31], a[100:103], v[68:71]
    ds_read_b64_tr_b16 v[50:51], v17 offset:55296
    s_waitcnt lgkmcnt(8)
    v_mfma_f32_16x16x32_bf16 v[56:59], v[32:35], a[96:99], v[56:59]
    ds_read_b64_tr_b16 v[28:29], v18 offset:53248
    v_mfma_f32_16x16x32_bf16 v[72:75], v[32:35], a[100:103], v[72:75]
    ds_read_b64_tr_b16 v[30:31], v18 offset:55296
    s_waitcnt lgkmcnt(8)
    v_mfma_f32_16x16x32_bf16 v[60:63], v[36:39], a[96:99], v[60:63]
    ds_read_b64_tr_b16 v[32:33], v19 offset:53248
    v_mfma_f32_16x16x32_bf16 v[76:79], v[36:39], a[100:103], v[76:79]
    ds_read_b64_tr_b16 v[34:35], v19 offset:55296
    s_waitcnt lgkmcnt(8)
    v_mfma_f32_16x16x32_bf16 v[64:67], v[40:43], a[96:99], v[64:67]
    ds_read_b64_tr_b16 v[36:37], v16 offset:57344
    v_mfma_f32_16x16x32_bf16 v[80:83], v[40:43], a[100:103], v[80:83]
    ds_read_b64_tr_b16 v[38:39], v16 offset:59392
    s_waitcnt vmcnt(4)
    s_waitcnt lgkmcnt(8)
    v_mfma_f32_16x16x32_bf16 v[52:55], v[44:47], a[104:107], v[52:55]
    ds_read_b64_tr_b16 v[40:41], v17 offset:57344
    v_mfma_f32_16x16x32_bf16 v[68:71], v[44:47], a[108:111], v[68:71]
    ds_read_b64_tr_b16 v[42:43], v17 offset:59392
    s_waitcnt lgkmcnt(8)
    v_mfma_f32_16x16x32_bf16 v[56:59], v[48:51], a[104:107], v[56:59]
    ds_read_b64_tr_b16 v[44:45], v18 offset:57344
    v_mfma_f32_16x16x32_bf16 v[72:75], v[48:51], a[108:111], v[72:75]
    ds_read_b64_tr_b16 v[46:47], v18 offset:59392
    s_waitcnt lgkmcnt(8)
    v_mfma_f32_16x16x32_bf16 v[60:63], v[28:31], a[104:107], v[60:63]
    ds_read_b64_tr_b16 v[48:49], v19 offset:57344
    v_mfma_f32_16x16x32_bf16 v[76:79], v[28:31], a[108:111], v[76:79]
    ds_read_b64_tr_b16 v[50:51], v19 offset:59392
    s_waitcnt lgkmcnt(8)
    v_mfma_f32_16x16x32_bf16 v[64:67], v[32:35], a[104:107], v[64:67]
    ds_read_b64_tr_b16 v[28:29], v16 offset:61440
    v_mfma_f32_16x16x32_bf16 v[80:83], v[32:35], a[108:111], v[80:83]
    ds_read_b64_tr_b16 v[30:31], v16 offset:63488
    s_waitcnt vmcnt(2)
    s_waitcnt lgkmcnt(8)
    v_mfma_f32_16x16x32_bf16 v[52:55], v[36:39], a[112:115], v[52:55]
    ds_read_b64_tr_b16 v[32:33], v17 offset:61440
    v_mfma_f32_16x16x32_bf16 v[68:71], v[36:39], a[116:119], v[68:71]
    ds_read_b64_tr_b16 v[34:35], v17 offset:63488
    s_waitcnt lgkmcnt(8)
    v_mfma_f32_16x16x32_bf16 v[56:59], v[40:43], a[112:115], v[56:59]
    ds_read_b64_tr_b16 v[36:37], v18 offset:61440
    v_mfma_f32_16x16x32_bf16 v[72:75], v[40:43], a[116:119], v[72:75]
    ds_read_b64_tr_b16 v[38:39], v18 offset:63488
    s_waitcnt lgkmcnt(8)
    v_mfma_f32_16x16x32_bf16 v[60:63], v[44:47], a[112:115], v[60:63]
    ds_read_b64_tr_b16 v[40:41], v19 offset:61440
    v_mfma_f32_16x16x32_bf16 v[76:79], v[44:47], a[116:119], v[76:79]
    ds_read_b64_tr_b16 v[42:43], v19 offset:63488
    s_waitcnt lgkmcnt(8)
    v_mfma_f32_16x16x32_bf16 v[64:67], v[48:51], a[112:115], v[64:67]
    v_mfma_f32_16x16x32_bf16 v[80:83], v[48:51], a[116:119], v[80:83]
    s_waitcnt vmcnt(0)
    s_waitcnt lgkmcnt(6)
    v_mfma_f32_16x16x32_bf16 v[52:55], v[28:31], a[120:123], v[52:55]
    v_mfma_f32_16x16x32_bf16 v[68:71], v[28:31], a[124:127], v[68:71]
    s_waitcnt lgkmcnt(4)
    v_mfma_f32_16x16x32_bf16 v[56:59], v[32:35], a[120:123], v[56:59]
    v_mfma_f32_16x16x32_bf16 v[72:75], v[32:35], a[124:127], v[72:75]
    s_waitcnt lgkmcnt(2)
    v_mfma_f32_16x16x32_bf16 v[60:63], v[36:39], a[120:123], v[60:63]
    v_mfma_f32_16x16x32_bf16 v[76:79], v[36:39], a[124:127], v[76:79]
    s_waitcnt lgkmcnt(0)
    v_mfma_f32_16x16x32_bf16 v[64:67], v[40:43], a[120:123], v[64:67]
    v_mfma_f32_16x16x32_bf16 v[80:83], v[40:43], a[124:127], v[80:83]
    s_mov_b32 s36, s20
    s_and_b32 s37, s21, 0xffff
    s_mov_b32 s38, 0x1c0000
    s_mov_b32 s39, 0x20000
    v_add_u32 v4, 0, v1
    v_mul_u32_u24 v5, 4682, v4
    v_lshrrev_b32 v5, 16, v5
    v_mul_u32_u24 v6, 14, v5
    v_sub_u32 v6, v4, v6
    v_mul_u32_u24 v5, 3584, v5
    v_lshl_add_u32 v5, v6, 4, v5
    v_subrev_u32 v20, 0, v5
    v_add_u32 v4, 64, v1
    v_mul_u32_u24 v5, 4682, v4
    v_lshrrev_b32 v5, 16, v5
    v_mul_u32_u24 v6, 14, v5
    v_sub_u32 v6, v4, v6
    v_mul_u32_u24 v5, 3584, v5
    v_lshl_add_u32 v5, v6, 4, v5
    v_subrev_u32 v21, 1024, v5
    v_add_u32 v4, 128, v1
    v_mul_u32_u24 v5, 4682, v4
    v_lshrrev_b32 v5, 16, v5
    v_mul_u32_u24 v6, 14, v5
    v_sub_u32 v6, v4, v6
    v_mul_u32_u24 v5, 3584, v5
    v_lshl_add_u32 v5, v6, 4, v5
    v_subrev_u32 v22, 2048, v5
    v_add_u32 v4, 192, v1
    v_mul_u32_u24 v5, 4682, v4
    v_lshrrev_b32 v5, 16, v5
    v_mul_u32_u24 v6, 14, v5
    v_sub_u32 v6, v4, v6
    v_mul_u32_u24 v5, 3584, v5
    v_lshl_add_u32 v5, v6, 4, v5
    v_subrev_u32 v23, 3072, v5
    v_add_u32 v4, 256, v1
    v_mul_u32_u24 v5, 4682, v4
    v_lshrrev_b32 v5, 16, v5
    v_mul_u32_u24 v6, 14, v5
    v_sub_u32 v6, v4, v6
    v_mul_u32_u24 v5, 3584, v5
    v_lshl_add_u32 v5, v6, 4, v5
    v_subrev_u32 v24, 0, v5
    v_add_u32 v4, 320, v1
    v_mul_u32_u24 v5, 4682, v4
    v_lshrrev_b32 v5, 16, v5
    v_mul_u32_u24 v6, 14, v5
    v_sub_u32 v6, v4, v6
    v_mul_u32_u24 v5, 3584, v5
    v_lshl_add_u32 v5, v6, 4, v5
    v_subrev_u32 v25, 1024, v5
    v_add_u32 v4, 384, v1
    v_mul_u32_u24 v5, 4682, v4
    v_lshrrev_b32 v5, 16, v5
    v_mul_u32_u24 v6, 14, v5
    v_sub_u32 v6, v4, v6
    v_mul_u32_u24 v5, 3584, v5
    v_lshl_add_u32 v5, v6, 4, v5
    v_subrev_u32 v26, 2048, v5
    s_mul_i32 s64, s51, 224
    s_mul_i32 s52, s48, 114688
    s_add_u32 s64, s64, s52
    s_mul_i32 s66, s48, 7168
    s_lshl_b32 s52, s67, 14
    s_lshl_b32 s53, s77, 11
    s_add_u32 s52, s52, s53
    s_add_u32 s56, s52, 4194304
    s_add_u32 s57, s56, 16384
    s_lshl_b32 s58, s67, 7
    s_lshl_b32 s55, s77, 14
    s_add_u32 s58, s58, s55
    s_add_u32 s58, s58, 15859712
    v_lshlrev_b32 v5, 3, v2
    v_lshlrev_b32 v128, 16, v112
    v_and_b32 v129, 0xffff0000, v112
    v_lshlrev_b32 v130, 16, v113
    v_and_b32 v131, 0xffff0000, v113
    v_pk_add_f32 v[52:53], v[52:53], v[128:129]
    v_pk_add_f32 v[54:55], v[54:55], v[130:131]
    v_lshlrev_b32 v128, 16, v114
    v_and_b32 v129, 0xffff0000, v114
    v_lshlrev_b32 v130, 16, v115
    v_and_b32 v131, 0xffff0000, v115
    v_pk_add_f32 v[56:57], v[56:57], v[128:129]
    v_pk_add_f32 v[58:59], v[58:59], v[130:131]
    v_lshlrev_b32 v128, 16, v116
    v_and_b32 v129, 0xffff0000, v116
    v_lshlrev_b32 v130, 16, v117
    v_and_b32 v131, 0xffff0000, v117
    v_pk_add_f32 v[60:61], v[60:61], v[128:129]
    v_pk_add_f32 v[62:63], v[62:63], v[130:131]
    v_lshlrev_b32 v128, 16, v118
    v_and_b32 v129, 0xffff0000, v118
    v_lshlrev_b32 v130, 16, v119
    v_and_b32 v131, 0xffff0000, v119
    v_pk_add_f32 v[64:65], v[64:65], v[128:129]
    v_pk_add_f32 v[66:67], v[66:67], v[130:131]
    v_cvt_pk_bf16_f32 v148, v52, v53
    v_cvt_pk_bf16_f32 v149, v54, v55
    v_cvt_pk_bf16_f32 v150, v56, v57
    v_cvt_pk_bf16_f32 v151, v58, v59
    buffer_store_dwordx4 v[148:151], v27, s[40:43], s56 offen offset:0 sc1
    v_cvt_pk_bf16_f32 v152, v60, v61
    v_cvt_pk_bf16_f32 v153, v62, v63
    v_cvt_pk_bf16_f32 v154, v64, v65
    v_cvt_pk_bf16_f32 v155, v66, v67
    buffer_store_dwordx4 v[152:155], v27, s[40:43], s56 offen offset:1024 sc1
    v_pk_mul_f32 v[146:147], v[52:53], v[52:53]
    v_mov_b32 v144, v52
    v_mov_b32 v145, v53
    v_pk_add_f32 v[144:145], v[144:145], v[54:55]
    v_pk_fma_f32 v[146:147], v[54:55], v[54:55], v[146:147]
    v_pk_add_f32 v[144:145], v[144:145], v[56:57]
    v_pk_fma_f32 v[146:147], v[56:57], v[56:57], v[146:147]
    v_pk_add_f32 v[144:145], v[144:145], v[58:59]
    v_pk_fma_f32 v[146:147], v[58:59], v[58:59], v[146:147]
    v_pk_add_f32 v[144:145], v[144:145], v[60:61]
    v_pk_fma_f32 v[146:147], v[60:61], v[60:61], v[146:147]
    v_pk_add_f32 v[144:145], v[144:145], v[62:63]
    v_pk_fma_f32 v[146:147], v[62:63], v[62:63], v[146:147]
    v_pk_add_f32 v[144:145], v[144:145], v[64:65]
    v_pk_fma_f32 v[146:147], v[64:65], v[64:65], v[146:147]
    v_pk_add_f32 v[144:145], v[144:145], v[66:67]
    v_pk_fma_f32 v[146:147], v[66:67], v[66:67], v[146:147]
    v_add_f32 v168, v144, v145
    v_add_f32 v169, v146, v147
    v_mov_b32 v132, v168
    s_nop 1
    v_permlane16_swap_b32 v168, v132
    v_add_f32 v168, v168, v132
    v_mov_b32 v132, v168
    s_nop 1
    v_permlane32_swap_b32 v168, v132
    v_add_f32 v168, v168, v132
    v_mov_b32 v133, v169
    s_nop 1
    v_permlane16_swap_b32 v169, v133
    v_add_f32 v169, v169, v133
    v_mov_b32 v133, v169
    s_nop 1
    v_permlane32_swap_b32 v169, v133
    v_add_f32 v169, v169, v133
    v_lshlrev_b32 v128, 16, v120
    v_and_b32 v129, 0xffff0000, v120
    v_lshlrev_b32 v130, 16, v121
    v_and_b32 v131, 0xffff0000, v121
    v_pk_add_f32 v[68:69], v[68:69], v[128:129]
    v_pk_add_f32 v[70:71], v[70:71], v[130:131]
    v_lshlrev_b32 v128, 16, v122
    v_and_b32 v129, 0xffff0000, v122
    v_lshlrev_b32 v130, 16, v123
    v_and_b32 v131, 0xffff0000, v123
    v_pk_add_f32 v[72:73], v[72:73], v[128:129]
    v_pk_add_f32 v[74:75], v[74:75], v[130:131]
    v_lshlrev_b32 v128, 16, v124
    v_and_b32 v129, 0xffff0000, v124
    v_lshlrev_b32 v130, 16, v125
    v_and_b32 v131, 0xffff0000, v125
    v_pk_add_f32 v[76:77], v[76:77], v[128:129]
    v_pk_add_f32 v[78:79], v[78:79], v[130:131]
    v_lshlrev_b32 v128, 16, v126
    v_and_b32 v129, 0xffff0000, v126
    v_lshlrev_b32 v130, 16, v127
    v_and_b32 v131, 0xffff0000, v127
    v_pk_add_f32 v[80:81], v[80:81], v[128:129]
    v_pk_add_f32 v[82:83], v[82:83], v[130:131]
    v_cvt_pk_bf16_f32 v156, v68, v69
    v_cvt_pk_bf16_f32 v157, v70, v71
    v_cvt_pk_bf16_f32 v158, v72, v73
    v_cvt_pk_bf16_f32 v159, v74, v75
    buffer_store_dwordx4 v[156:159], v27, s[40:43], s57 offen offset:0 sc1
    v_cvt_pk_bf16_f32 v160, v76, v77
    v_cvt_pk_bf16_f32 v161, v78, v79
    v_cvt_pk_bf16_f32 v162, v80, v81
    v_cvt_pk_bf16_f32 v163, v82, v83
    buffer_store_dwordx4 v[160:163], v27, s[40:43], s57 offen offset:1024 sc1
    v_pk_mul_f32 v[146:147], v[68:69], v[68:69]
    v_mov_b32 v144, v68
    v_mov_b32 v145, v69
    v_pk_add_f32 v[144:145], v[144:145], v[70:71]
    v_pk_fma_f32 v[146:147], v[70:71], v[70:71], v[146:147]
    v_pk_add_f32 v[144:145], v[144:145], v[72:73]
    v_pk_fma_f32 v[146:147], v[72:73], v[72:73], v[146:147]
    v_pk_add_f32 v[144:145], v[144:145], v[74:75]
    v_pk_fma_f32 v[146:147], v[74:75], v[74:75], v[146:147]
    v_pk_add_f32 v[144:145], v[144:145], v[76:77]
    v_pk_fma_f32 v[146:147], v[76:77], v[76:77], v[146:147]
    v_pk_add_f32 v[144:145], v[144:145], v[78:79]
    v_pk_fma_f32 v[146:147], v[78:79], v[78:79], v[146:147]
    v_pk_add_f32 v[144:145], v[144:145], v[80:81]
    v_pk_fma_f32 v[146:147], v[80:81], v[80:81], v[146:147]
    v_pk_add_f32 v[144:145], v[144:145], v[82:83]
    v_pk_fma_f32 v[146:147], v[82:83], v[82:83], v[146:147]
    v_add_f32 v170, v144, v145
    v_add_f32 v171, v146, v147
    v_mov_b32 v132, v170
    s_nop 1
    v_permlane16_swap_b32 v170, v132
    v_add_f32 v170, v170, v132
    v_mov_b32 v132, v170
    s_nop 1
    v_permlane32_swap_b32 v170, v132
    v_add_f32 v170, v170, v132
    v_mov_b32 v133, v171
    s_nop 1
    v_permlane16_swap_b32 v171, v133
    v_add_f32 v171, v171, v133
    v_mov_b32 v133, v171
    s_nop 1
    v_permlane32_swap_b32 v171, v133
    v_add_f32 v171, v171, v133
    v_cmp_gt_u32 vcc, 16, v1
    s_nop 3
    s_and_saveexec_b64 s[60:61], vcc
    buffer_store_dwordx2 v[168:169], v5, s[40:43], s58 offen offset:0 sc1
    buffer_store_dwordx2 v[170:171], v5, s[40:43], s58 offen offset:128 sc1
    s_mov_b64 exec, s[60:61]
    s_waitcnt vmcnt(0)
    s_barrier
    s_cmp_lg_u32 s48, 0
    s_cbranch_scc1 L_sig_10
    s_lshl_b32 s52, s76, 7
    s_lshl_b32 s53, s77, 2
    s_add_u32 s52, s52, s53
    s_add_u32 s52, s52, 15765504
    v_mov_b32 v4, s52
    v_mov_b32 v5, 1
    s_mov_b64 exec, 1
    buffer_store_dword v5, v4, s[40:43], 0 offen sc1
    s_mov_b64 exec, -1
L_sig_10:
    s_add_u32 s6, s64, 0
    s_add_u32 m0, s66, 0
    s_nop 0
    buffer_load_dwordx4 v20, s[36:39], s6 offen offset:0 lds
    buffer_load_dwordx4 v21, s[36:39], s6 offen offset:1024 lds
    buffer_load_dwordx4 v22, s[36:39], s6 offen offset:2048 lds
    buffer_load_dwordx4 v23, s[36:39], s6 offen offset:3072 lds
    s_add_u32 m0, s66, 4096
    s_nop 0
    buffer_load_dwordx4 v24, s[36:39], s6 offen offset:0 lds
    buffer_load_dwordx4 v25, s[36:39], s6 offen offset:1024 lds
    buffer_load_dwordx4 v26, s[36:39], s6 offen offset:2048 lds
    s_add_u32 s6, s64, 458752
    s_add_u32 m0, s66, 28672
    s_nop 0
    buffer_load_dwordx4 v20, s[36:39], s6 offen offset:0 lds
    buffer_load_dwordx4 v21, s[36:39], s6 offen offset:1024 lds
    buffer_load_dwordx4 v22, s[36:39], s6 offen offset:2048 lds
    buffer_load_dwordx4 v23, s[36:39], s6 offen offset:3072 lds
    s_add_u32 m0, s66, 32768
    s_nop 0
    buffer_load_dwordx4 v24, s[36:39], s6 offen offset:0 lds
    buffer_load_dwordx4 v25, s[36:39], s6 offen offset:1024 lds
    buffer_load_dwordx4 v26, s[36:39], s6 offen offset:2048 lds
    s_add_u32 s6, s64, 917504
    s_add_u32 m0, s66, 57344
    s_nop 0
    buffer_load_dwordx4 v20, s[36:39], s6 offen offset:0 lds
    buffer_load_dwordx4 v21, s[36:39], s6 offen offset:1024 lds
    buffer_load_dwordx4 v22, s[36:39], s6 offen offset:2048 lds
    buffer_load_dwordx4 v23, s[36:39], s6 offen offset:3072 lds
    s_add_u32 m0, s66, 61440
    s_nop 0
    buffer_load_dwordx4 v24, s[36:39], s6 offen offset:0 lds
    buffer_load_dwordx4 v25, s[36:39], s6 offen offset:1024 lds
    buffer_load_dwordx4 v26, s[36:39], s6 offen offset:2048 lds
    s_add_u32 s6, s64, 1376256
    s_add_u32 m0, s66, 86016
    s_nop 0
    buffer_load_dwordx4 v20, s[36:39], s6 offen offset:0 lds
    buffer_load_dwordx4 v21, s[36:39], s6 offen offset:1024 lds
    buffer_load_dwordx4 v22, s[36:39], s6 offen offset:2048 lds
    buffer_load_dwordx4 v23, s[36:39], s6 offen offset:3072 lds
    s_add_u32 m0, s66, 90112
    s_nop 0
    buffer_load_dwordx4 v24, s[36:39], s6 offen offset:0 lds
    buffer_load_dwordx4 v25, s[36:39], s6 offen offset:1024 lds
    buffer_load_dwordx4 v26, s[36:39], s6 offen offset:2048 lds
    s_branch L_tail
L_roleA:
    s_mov_b32 s36, s10
    s_and_b32 s37, s11, 0xffff
    s_mov_b32 s38, 0x180000
    s_mov_b32 s39, 0x20000
    s_lshl_b32 s67, s48, 11
    s_mul_i32 s65, s48, 49152
    s_lshl_b32 s52, s77, 7
    s_add_u32 s65, s65, s52
    v_lshrrev_b32 v4, 3, v1
    v_and_b32 v5, 7, v1
    v_and_b32 v6, 2, v4
    v_xor_b32 v6, v5, v6
    v_mul_u32_u24 v7, 3072, v4
    v_lshl_add_u32 v56, v6, 4, v7
    v_xor_b32 v6, 4, v6
    v_lshl_add_u32 v57, v6, 4, v7
    v_add_u32 v57, 23552, v57
    s_add_u32 s55, s68, 0
    s_and_b32 s55, s55, 7
    s_mul_i32 s55, s55, 196608
    s_add_u32 s55, s55, s65
    s_add_u32 m0, s67, 16384
    s_add_u32 s54, s55, 0
    buffer_load_dwordx4 v56, s[36:39], s54 offen offset:0 lds
    buffer_load_dwordx4 v57, s[36:39], s54 offen offset:1024 lds
    s_add_u32 m0, s67, 24576
    s_add_u32 s54, s55, 1024
    buffer_load_dwordx4 v56, s[36:39], s54 offen offset:0 lds
    buffer_load_dwordx4 v57, s[36:39], s54 offen offset:1024 lds
    s_add_u32 m0, s67, 32768
    s_add_u32 s54, s55, 2048
    buffer_load_dwordx4 v56, s[36:39], s54 offen offset:0 lds
    buffer_load_dwordx4 v57, s[36:39], s54 offen offset:1024 lds
    s_mov_b32 s44, s24
    s_and_b32 s45, s25, 0xffff
    s_mov_b32 s46, 0x400
    s_mov_b32 s47, 0x20000
    v_lshlrev_b32 v4, 4, v3
    s_add_u32 s55, s68, 0
    s_and_b32 s55, s55, 7
    s_lshl_b32 s55, s55, 7
    buffer_load_dwordx4 a[0:3], v4, s[44:47], s55 offen offset:0
    buffer_load_dwordx4 a[4:7], v4, s[44:47], s55 offen offset:64
    s_add_u32 s55, s68, 1
    s_and_b32 s55, s55, 7
    s_lshl_b32 s55, s55, 7
    buffer_load_dwordx4 a[8:11], v4, s[44:47], s55 offen offset:0
    buffer_load_dwordx4 a[12:15], v4, s[44:47], s55 offen offset:64
    s_add_u32 s55, s68, 2
    s_and_b32 s55, s55, 7
    s_lshl_b32 s55, s55, 7
    buffer_load_dwordx4 a[16:19], v4, s[44:47], s55 offen offset:0
    buffer_load_dwordx4 a[20:23], v4, s[44:47], s55 offen offset:64
    s_add_u32 s55, s68, 3
    s_and_b32 s55, s55, 7
    s_lshl_b32 s55, s55, 7
    buffer_load_dwordx4 a[24:27], v4, s[44:47], s55 offen offset:0
    buffer_load_dwordx4 a[28:31], v4, s[44:47], s55 offen offset:64
    s_add_u32 s55, s68, 4
    s_and_b32 s55, s55, 7
    s_lshl_b32 s55, s55, 7
    buffer_load_dwordx4 a[32:35], v4, s[44:47], s55 offen offset:0
    buffer_load_dwordx4 a[36:39], v4, s[44:47], s55 offen offset:64
    s_add_u32 s55, s68, 5
    s_and_b32 s55, s55, 7
    s_lshl_b32 s55, s55, 7
    buffer_load_dwordx4 a[40:43], v4, s[44:47], s55 offen offset:0
    buffer_load_dwordx4 a[44:47], v4, s[44:47], s55 offen offset:64
    s_add_u32 s55, s68, 6
    s_and_b32 s55, s55, 7
    s_lshl_b32 s55, s55, 7
    buffer_load_dwordx4 a[48:51], v4, s[44:47], s55 offen offset:0
    buffer_load_dwordx4 a[52:55], v4, s[44:47], s55 offen offset:64
    s_add_u32 s55, s68, 7
    s_and_b32 s55, s55, 7
    s_lshl_b32 s55, s55, 7
    buffer_load_dwordx4 a[56:59], v4, s[44:47], s55 offen offset:0
    buffer_load_dwordx4 a[60:63], v4, s[44:47], s55 offen offset:64
    s_add_u32 s55, s68, 1
    s_and_b32 s55, s55, 7
    s_add_u32 m0, s66, 40960
    s_lshl_b32 s53, s55, 7
    s_add_u32 s53, s53, s64
    buffer_load_dwordx4 v52, s[32:35], s53 offen offset:0 lds
    buffer_load_dwordx4 v53, s[32:35], s53 offen offset:1024 lds
    buffer_load_dwordx4 v54, s[32:35], s53 offen offset:2048 lds
    buffer_load_dwordx4 v55, s[32:35], s53 offen offset:3072 lds
    s_add_u32 s55, s68, 1
    s_and_b32 s55, s55, 7
    s_mul_i32 s55, s55, 196608
    s_add_u32 s55, s55, s65
    s_add_u32 m0, s67, 57344
    s_add_u32 s54, s55, 0
    buffer_load_dwordx4 v56, s[36:39], s54 offen offset:0 lds
    buffer_load_dwordx4 v57, s[36:39], s54 offen offset:1024 lds
    s_add_u32 m0, s67, 65536
    s_add_u32 s54, s55, 1024
    buffer_load_dwordx4 v56, s[36:39], s54 offen offset:0 lds
    buffer_load_dwordx4 v57, s[36:39], s54 offen offset:1024 lds
    s_add_u32 m0, s67, 73728
    s_add_u32 s54, s55, 2048
    buffer_load_dwordx4 v56, s[36:39], s54 offen offset:0 lds
    buffer_load_dwordx4 v57, s[36:39], s54 offen offset:1024 lds
    s_add_u32 s55, s68, 2
    s_and_b32 s55, s55, 7
    s_add_u32 m0, s66, 81920
    s_lshl_b32 s53, s55, 7
    s_add_u32 s53, s53, s64
    buffer_load_dwordx4 v52, s[32:35], s53 offen offset:0 lds
    buffer_load_dwordx4 v53, s[32:35], s53 offen offset:1024 lds
    buffer_load_dwordx4 v54, s[32:35], s53 offen offset:2048 lds
    buffer_load_dwordx4 v55, s[32:35], s53 offen offset:3072 lds
    s_add_u32 s55, s68, 2
    s_and_b32 s55, s55, 7
    s_mul_i32 s55, s55, 196608
    s_add_u32 s55, s55, s65
    s_add_u32 m0, s67, 98304
    s_add_u32 s54, s55, 0
    buffer_load_dwordx4 v56, s[36:39], s54 offen offset:0 lds
    buffer_load_dwordx4 v57, s[36:39], s54 offen offset:1024 lds
    s_add_u32 m0, s67, 106496
    s_add_u32 s54, s55, 1024
    buffer_load_dwordx4 v56, s[36:39], s54 offen offset:0 lds
    buffer_load_dwordx4 v57, s[36:39], s54 offen offset:1024 lds
    s_add_u32 m0, s67, 114688
    s_add_u32 s54, s55, 2048
    buffer_load_dwordx4 v56, s[36:39], s54 offen offset:0 lds
    buffer_load_dwordx4 v57, s[36:39], s54 offen offset:1024 lds
    v_lshrrev_b32 v4, 2, v1
    v_and_b32 v4, 3, v4
    v_and_b32 v5, 1, v3
    v_lshlrev_b32 v5, 1, v5
    v_lshrrev_b32 v7, 1, v4
    v_or_b32 v5, v5, v7
    v_lshl_add_u32 v6, v3, 3, v4
    v_lshlrev_b32 v6, 7, v6
    v_and_b32 v7, 3, v1
    v_lshl_add_u32 v6, v7, 3, v6
    v_xor_b32 v7, 0, v5
    v_lshl_add_u32 v16, v7, 5, v6
    v_xor_b32 v7, 1, v5
    v_lshl_add_u32 v17, v7, 5, v6
    v_xor_b32 v7, 2, v5
    v_lshl_add_u32 v18, v7, 5, v6
    v_xor_b32 v7, 3, v5
    v_lshl_add_u32 v19, v7, 5, v6
    v_lshrrev_b32 v4, 1, v2
    v_xor_b32 v4, v3, v4
    v_lshlrev_b32 v4, 4, v4
    v_lshl_add_u32 v4, v2, 7, v4
    v_add_u32 v24, s66, v4
    v_xor_b32 v25, 64, v24
    v_mov_b32 v176, 0
    v_mov_b32 v177, 0
    v_mov_b32 v178, 0
    v_mov_b32 v179, 0
    v_mov_b32 v180, 0
    v_mov_b32 v181, 0
    v_mov_b32 v182, 0
    v_mov_b32 v183, 0
    v_mov_b32 v60, 0x3f803f80
    v_mov_b32 v61, 0x3f803f80
    v_mov_b32 v62, 0x3f803f80
    v_mov_b32 v63, 0x3f803f80
    s_waitcnt vmcnt(20)
    s_barrier
    s_cmp_lg_u32 s2, 0
    s_cbranch_scc1 L_pub_11
    s_cmp_lg_u32 s48, 0
    s_cbranch_scc1 L_pub_11
    s_mov_b32 s44, s28
    s_and_b32 s45, s29, 0xffff
    s_mov_b32 s46, 0x100
    s_mov_b32 s47, 0x20000
    v_mov_b32 v4, 128
    v_mov_b32 v5, 1
    s_mov_b64 exec, 1
    buffer_store_dword v5, v4, s[44:47], 0 offen sc1
    s_mov_b64 exec, -1
L_pub_11:
    ds_read_b128 v[64:67], v24 offset:0
    ds_read_b128 v[68:71], v24 offset:2048
    ds_read_b64_tr_b16 v[28:29], v16 offset:16384
    ds_read_b64_tr_b16 v[30:31], v16 offset:16896
    ds_read_b64_tr_b16 v[32:33], v17 offset:16384
    ds_read_b64_tr_b16 v[34:35], v17 offset:16896
    ds_read_b64_tr_b16 v[36:37], v18 offset:16384
    ds_read_b64_tr_b16 v[38:39], v18 offset:16896
    ds_read_b64_tr_b16 v[40:41], v19 offset:16384
    ds_read_b64_tr_b16 v[42:43], v19 offset:16896
    ds_read_b64_tr_b16 v[44:45], v16 offset:24576
    ds_read_b64_tr_b16 v[46:47], v16 offset:25088
    s_waitcnt lgkmcnt(10)
    s_waitcnt lgkmcnt(8)
    v_mfma_f32_16x16x32_bf16 v[80:83], v[28:31], v[64:67], 0
    ds_read_b64_tr_b16 v[48:49], v17 offset:24576
    v_mfma_f32_16x16x32_bf16 v[128:131], v[28:31], v[68:71], 0
    ds_read_b64_tr_b16 v[50:51], v17 offset:25088
    s_waitcnt lgkmcnt(8)
    v_mfma_f32_16x16x32_bf16 v[84:87], v[32:35], v[64:67], 0
    ds_read_b64_tr_b16 v[28:29], v18 offset:24576
    v_mfma_f32_16x16x32_bf16 v[132:135], v[32:35], v[68:71], 0
    ds_read_b64_tr_b16 v[30:31], v18 offset:25088
    ds_read_b128 v[72:75], v25 offset:0
    ds_read_b128 v[76:79], v25 offset:2048
    s_waitcnt lgkmcnt(10)
    v_mfma_f32_16x16x32_bf16 v[88:91], v[36:39], v[64:67], 0
    ds_read_b64_tr_b16 v[32:33], v19 offset:24576
    v_mfma_f32_16x16x32_bf16 v[136:139], v[36:39], v[68:71], 0
    v_mfma_f32_16x16x32_bf16 v[176:179], v[64:67], a[0:3], v[176:179]
    ds_read_b64_tr_b16 v[34:35], v19 offset:25088
    s_waitcnt lgkmcnt(10)
    v_mfma_f32_16x16x32_bf16 v[92:95], v[40:43], v[64:67], 0
    ds_read_b64_tr_b16 v[36:37], v16 offset:32768
    v_mfma_f32_16x16x32_bf16 v[140:143], v[40:43], v[68:71], 0
    v_mfma_f32_16x16x32_bf16 v[180:183], v[68:71], a[0:3], v[180:183]
    ds_read_b64_tr_b16 v[38:39], v16 offset:33280
    s_waitcnt lgkmcnt(10)
    v_mfma_f32_16x16x32_bf16 v[96:99], v[64:67], v[44:47], 0
    ds_read_b64_tr_b16 v[40:41], v17 offset:32768
    v_mfma_f32_16x16x32_bf16 v[144:147], v[68:71], v[44:47], 0
    ds_read_b64_tr_b16 v[42:43], v17 offset:33280
    s_waitcnt lgkmcnt(10)
    v_mfma_f32_16x16x32_bf16 v[100:103], v[64:67], v[48:51], 0
    ds_read_b64_tr_b16 v[44:45], v18 offset:32768
    v_mfma_f32_16x16x32_bf16 v[148:151], v[68:71], v[48:51], 0
    ds_read_b64_tr_b16 v[46:47], v18 offset:33280
    s_waitcnt lgkmcnt(10)
    v_mfma_f32_16x16x32_bf16 v[104:107], v[64:67], v[28:31], 0
    ds_read_b64_tr_b16 v[48:49], v19 offset:32768
    v_mfma_f32_16x16x32_bf16 v[152:155], v[68:71], v[28:31], 0
    ds_read_b64_tr_b16 v[50:51], v19 offset:33280
    s_waitcnt lgkmcnt(8)
    v_mfma_f32_16x16x32_bf16 v[108:111], v[64:67], v[32:35], 0
    ds_read_b64_tr_b16 v[28:29], v16 offset:20480
    v_mfma_f32_16x16x32_bf16 v[156:159], v[68:71], v[32:35], 0
    ds_read_b64_tr_b16 v[30:31], v16 offset:20992
    s_waitcnt lgkmcnt(8)
    v_mfma_f32_16x16x32_bf16 v[112:115], v[64:67], v[36:39], 0
    ds_read_b64_tr_b16 v[32:33], v17 offset:20480
    v_mfma_f32_16x16x32_bf16 v[160:163], v[68:71], v[36:39], 0
    ds_read_b64_tr_b16 v[34:35], v17 offset:20992
    s_waitcnt lgkmcnt(8)
    v_mfma_f32_16x16x32_bf16 v[116:119], v[64:67], v[40:43], 0
    ds_read_b64_tr_b16 v[36:37], v18 offset:20480
    v_mfma_f32_16x16x32_bf16 v[164:167], v[68:71], v[40:43], 0
    ds_read_b64_tr_b16 v[38:39], v18 offset:20992
    s_waitcnt lgkmcnt(8)
    v_mfma_f32_16x16x32_bf16 v[120:123], v[64:67], v[44:47], 0
    ds_read_b64_tr_b16 v[40:41], v19 offset:20480
    v_mfma_f32_16x16x32_bf16 v[168:171], v[68:71], v[44:47], 0
    ds_read_b64_tr_b16 v[42:43], v19 offset:20992
    s_waitcnt lgkmcnt(8)
    v_mfma_f32_16x16x32_bf16 v[124:127], v[64:67], v[48:51], 0
    ds_read_b64_tr_b16 v[44:45], v16 offset:28672
    v_mfma_f32_16x16x32_bf16 v[172:175], v[68:71], v[48:51], 0
    ds_read_b64_tr_b16 v[46:47], v16 offset:29184
    s_waitcnt vmcnt(10)
    s_barrier
    s_waitcnt lgkmcnt(8)
    v_mfma_f32_16x16x32_bf16 v[80:83], v[28:31], v[72:75], v[80:83]
    ds_read_b64_tr_b16 v[48:49], v17 offset:28672
    v_mfma_f32_16x16x32_bf16 v[128:131], v[28:31], v[76:79], v[128:131]
    ds_read_b64_tr_b16 v[50:51], v17 offset:29184
    s_add_u32 s55, s68, 3
    s_and_b32 s55, s55, 7
    s_add_u32 m0, s66, 122880
    s_lshl_b32 s53, s55, 7
    s_add_u32 s53, s53, s64
    buffer_load_dwordx4 v52, s[32:35], s53 offen offset:0 lds
    buffer_load_dwordx4 v53, s[32:35], s53 offen offset:1024 lds
    buffer_load_dwordx4 v54, s[32:35], s53 offen offset:2048 lds
    buffer_load_dwordx4 v55, s[32:35], s53 offen offset:3072 lds
    s_waitcnt lgkmcnt(8)
    v_mfma_f32_16x16x32_bf16 v[84:87], v[32:35], v[72:75], v[84:87]
    ds_read_b64_tr_b16 v[28:29], v18 offset:28672
    v_mfma_f32_16x16x32_bf16 v[132:135], v[32:35], v[76:79], v[132:135]
    ds_read_b64_tr_b16 v[30:31], v18 offset:29184
    ds_read_b128 v[64:67], v24 offset:40960
    ds_read_b128 v[68:71], v24 offset:43008
    s_waitcnt lgkmcnt(10)
    v_mfma_f32_16x16x32_bf16 v[88:91], v[36:39], v[72:75], v[88:91]
    ds_read_b64_tr_b16 v[32:33], v19 offset:28672
    v_mfma_f32_16x16x32_bf16 v[136:139], v[36:39], v[76:79], v[136:139]
    v_mfma_f32_16x16x32_bf16 v[176:179], v[72:75], a[4:7], v[176:179]
    ds_read_b64_tr_b16 v[34:35], v19 offset:29184
    s_add_u32 s55, s68, 3
    s_and_b32 s55, s55, 7
    s_mul_i32 s55, s55, 196608
    s_add_u32 s55, s55, s65
    s_add_u32 m0, s67, 139264
    s_add_u32 s54, s55, 0
    buffer_load_dwordx4 v56, s[36:39], s54 offen offset:0 lds
    buffer_load_dwordx4 v57, s[36:39], s54 offen offset:1024 lds
    s_add_u32 m0, s67, 147456
    s_add_u32 s54, s55, 1024
    buffer_load_dwordx4 v56, s[36:39], s54 offen offset:0 lds
    buffer_load_dwordx4 v57, s[36:39], s54 offen offset:1024 lds
    s_add_u32 m0, s67, 155648
    s_add_u32 s54, s55, 2048
    buffer_load_dwordx4 v56, s[36:39], s54 offen offset:0 lds
    buffer_load_dwordx4 v57, s[36:39], s54 offen offset:1024 lds
    s_waitcnt lgkmcnt(10)
    v_mfma_f32_16x16x32_bf16 v[92:95], v[40:43], v[72:75], v[92:95]
    ds_read_b64_tr_b16 v[36:37], v16 offset:36864
    v_mfma_f32_16x16x32_bf16 v[140:143], v[40:43], v[76:79], v[140:143]
    v_mfma_f32_16x16x32_bf16 v[180:183], v[76:79], a[4:7], v[180:183]
    ds_read_b64_tr_b16 v[38:39], v16 offset:37376
    s_waitcnt lgkmcnt(10)
    v_mfma_f32_16x16x32_bf16 v[96:99], v[72:75], v[44:47], v[96:99]
    ds_read_b64_tr_b16 v[40:41], v17 offset:36864
    v_mfma_f32_16x16x32_bf16 v[144:147], v[76:79], v[44:47], v[144:147]
    ds_read_b64_tr_b16 v[42:43], v17 offset:37376
    s_waitcnt lgkmcnt(10)
    v_mfma_f32_16x16x32_bf16 v[100:103], v[72:75], v[48:51], v[100:103]
    ds_read_b64_tr_b16 v[44:45], v18 offset:36864
    v_mfma_f32_16x16x32_bf16 v[148:151], v[76:79], v[48:51], v[148:151]
    ds_read_b64_tr_b16 v[46:47], v18 offset:37376
    s_waitcnt lgkmcnt(10)
    v_mfma_f32_16x16x32_bf16 v[104:107], v[72:75], v[28:31], v[104:107]
    ds_read_b64_tr_b16 v[48:49], v19 offset:36864
    v_mfma_f32_16x16x32_bf16 v[152:155], v[76:79], v[28:31], v[152:155]
    ds_read_b64_tr_b16 v[50:51], v19 offset:37376
    s_waitcnt lgkmcnt(8)
    v_mfma_f32_16x16x32_bf16 v[108:111], v[72:75], v[32:35], v[108:111]
    ds_read_b64_tr_b16 v[28:29], v16 offset:57344
    v_mfma_f32_16x16x32_bf16 v[156:159], v[76:79], v[32:35], v[156:159]
    ds_read_b64_tr_b16 v[30:31], v16 offset:57856
    s_waitcnt lgkmcnt(8)
    v_mfma_f32_16x16x32_bf16 v[112:115], v[72:75], v[36:39], v[112:115]
    ds_read_b64_tr_b16 v[32:33], v17 offset:57344
    v_mfma_f32_16x16x32_bf16 v[160:163], v[76:79], v[36:39], v[160:163]
    ds_read_b64_tr_b16 v[34:35], v17 offset:57856
    s_waitcnt lgkmcnt(8)
    v_mfma_f32_16x16x32_bf16 v[116:119], v[72:75], v[40:43], v[116:119]
    ds_read_b64_tr_b16 v[36:37], v18 offset:57344
    v_mfma_f32_16x16x32_bf16 v[164:167], v[76:79], v[40:43], v[164:167]
    ds_read_b64_tr_b16 v[38:39], v18 offset:57856
    s_waitcnt lgkmcnt(8)
    v_mfma_f32_16x16x32_bf16 v[120:123], v[72:75], v[44:47], v[120:123]
    ds_read_b64_tr_b16 v[40:41], v19 offset:57344
    v_mfma_f32_16x16x32_bf16 v[168:171], v[76:79], v[44:47], v[168:171]
    ds_read_b64_tr_b16 v[42:43], v19 offset:57856
    s_waitcnt lgkmcnt(8)
    v_mfma_f32_16x16x32_bf16 v[124:127], v[72:75], v[48:51], v[124:127]
    v_add_u32 v16, 65536, v16
    v_add_u32 v17, 65536, v17
    v_add_u32 v18, 65536, v18
    v_add_u32 v19, 65536, v19
    ds_read_b64_tr_b16 v[44:45], v16 offset:0
    v_mfma_f32_16x16x32_bf16 v[172:175], v[76:79], v[48:51], v[172:175]
    ds_read_b64_tr_b16 v[46:47], v16 offset:512
    s_waitcnt lgkmcnt(8)
    v_mfma_f32_16x16x32_bf16 v[80:83], v[28:31], v[64:67], v[80:83]
    ds_read_b64_tr_b16 v[48:49], v17 offset:0
    v_mfma_f32_16x16x32_bf16 v[128:131], v[28:31], v[68:71], v[128:131]
    ds_read_b64_tr_b16 v[50:51], v17 offset:512
    s_waitcnt lgkmcnt(8)
    v_mfma_f32_16x16x32_bf16 v[84:87], v[32:35], v[64:67], v[84:87]
    ds_read_b64_tr_b16 v[28:29], v18 offset:0
    v_mfma_f32_16x16x32_bf16 v[132:135], v[32:35], v[68:71], v[132:135]
    ds_read_b64_tr_b16 v[30:31], v18 offset:512
    ds_read_b128 v[72:75], v25 offset:40960
    ds_read_b128 v[76:79], v25 offset:43008
    s_waitcnt lgkmcnt(10)
    v_mfma_f32_16x16x32_bf16 v[88:91], v[36:39], v[64:67], v[88:91]
    ds_read_b64_tr_b16 v[32:33], v19 offset:0
    v_mfma_f32_16x16x32_bf16 v[136:139], v[36:39], v[68:71], v[136:139]
    v_mfma_f32_16x16x32_bf16 v[176:179], v[64:67], a[8:11], v[176:179]
    ds_read_b64_tr_b16 v[34:35], v19 offset:512
    s_waitcnt lgkmcnt(10)
    v_mfma_f32_16x16x32_bf16 v[92:95], v[40:43], v[64:67], v[92:95]
    ds_read_b64_tr_b16 v[36:37], v16 offset:8192
    v_mfma_f32_16x16x32_bf16 v[140:143], v[40:43], v[68:71], v[140:143]
    v_mfma_f32_16x16x32_bf16 v[180:183], v[68:71], a[8:11], v[180:183]
    ds_read_b64_tr_b16 v[38:39], v16 offset:8704
    s_waitcnt lgkmcnt(10)
    v_mfma_f32_16x16x32_bf16 v[96:99], v[64:67], v[44:47], v[96:99]
    ds_read_b64_tr_b16 v[40:41], v17 offset:8192
    v_mfma_f32_16x16x32_bf16 v[144:147], v[68:71], v[44:47], v[144:147]
    ds_read_b64_tr_b16 v[42:43], v17 offset:8704
    s_waitcnt lgkmcnt(10)
    v_mfma_f32_16x16x32_bf16 v[100:103], v[64:67], v[48:51], v[100:103]
    ds_read_b64_tr_b16 v[44:45], v18 offset:8192
    v_mfma_f32_16x16x32_bf16 v[148:151], v[68:71], v[48:51], v[148:151]
    ds_read_b64_tr_b16 v[46:47], v18 offset:8704
    s_waitcnt lgkmcnt(10)
    v_mfma_f32_16x16x32_bf16 v[104:107], v[64:67], v[28:31], v[104:107]
    ds_read_b64_tr_b16 v[48:49], v19 offset:8192
    v_mfma_f32_16x16x32_bf16 v[152:155], v[68:71], v[28:31], v[152:155]
    ds_read_b64_tr_b16 v[50:51], v19 offset:8704
    s_waitcnt lgkmcnt(8)
    v_mfma_f32_16x16x32_bf16 v[108:111], v[64:67], v[32:35], v[108:111]
    v_subrev_u32 v16, 65536, v16
    v_subrev_u32 v17, 65536, v17
    v_subrev_u32 v18, 65536, v18
    v_subrev_u32 v19, 65536, v19
    ds_read_b64_tr_b16 v[28:29], v16 offset:61440
    v_mfma_f32_16x16x32_bf16 v[156:159], v[68:71], v[32:35], v[156:159]
    ds_read_b64_tr_b16 v[30:31], v16 offset:61952
    s_waitcnt lgkmcnt(8)
    v_mfma_f32_16x16x32_bf16 v[112:115], v[64:67], v[36:39], v[112:115]
    ds_read_b64_tr_b16 v[32:33], v17 offset:61440
    v_mfma_f32_16x16x32_bf16 v[160:163], v[68:71], v[36:39], v[160:163]
    ds_read_b64_tr_b16 v[34:35], v17 offset:61952
    s_waitcnt lgkmcnt(8)
    v_mfma_f32_16x16x32_bf16 v[116:119], v[64:67], v[40:43], v[116:119]
    ds_read_b64_tr_b16 v[36:37], v18 offset:61440
    v_mfma_f32_16x16x32_bf16 v[164:167], v[68:71], v[40:43], v[164:167]
    ds_read_b64_tr_b16 v[38:39], v18 offset:61952
    s_waitcnt lgkmcnt(8)
    v_mfma_f32_16x16x32_bf16 v[120:123], v[64:67], v[44:47], v[120:123]
    ds_read_b64_tr_b16 v[40:41], v19 offset:61440
    v_mfma_f32_16x16x32_bf16 v[168:171], v[68:71], v[44:47], v[168:171]
    ds_read_b64_tr_b16 v[42:43], v19 offset:61952
    s_waitcnt lgkmcnt(8)
    v_mfma_f32_16x16x32_bf16 v[124:127], v[64:67], v[48:51], v[124:127]
    v_add_u32 v16, 65536, v16
    v_add_u32 v17, 65536, v17
    v_add_u32 v18, 65536, v18
    v_add_u32 v19, 65536, v19
    ds_read_b64_tr_b16 v[44:45], v16 offset:4096
    v_mfma_f32_16x16x32_bf16 v[172:175], v[68:71], v[48:51], v[172:175]
    ds_read_b64_tr_b16 v[46:47], v16 offset:4608
    s_waitcnt vmcnt(10)
    s_barrier
    s_waitcnt lgkmcnt(8)
    v_mfma_f32_16x16x32_bf16 v[80:83], v[28:31], v[72:75], v[80:83]
    ds_read_b64_tr_b16 v[48:49], v17 offset:4096
    v_mfma_f32_16x16x32_bf16 v[128:131], v[28:31], v[76:79], v[128:131]
    ds_read_b64_tr_b16 v[50:51], v17 offset:4608
    s_add_u32 s55, s68, 4
    s_and_b32 s55, s55, 7
    s_add_u32 m0, s66, 0
    s_lshl_b32 s53, s55, 7
    s_add_u32 s53, s53, s64
    buffer_load_dwordx4 v52, s[32:35], s53 offen offset:0 lds
    buffer_load_dwordx4 v53, s[32:35], s53 offen offset:1024 lds
    buffer_load_dwordx4 v54, s[32:35], s53 offen offset:2048 lds
    buffer_load_dwordx4 v55, s[32:35], s53 offen offset:3072 lds
    s_waitcnt lgkmcnt(8)
    v_mfma_f32_16x16x32_bf16 v[84:87], v[32:35], v[72:75], v[84:87]
    ds_read_b64_tr_b16 v[28:29], v18 offset:4096
    v_mfma_f32_16x16x32_bf16 v[132:135], v[32:35], v[76:79], v[132:135]
    ds_read_b64_tr_b16 v[30:31], v18 offset:4608
    v_add_u32 v24, 65536, v24
    v_add_u32 v25, 65536, v25
    ds_read_b128 v[64:67], v24 offset:16384
    ds_read_b128 v[68:71], v24 offset:18432
    s_waitcnt lgkmcnt(10)
    v_mfma_f32_16x16x32_bf16 v[88:91], v[36:39], v[72:75], v[88:91]
    ds_read_b64_tr_b16 v[32:33], v19 offset:4096
    v_mfma_f32_16x16x32_bf16 v[136:139], v[36:39], v[76:79], v[136:139]
    v_mfma_f32_16x16x32_bf16 v[176:179], v[72:75], a[12:15], v[176:179]
    ds_read_b64_tr_b16 v[34:35], v19 offset:4608
    s_add_u32 s55, s68, 4
    s_and_b32 s55, s55, 7
    s_mul_i32 s55, s55, 196608
    s_add_u32 s55, s55, s65
    s_add_u32 m0, s67, 16384
    s_add_u32 s54, s55, 0
    buffer_load_dwordx4 v56, s[36:39], s54 offen offset:0 lds
    buffer_load_dwordx4 v57, s[36:39], s54 offen offset:1024 lds
    s_add_u32 m0, s67, 24576
    s_add_u32 s54, s55, 1024
    buffer_load_dwordx4 v56, s[36:39], s54 offen offset:0 lds
    buffer_load_dwordx4 v57, s[36:39], s54 offen offset:1024 lds
    s_add_u32 m0, s67, 32768
    s_add_u32 s54, s55, 2048
    buffer_load_dwordx4 v56, s[36:39], s54 offen offset:0 lds
    buffer_load_dwordx4 v57, s[36:39], s54 offen offset:1024 lds
    s_waitcnt lgkmcnt(10)
    v_mfma_f32_16x16x32_bf16 v[92:95], v[40:43], v[72:75], v[92:95]
    ds_read_b64_tr_b16 v[36:37], v16 offset:12288
    v_mfma_f32_16x16x32_bf16 v[140:143], v[40:43], v[76:79], v[140:143]
    v_mfma_f32_16x16x32_bf16 v[180:183], v[76:79], a[12:15], v[180:183]
    ds_read_b64_tr_b16 v[38:39], v16 offset:12800
    s_waitcnt lgkmcnt(10)
    v_mfma_f32_16x16x32_bf16 v[96:99], v[72:75], v[44:47], v[96:99]
    ds_read_b64_tr_b16 v[40:41], v17 offset:12288
    v_mfma_f32_16x16x32_bf16 v[144:147], v[76:79], v[44:47], v[144:147]
    ds_read_b64_tr_b16 v[42:43], v17 offset:12800
    s_waitcnt lgkmcnt(10)
    v_mfma_f32_16x16x32_bf16 v[100:103], v[72:75], v[48:51], v[100:103]
    ds_read_b64_tr_b16 v[44:45], v18 offset:12288
    v_mfma_f32_16x16x32_bf16 v[148:151], v[76:79], v[48:51], v[148:151]
    ds_read_b64_tr_b16 v[46:47], v18 offset:12800
    s_waitcnt lgkmcnt(10)
    v_mfma_f32_16x16x32_bf16 v[104:107], v[72:75], v[28:31], v[104:107]
    ds_read_b64_tr_b16 v[48:49], v19 offset:12288
    v_mfma_f32_16x16x32_bf16 v[152:155], v[76:79], v[28:31], v[152:155]
    ds_read_b64_tr_b16 v[50:51], v19 offset:12800
    s_waitcnt lgkmcnt(8)
    v_mfma_f32_16x16x32_bf16 v[108:111], v[72:75], v[32:35], v[108:111]
    ds_read_b64_tr_b16 v[28:29], v16 offset:32768
    v_mfma_f32_16x16x32_bf16 v[156:159], v[76:79], v[32:35], v[156:159]
    ds_read_b64_tr_b16 v[30:31], v16 offset:33280
    s_waitcnt lgkmcnt(8)
    v_mfma_f32_16x16x32_bf16 v[112:115], v[72:75], v[36:39], v[112:115]
    ds_read_b64_tr_b16 v[32:33], v17 offset:32768
    v_mfma_f32_16x16x32_bf16 v[160:163], v[76:79], v[36:39], v[160:163]
    ds_read_b64_tr_b16 v[34:35], v17 offset:33280
    s_waitcnt lgkmcnt(8)
    v_mfma_f32_16x16x32_bf16 v[116:119], v[72:75], v[40:43], v[116:119]
    ds_read_b64_tr_b16 v[36:37], v18 offset:32768
    v_mfma_f32_16x16x32_bf16 v[164:167], v[76:79], v[40:43], v[164:167]
    ds_read_b64_tr_b16 v[38:39], v18 offset:33280
    s_waitcnt lgkmcnt(8)
    v_mfma_f32_16x16x32_bf16 v[120:123], v[72:75], v[44:47], v[120:123]
    ds_read_b64_tr_b16 v[40:41], v19 offset:32768
    v_mfma_f32_16x16x32_bf16 v[168:171], v[76:79], v[44:47], v[168:171]
    ds_read_b64_tr_b16 v[42:43], v19 offset:33280
    s_waitcnt lgkmcnt(8)
    v_mfma_f32_16x16x32_bf16 v[124:127], v[72:75], v[48:51], v[124:127]
    ds_read_b64_tr_b16 v[44:45], v16 offset:40960
    v_mfma_f32_16x16x32_bf16 v[172:175], v[76:79], v[48:51], v[172:175]
    ds_read_b64_tr_b16 v[46:47], v16 offset:41472
    s_waitcnt lgkmcnt(8)
    v_mfma_f32_16x16x32_bf16 v[80:83], v[28:31], v[64:67], v[80:83]
    ds_read_b64_tr_b16 v[48:49], v17 offset:40960
    v_mfma_f32_16x16x32_bf16 v[128:131], v[28:31], v[68:71], v[128:131]
    ds_read_b64_tr_b16 v[50:51], v17 offset:41472
    s_waitcnt lgkmcnt(8)
    v_mfma_f32_16x16x32_bf16 v[84:87], v[32:35], v[64:67], v[84:87]
    ds_read_b64_tr_b16 v[28:29], v18 offset:40960
    v_mfma_f32_16x16x32_bf16 v[132:135], v[32:35], v[68:71], v[132:135]
    ds_read_b64_tr_b16 v[30:31], v18 offset:41472
    ds_read_b128 v[72:75], v25 offset:16384
    ds_read_b128 v[76:79], v25 offset:18432
    s_waitcnt lgkmcnt(10)
    v_mfma_f32_16x16x32_bf16 v[88:91], v[36:39], v[64:67], v[88:91]
    ds_read_b64_tr_b16 v[32:33], v19 offset:40960
    v_mfma_f32_16x16x32_bf16 v[136:139], v[36:39], v[68:71], v[136:139]
    v_mfma_f32_16x16x32_bf16 v[176:179], v[64:67], a[16:19], v[176:179]
    ds_read_b64_tr_b16 v[34:35], v19 offset:41472
    s_waitcnt lgkmcnt(10)
    v_mfma_f32_16x16x32_bf16 v[92:95], v[40:43], v[64:67], v[92:95]
    ds_read_b64_tr_b16 v[36:37], v16 offset:49152
    v_mfma_f32_16x16x32_bf16 v[140:143], v[40:43], v[68:71], v[140:143]
    v_mfma_f32_16x16x32_bf16 v[180:183], v[68:71], a[16:19], v[180:183]
    ds_read_b64_tr_b16 v[38:39], v16 offset:49664
    s_waitcnt lgkmcnt(10)
    v_mfma_f32_16x16x32_bf16 v[96:99], v[64:67], v[44:47], v[96:99]
    ds_read_b64_tr_b16 v[40:41], v17 offset:49152
    v_mfma_f32_16x16x32_bf16 v[144:147], v[68:71], v[44:47], v[144:147]
    ds_read_b64_tr_b16 v[42:43], v17 offset:49664
    s_waitcnt lgkmcnt(10)
    v_mfma_f32_16x16x32_bf16 v[100:103], v[64:67], v[48:51], v[100:103]
    ds_read_b64_tr_b16 v[44:45], v18 offset:49152
    v_mfma_f32_16x16x32_bf16 v[148:151], v[68:71], v[48:51], v[148:151]
    ds_read_b64_tr_b16 v[46:47], v18 offset:49664
    s_waitcnt lgkmcnt(10)
    v_mfma_f32_16x16x32_bf16 v[104:107], v[64:67], v[28:31], v[104:107]
    ds_read_b64_tr_b16 v[48:49], v19 offset:49152
    v_mfma_f32_16x16x32_bf16 v[152:155], v[68:71], v[28:31], v[152:155]
    ds_read_b64_tr_b16 v[50:51], v19 offset:49664
    s_waitcnt lgkmcnt(8)
    v_mfma_f32_16x16x32_bf16 v[108:111], v[64:67], v[32:35], v[108:111]
    ds_read_b64_tr_b16 v[28:29], v16 offset:36864
    v_mfma_f32_16x16x32_bf16 v[156:159], v[68:71], v[32:35], v[156:159]
    ds_read_b64_tr_b16 v[30:31], v16 offset:37376
    s_waitcnt lgkmcnt(8)
    v_mfma_f32_16x16x32_bf16 v[112:115], v[64:67], v[36:39], v[112:115]
    ds_read_b64_tr_b16 v[32:33], v17 offset:36864
    v_mfma_f32_16x16x32_bf16 v[160:163], v[68:71], v[36:39], v[160:163]
    ds_read_b64_tr_b16 v[34:35], v17 offset:37376
    s_waitcnt lgkmcnt(8)
    v_mfma_f32_16x16x32_bf16 v[116:119], v[64:67], v[40:43], v[116:119]
    ds_read_b64_tr_b16 v[36:37], v18 offset:36864
    v_mfma_f32_16x16x32_bf16 v[164:167], v[68:71], v[40:43], v[164:167]
    ds_read_b64_tr_b16 v[38:39], v18 offset:37376
    s_waitcnt lgkmcnt(8)
    v_mfma_f32_16x16x32_bf16 v[120:123], v[64:67], v[44:47], v[120:123]
    ds_read_b64_tr_b16 v[40:41], v19 offset:36864
    v_mfma_f32_16x16x32_bf16 v[168:171], v[68:71], v[44:47], v[168:171]
    ds_read_b64_tr_b16 v[42:43], v19 offset:37376
    s_waitcnt lgkmcnt(8)
    v_mfma_f32_16x16x32_bf16 v[124:127], v[64:67], v[48:51], v[124:127]
    ds_read_b64_tr_b16 v[44:45], v16 offset:45056
    v_mfma_f32_16x16x32_bf16 v[172:175], v[68:71], v[48:51], v[172:175]
    ds_read_b64_tr_b16 v[46:47], v16 offset:45568
    s_waitcnt vmcnt(10)
    s_barrier
    s_waitcnt lgkmcnt(8)
    v_mfma_f32_16x16x32_bf16 v[80:83], v[28:31], v[72:75], v[80:83]
    ds_read_b64_tr_b16 v[48:49], v17 offset:45056
    v_mfma_f32_16x16x32_bf16 v[128:131], v[28:31], v[76:79], v[128:131]
    ds_read_b64_tr_b16 v[50:51], v17 offset:45568
    s_add_u32 s55, s68, 5
    s_and_b32 s55, s55, 7
    s_add_u32 m0, s66, 40960
    s_lshl_b32 s53, s55, 7
    s_add_u32 s53, s53, s64
    buffer_load_dwordx4 v52, s[32:35], s53 offen offset:0 lds
    buffer_load_dwordx4 v53, s[32:35], s53 offen offset:1024 lds
    buffer_load_dwordx4 v54, s[32:35], s53 offen offset:2048 lds
    buffer_load_dwordx4 v55, s[32:35], s53 offen offset:3072 lds
    s_waitcnt lgkmcnt(8)
    v_mfma_f32_16x16x32_bf16 v[84:87], v[32:35], v[72:75], v[84:87]
    ds_read_b64_tr_b16 v[28:29], v18 offset:45056
    v_mfma_f32_16x16x32_bf16 v[132:135], v[32:35], v[76:79], v[132:135]
    ds_read_b64_tr_b16 v[30:31], v18 offset:45568
    ds_read_b128 v[64:67], v24 offset:57344
    ds_read_b128 v[68:71], v24 offset:59392
    s_waitcnt lgkmcnt(10)
    v_mfma_f32_16x16x32_bf16 v[88:91], v[36:39], v[72:75], v[88:91]
    ds_read_b64_tr_b16 v[32:33], v19 offset:45056
    v_mfma_f32_16x16x32_bf16 v[136:139], v[36:39], v[76:79], v[136:139]
    v_mfma_f32_16x16x32_bf16 v[176:179], v[72:75], a[20:23], v[176:179]
    ds_read_b64_tr_b16 v[34:35], v19 offset:45568
    s_add_u32 s55, s68, 5
    s_and_b32 s55, s55, 7
    s_mul_i32 s55, s55, 196608
    s_add_u32 s55, s55, s65
    s_add_u32 m0, s67, 57344
    s_add_u32 s54, s55, 0
    buffer_load_dwordx4 v56, s[36:39], s54 offen offset:0 lds
    buffer_load_dwordx4 v57, s[36:39], s54 offen offset:1024 lds
    s_add_u32 m0, s67, 65536
    s_add_u32 s54, s55, 1024
    buffer_load_dwordx4 v56, s[36:39], s54 offen offset:0 lds
    buffer_load_dwordx4 v57, s[36:39], s54 offen offset:1024 lds
    s_add_u32 m0, s67, 73728
    s_add_u32 s54, s55, 2048
    buffer_load_dwordx4 v56, s[36:39], s54 offen offset:0 lds
    buffer_load_dwordx4 v57, s[36:39], s54 offen offset:1024 lds
    s_waitcnt lgkmcnt(10)
    v_mfma_f32_16x16x32_bf16 v[92:95], v[40:43], v[72:75], v[92:95]
    ds_read_b64_tr_b16 v[36:37], v16 offset:53248
    v_mfma_f32_16x16x32_bf16 v[140:143], v[40:43], v[76:79], v[140:143]
    v_mfma_f32_16x16x32_bf16 v[180:183], v[76:79], a[20:23], v[180:183]
    ds_read_b64_tr_b16 v[38:39], v16 offset:53760
    s_waitcnt lgkmcnt(10)
    v_mfma_f32_16x16x32_bf16 v[96:99], v[72:75], v[44:47], v[96:99]
    ds_read_b64_tr_b16 v[40:41], v17 offset:53248
    v_mfma_f32_16x16x32_bf16 v[144:147], v[76:79], v[44:47], v[144:147]
    ds_read_b64_tr_b16 v[42:43], v17 offset:53760
    s_waitcnt lgkmcnt(10)
    v_mfma_f32_16x16x32_bf16 v[100:103], v[72:75], v[48:51], v[100:103]
    ds_read_b64_tr_b16 v[44:45], v18 offset:53248
    v_mfma_f32_16x16x32_bf16 v[148:151], v[76:79], v[48:51], v[148:151]
    ds_read_b64_tr_b16 v[46:47], v18 offset:53760
    s_waitcnt lgkmcnt(10)
    v_mfma_f32_16x16x32_bf16 v[104:107], v[72:75], v[28:31], v[104:107]
    ds_read_b64_tr_b16 v[48:49], v19 offset:53248
    v_mfma_f32_16x16x32_bf16 v[152:155], v[76:79], v[28:31], v[152:155]
    ds_read_b64_tr_b16 v[50:51], v19 offset:53760
    s_waitcnt lgkmcnt(8)
    v_mfma_f32_16x16x32_bf16 v[108:111], v[72:75], v[32:35], v[108:111]
    v_add_u32 v16, 65536, v16
    v_add_u32 v17, 65536, v17
    v_add_u32 v18, 65536, v18
    v_add_u32 v19, 65536, v19
    ds_read_b64_tr_b16 v[28:29], v16 offset:8192
    v_mfma_f32_16x16x32_bf16 v[156:159], v[76:79], v[32:35], v[156:159]
    ds_read_b64_tr_b16 v[30:31], v16 offset:8704
    s_waitcnt lgkmcnt(8)
    v_mfma_f32_16x16x32_bf16 v[112:115], v[72:75], v[36:39], v[112:115]
    ds_read_b64_tr_b16 v[32:33], v17 offset:8192
    v_mfma_f32_16x16x32_bf16 v[160:163], v[76:79], v[36:39], v[160:163]
    ds_read_b64_tr_b16 v[34:35], v17 offset:8704
    s_waitcnt lgkmcnt(8)
    v_mfma_f32_16x16x32_bf16 v[116:119], v[72:75], v[40:43], v[116:119]
    ds_read_b64_tr_b16 v[36:37], v18 offset:8192
    v_mfma_f32_16x16x32_bf16 v[164:167], v[76:79], v[40:43], v[164:167]
    ds_read_b64_tr_b16 v[38:39], v18 offset:8704
    s_waitcnt lgkmcnt(8)
    v_mfma_f32_16x16x32_bf16 v[120:123], v[72:75], v[44:47], v[120:123]
    ds_read_b64_tr_b16 v[40:41], v19 offset:8192
    v_mfma_f32_16x16x32_bf16 v[168:171], v[76:79], v[44:47], v[168:171]
    ds_read_b64_tr_b16 v[42:43], v19 offset:8704
    s_waitcnt lgkmcnt(8)
    v_mfma_f32_16x16x32_bf16 v[124:127], v[72:75], v[48:51], v[124:127]
    ds_read_b64_tr_b16 v[44:45], v16 offset:16384
    v_mfma_f32_16x16x32_bf16 v[172:175], v[76:79], v[48:51], v[172:175]
    ds_read_b64_tr_b16 v[46:47], v16 offset:16896
    s_waitcnt lgkmcnt(8)
    v_mfma_f32_16x16x32_bf16 v[80:83], v[28:31], v[64:67], v[80:83]
    ds_read_b64_tr_b16 v[48:49], v17 offset:16384
    v_mfma_f32_16x16x32_bf16 v[128:131], v[28:31], v[68:71], v[128:131]
    ds_read_b64_tr_b16 v[50:51], v17 offset:16896
    s_waitcnt lgkmcnt(8)
    v_mfma_f32_16x16x32_bf16 v[84:87], v[32:35], v[64:67], v[84:87]
    ds_read_b64_tr_b16 v[28:29], v18 offset:16384
    v_mfma_f32_16x16x32_bf16 v[132:135], v[32:35], v[68:71], v[132:135]
    ds_read_b64_tr_b16 v[30:31], v18 offset:16896
    ds_read_b128 v[72:75], v25 offset:57344
    ds_read_b128 v[76:79], v25 offset:59392
    s_waitcnt lgkmcnt(10)
    v_mfma_f32_16x16x32_bf16 v[88:91], v[36:39], v[64:67], v[88:91]
    ds_read_b64_tr_b16 v[32:33], v19 offset:16384
    v_mfma_f32_16x16x32_bf16 v[136:139], v[36:39], v[68:71], v[136:139]
    v_mfma_f32_16x16x32_bf16 v[176:179], v[64:67], a[24:27], v[176:179]
    ds_read_b64_tr_b16 v[34:35], v19 offset:16896
    s_mov_b32 s96, s18
    s_and_b32 s97, s19, 0xffff
    s_mov_b32 s98, 0x80000
    s_mov_b32 s99, 0x20000
    s_lshl_b32 s7, s2, 2
    s_add_u32 s7, s7, s48
    s_mul_i32 s7, s7, 512
    v_lshlrev_b32 v238, 7, v1
    s_mov_b32 exec_lo, 0xf
    s_mov_b32 exec_hi, 0
    buffer_load_dword v255, v238, s[96:99], s7 offen
    s_mov_b64 exec, -1
    s_mov_b32 s96, s12
    s_and_b32 s97, s13, 0xffff
    s_mov_b32 s98, 0x80000
    s_mov_b32 s99, 0x20000
    s_lshl_b32 s7, s2, 2
    s_add_u32 s7, s7, s48
    s_mul_i32 s7, s7, 512
    v_lshlrev_b32 v238, 7, v1
    s_mov_b32 exec_lo, 0xf
    s_mov_b32 exec_hi, 0
    buffer_load_dword v255, v238, s[96:99], s7 offen
    s_mov_b64 exec, -1
    s_mov_b32 s96, s20
    s_and_b32 s97, s21, 0xffff
    s_mov_b32 s98, 0x1c0000
    s_mov_b32 s99, 0x20000
    s_lshl_b32 s7, s2, 2
    s_add_u32 s7, s7, s48
    s_mul_i32 s7, s7, 1792
    v_lshlrev_b32 v238, 7, v1
    s_mov_b32 exec_lo, 0x3fff
    s_mov_b32 exec_hi, 0
    buffer_load_dword v255, v238, s[96:99], s7 offen
    s_mov_b64 exec, -1
    s_mov_b32 s96, s22
    s_and_b32 s97, s23, 0xffff
    s_mov_b32 s98, 0x1c0000
    s_mov_b32 s99, 0x20000
    s_lshl_b32 s7, s2, 2
    s_add_u32 s7, s7, s48
    s_mul_i32 s7, s7, 1792
    v_lshlrev_b32 v238, 7, v1
    s_mov_b32 exec_lo, 0x3fff
    s_mov_b32 exec_hi, 0
    buffer_load_dword v255, v238, s[96:99], s7 offen
    s_mov_b64 exec, -1
    s_waitcnt lgkmcnt(10)
    v_mfma_f32_16x16x32_bf16 v[92:95], v[40:43], v[64:67], v[92:95]
    ds_read_b64_tr_b16 v[36:37], v16 offset:24576
    v_mfma_f32_16x16x32_bf16 v[140:143], v[40:43], v[68:71], v[140:143]
    v_mfma_f32_16x16x32_bf16 v[180:183], v[68:71], a[24:27], v[180:183]
    ds_read_b64_tr_b16 v[38:39], v16 offset:25088
    s_waitcnt lgkmcnt(10)
    v_mfma_f32_16x16x32_bf16 v[96:99], v[64:67], v[44:47], v[96:99]
    ds_read_b64_tr_b16 v[40:41], v17 offset:24576
    v_mfma_f32_16x16x32_bf16 v[144:147], v[68:71], v[44:47], v[144:147]
    ds_read_b64_tr_b16 v[42:43], v17 offset:25088
    s_waitcnt lgkmcnt(10)
    v_mfma_f32_16x16x32_bf16 v[100:103], v[64:67], v[48:51], v[100:103]
    ds_read_b64_tr_b16 v[44:45], v18 offset:24576
    v_mfma_f32_16x16x32_bf16 v[148:151], v[68:71], v[48:51], v[148:151]
    ds_read_b64_tr_b16 v[46:47], v18 offset:25088
    s_waitcnt lgkmcnt(10)
    v_mfma_f32_16x16x32_bf16 v[104:107], v[64:67], v[28:31], v[104:107]
    ds_read_b64_tr_b16 v[48:49], v19 offset:24576
    v_mfma_f32_16x16x32_bf16 v[152:155], v[68:71], v[28:31], v[152:155]
    ds_read_b64_tr_b16 v[50:51], v19 offset:25088
    s_waitcnt lgkmcnt(8)
    v_mfma_f32_16x16x32_bf16 v[108:111], v[64:67], v[32:35], v[108:111]
    ds_read_b64_tr_b16 v[28:29], v16 offset:12288
    v_mfma_f32_16x16x32_bf16 v[156:159], v[68:71], v[32:35], v[156:159]
    ds_read_b64_tr_b16 v[30:31], v16 offset:12800
    s_waitcnt lgkmcnt(8)
    v_mfma_f32_16x16x32_bf16 v[112:115], v[64:67], v[36:39], v[112:115]
    ds_read_b64_tr_b16 v[32:33], v17 offset:12288
    v_mfma_f32_16x16x32_bf16 v[160:163], v[68:71], v[36:39], v[160:163]
    ds_read_b64_tr_b16 v[34:35], v17 offset:12800
    s_waitcnt lgkmcnt(8)
    v_mfma_f32_16x16x32_bf16 v[116:119], v[64:67], v[40:43], v[116:119]
    ds_read_b64_tr_b16 v[36:37], v18 offset:12288
    v_mfma_f32_16x16x32_bf16 v[164:167], v[68:71], v[40:43], v[164:167]
    ds_read_b64_tr_b16 v[38:39], v18 offset:12800
    s_waitcnt lgkmcnt(8)
    v_mfma_f32_16x16x32_bf16 v[120:123], v[64:67], v[44:47], v[120:123]
    ds_read_b64_tr_b16 v[40:41], v19 offset:12288
    v_mfma_f32_16x16x32_bf16 v[168:171], v[68:71], v[44:47], v[168:171]
    ds_read_b64_tr_b16 v[42:43], v19 offset:12800
    s_waitcnt lgkmcnt(8)
    v_mfma_f32_16x16x32_bf16 v[124:127], v[64:67], v[48:51], v[124:127]
    ds_read_b64_tr_b16 v[44:45], v16 offset:20480
    v_mfma_f32_16x16x32_bf16 v[172:175], v[68:71], v[48:51], v[172:175]
    ds_read_b64_tr_b16 v[46:47], v16 offset:20992
    s_waitcnt vmcnt(14)
    s_barrier
    s_waitcnt lgkmcnt(8)
    v_mfma_f32_16x16x32_bf16 v[80:83], v[28:31], v[72:75], v[80:83]
    ds_read_b64_tr_b16 v[48:49], v17 offset:20480
    v_mfma_f32_16x16x32_bf16 v[128:131], v[28:31], v[76:79], v[128:131]
    ds_read_b64_tr_b16 v[50:51], v17 offset:20992
    s_add_u32 s55, s68, 6
    s_and_b32 s55, s55, 7
    s_add_u32 m0, s66, 81920
    s_lshl_b32 s53, s55, 7
    s_add_u32 s53, s53, s64
    buffer_load_dwordx4 v52, s[32:35], s53 offen offset:0 lds
    buffer_load_dwordx4 v53, s[32:35], s53 offen offset:1024 lds
    buffer_load_dwordx4 v54, s[32:35], s53 offen offset:2048 lds
    buffer_load_dwordx4 v55, s[32:35], s53 offen offset:3072 lds
    s_waitcnt lgkmcnt(8)
    v_mfma_f32_16x16x32_bf16 v[84:87], v[32:35], v[72:75], v[84:87]
    ds_read_b64_tr_b16 v[28:29], v18 offset:20480
    v_mfma_f32_16x16x32_bf16 v[132:135], v[32:35], v[76:79], v[132:135]
    ds_read_b64_tr_b16 v[30:31], v18 offset:20992
    v_subrev_u32 v24, 65536, v24
    v_subrev_u32 v25, 65536, v25
    ds_read_b128 v[64:67], v24 offset:0
    ds_read_b128 v[68:71], v24 offset:2048
    s_waitcnt lgkmcnt(10)
    v_mfma_f32_16x16x32_bf16 v[88:91], v[36:39], v[72:75], v[88:91]
    ds_read_b64_tr_b16 v[32:33], v19 offset:20480
    v_mfma_f32_16x16x32_bf16 v[136:139], v[36:39], v[76:79], v[136:139]
    v_mfma_f32_16x16x32_bf16 v[176:179], v[72:75], a[28:31], v[176:179]
    ds_read_b64_tr_b16 v[34:35], v19 offset:20992
    s_add_u32 s55, s68, 6
    s_and_b32 s55, s55, 7
    s_mul_i32 s55, s55, 196608
    s_add_u32 s55, s55, s65
    s_add_u32 m0, s67, 98304
    s_add_u32 s54, s55, 0
    buffer_load_dwordx4 v56, s[36:39], s54 offen offset:0 lds
    buffer_load_dwordx4 v57, s[36:39], s54 offen offset:1024 lds
    s_add_u32 m0, s67, 106496
    s_add_u32 s54, s55, 1024
    buffer_load_dwordx4 v56, s[36:39], s54 offen offset:0 lds
    buffer_load_dwordx4 v57, s[36:39], s54 offen offset:1024 lds
    s_add_u32 m0, s67, 114688
    s_add_u32 s54, s55, 2048
    buffer_load_dwordx4 v56, s[36:39], s54 offen offset:0 lds
    buffer_load_dwordx4 v57, s[36:39], s54 offen offset:1024 lds
    s_waitcnt lgkmcnt(10)
    v_mfma_f32_16x16x32_bf16 v[92:95], v[40:43], v[72:75], v[92:95]
    ds_read_b64_tr_b16 v[36:37], v16 offset:28672
    v_mfma_f32_16x16x32_bf16 v[140:143], v[40:43], v[76:79], v[140:143]
    v_mfma_f32_16x16x32_bf16 v[180:183], v[76:79], a[28:31], v[180:183]
    ds_read_b64_tr_b16 v[38:39], v16 offset:29184
    s_waitcnt lgkmcnt(10)
    v_mfma_f32_16x16x32_bf16 v[96:99], v[72:75], v[44:47], v[96:99]
    ds_read_b64_tr_b16 v[40:41], v17 offset:28672
    v_mfma_f32_16x16x32_bf16 v[144:147], v[76:79], v[44:47], v[144:147]
    ds_read_b64_tr_b16 v[42:43], v17 offset:29184
    s_waitcnt lgkmcnt(10)
    v_mfma_f32_16x16x32_bf16 v[100:103], v[72:75], v[48:51], v[100:103]
    ds_read_b64_tr_b16 v[44:45], v18 offset:28672
    v_mfma_f32_16x16x32_bf16 v[148:151], v[76:79], v[48:51], v[148:151]
    ds_read_b64_tr_b16 v[46:47], v18 offset:29184
    s_waitcnt lgkmcnt(10)
    v_mfma_f32_16x16x32_bf16 v[104:107], v[72:75], v[28:31], v[104:107]
    ds_read_b64_tr_b16 v[48:49], v19 offset:28672
    v_mfma_f32_16x16x32_bf16 v[152:155], v[76:79], v[28:31], v[152:155]
    ds_read_b64_tr_b16 v[50:51], v19 offset:29184
    s_waitcnt lgkmcnt(8)
    v_mfma_f32_16x16x32_bf16 v[108:111], v[72:75], v[32:35], v[108:111]
    v_subrev_u32 v16, 131072, v16
    v_subrev_u32 v17, 131072, v17
    v_subrev_u32 v18, 131072, v18
    v_subrev_u32 v19, 131072, v19
    ds_read_b64_tr_b16 v[28:29], v16 offset:16384
    v_mfma_f32_16x16x32_bf16 v[156:159], v[76:79], v[32:35], v[156:159]
    ds_read_b64_tr_b16 v[30:31], v16 offset:16896
    s_waitcnt lgkmcnt(8)
    v_mfma_f32_16x16x32_bf16 v[112:115], v[72:75], v[36:39], v[112:115]
    ds_read_b64_tr_b16 v[32:33], v17 offset:16384
    v_mfma_f32_16x16x32_bf16 v[160:163], v[76:79], v[36:39], v[160:163]
    ds_read_b64_tr_b16 v[34:35], v17 offset:16896
    s_waitcnt lgkmcnt(8)
    v_mfma_f32_16x16x32_bf16 v[116:119], v[72:75], v[40:43], v[116:119]
    ds_read_b64_tr_b16 v[36:37], v18 offset:16384
    v_mfma_f32_16x16x32_bf16 v[164:167], v[76:79], v[40:43], v[164:167]
    ds_read_b64_tr_b16 v[38:39], v18 offset:16896
    s_waitcnt lgkmcnt(8)
    v_mfma_f32_16x16x32_bf16 v[120:123], v[72:75], v[44:47], v[120:123]
    ds_read_b64_tr_b16 v[40:41], v19 offset:16384
    v_mfma_f32_16x16x32_bf16 v[168:171], v[76:79], v[44:47], v[168:171]
    ds_read_b64_tr_b16 v[42:43], v19 offset:16896
    s_waitcnt lgkmcnt(8)
    v_mfma_f32_16x16x32_bf16 v[124:127], v[72:75], v[48:51], v[124:127]
    ds_read_b64_tr_b16 v[44:45], v16 offset:24576
    v_mfma_f32_16x16x32_bf16 v[172:175], v[76:79], v[48:51], v[172:175]
    ds_read_b64_tr_b16 v[46:47], v16 offset:25088
    s_waitcnt lgkmcnt(8)
    v_mfma_f32_16x16x32_bf16 v[80:83], v[28:31], v[64:67], v[80:83]
    ds_read_b64_tr_b16 v[48:49], v17 offset:24576
    v_mfma_f32_16x16x32_bf16 v[128:131], v[28:31], v[68:71], v[128:131]
    ds_read_b64_tr_b16 v[50:51], v17 offset:25088
    s_waitcnt lgkmcnt(8)
    v_mfma_f32_16x16x32_bf16 v[84:87], v[32:35], v[64:67], v[84:87]
    ds_read_b64_tr_b16 v[28:29], v18 offset:24576
    v_mfma_f32_16x16x32_bf16 v[132:135], v[32:35], v[68:71], v[132:135]
    ds_read_b64_tr_b16 v[30:31], v18 offset:25088
    ds_read_b128 v[72:75], v25 offset:0
    ds_read_b128 v[76:79], v25 offset:2048
    s_waitcnt lgkmcnt(10)
    v_mfma_f32_16x16x32_bf16 v[88:91], v[36:39], v[64:67], v[88:91]
    ds_read_b64_tr_b16 v[32:33], v19 offset:24576
    v_mfma_f32_16x16x32_bf16 v[136:139], v[36:39], v[68:71], v[136:139]
    v_mfma_f32_16x16x32_bf16 v[176:179], v[64:67], a[32:35], v[176:179]
    ds_read_b64_tr_b16 v[34:35], v19 offset:25088
    s_waitcnt lgkmcnt(10)
    v_mfma_f32_16x16x32_bf16 v[92:95], v[40:43], v[64:67], v[92:95]
    ds_read_b64_tr_b16 v[36:37], v16 offset:32768
    v_mfma_f32_16x16x32_bf16 v[140:143], v[40:43], v[68:71], v[140:143]
    v_mfma_f32_16x16x32_bf16 v[180:183], v[68:71], a[32:35], v[180:183]
    ds_read_b64_tr_b16 v[38:39], v16 offset:33280
    s_waitcnt lgkmcnt(10)
    v_mfma_f32_16x16x32_bf16 v[96:99], v[64:67], v[44:47], v[96:99]
    ds_read_b64_tr_b16 v[40:41], v17 offset:32768
    v_mfma_f32_16x16x32_bf16 v[144:147], v[68:71], v[44:47], v[144:147]
    ds_read_b64_tr_b16 v[42:43], v17 offset:33280
    s_waitcnt lgkmcnt(10)
    v_mfma_f32_16x16x32_bf16 v[100:103], v[64:67], v[48:51], v[100:103]
    ds_read_b64_tr_b16 v[44:45], v18 offset:32768
    v_mfma_f32_16x16x32_bf16 v[148:151], v[68:71], v[48:51], v[148:151]
    ds_read_b64_tr_b16 v[46:47], v18 offset:33280
    s_waitcnt lgkmcnt(10)
    v_mfma_f32_16x16x32_bf16 v[104:107], v[64:67], v[28:31], v[104:107]
    ds_read_b64_tr_b16 v[48:49], v19 offset:32768
    v_mfma_f32_16x16x32_bf16 v[152:155], v[68:71], v[28:31], v[152:155]
    ds_read_b64_tr_b16 v[50:51], v19 offset:33280
    s_waitcnt lgkmcnt(8)
    v_mfma_f32_16x16x32_bf16 v[108:111], v[64:67], v[32:35], v[108:111]
    ds_read_b64_tr_b16 v[28:29], v16 offset:20480
    v_mfma_f32_16x16x32_bf16 v[156:159], v[68:71], v[32:35], v[156:159]
    ds_read_b64_tr_b16 v[30:31], v16 offset:20992
    s_waitcnt lgkmcnt(8)
    v_mfma_f32_16x16x32_bf16 v[112:115], v[64:67], v[36:39], v[112:115]
    ds_read_b64_tr_b16 v[32:33], v17 offset:20480
    v_mfma_f32_16x16x32_bf16 v[160:163], v[68:71], v[36:39], v[160:163]
    ds_read_b64_tr_b16 v[34:35], v17 offset:20992
    s_waitcnt lgkmcnt(8)
    v_mfma_f32_16x16x32_bf16 v[116:119], v[64:67], v[40:43], v[116:119]
    ds_read_b64_tr_b16 v[36:37], v18 offset:20480
    v_mfma_f32_16x16x32_bf16 v[164:167], v[68:71], v[40:43], v[164:167]
    ds_read_b64_tr_b16 v[38:39], v18 offset:20992
    s_waitcnt lgkmcnt(8)
    v_mfma_f32_16x16x32_bf16 v[120:123], v[64:67], v[44:47], v[120:123]
    ds_read_b64_tr_b16 v[40:41], v19 offset:20480
    v_mfma_f32_16x16x32_bf16 v[168:171], v[68:71], v[44:47], v[168:171]
    ds_read_b64_tr_b16 v[42:43], v19 offset:20992
    s_waitcnt lgkmcnt(8)
    v_mfma_f32_16x16x32_bf16 v[124:127], v[64:67], v[48:51], v[124:127]
    ds_read_b64_tr_b16 v[44:45], v16 offset:28672
    v_mfma_f32_16x16x32_bf16 v[172:175], v[68:71], v[48:51], v[172:175]
    ds_read_b64_tr_b16 v[46:47], v16 offset:29184
    s_waitcnt vmcnt(14)
    s_barrier
    s_waitcnt lgkmcnt(8)
    v_mfma_f32_16x16x32_bf16 v[80:83], v[28:31], v[72:75], v[80:83]
    ds_read_b64_tr_b16 v[48:49], v17 offset:28672
    v_mfma_f32_16x16x32_bf16 v[128:131], v[28:31], v[76:79], v[128:131]
    ds_read_b64_tr_b16 v[50:51], v17 offset:29184
    s_add_u32 s55, s68, 7
    s_and_b32 s55, s55, 7
    s_add_u32 m0, s66, 122880
    s_lshl_b32 s53, s55, 7
    s_add_u32 s53, s53, s64
    buffer_load_dwordx4 v52, s[32:35], s53 offen offset:0 lds
    buffer_load_dwordx4 v53, s[32:35], s53 offen offset:1024 lds
    buffer_load_dwordx4 v54, s[32:35], s53 offen offset:2048 lds
    buffer_load_dwordx4 v55, s[32:35], s53 offen offset:3072 lds
    s_waitcnt lgkmcnt(8)
    v_mfma_f32_16x16x32_bf16 v[84:87], v[32:35], v[72:75], v[84:87]
    ds_read_b64_tr_b16 v[28:29], v18 offset:28672
    v_mfma_f32_16x16x32_bf16 v[132:135], v[32:35], v[76:79], v[132:135]
    ds_read_b64_tr_b16 v[30:31], v18 offset:29184
    ds_read_b128 v[64:67], v24 offset:40960
    ds_read_b128 v[68:71], v24 offset:43008
    s_waitcnt lgkmcnt(10)
    v_mfma_f32_16x16x32_bf16 v[88:91], v[36:39], v[72:75], v[88:91]
    ds_read_b64_tr_b16 v[32:33], v19 offset:28672
    v_mfma_f32_16x16x32_bf16 v[136:139], v[36:39], v[76:79], v[136:139]
    v_mfma_f32_16x16x32_bf16 v[176:179], v[72:75], a[36:39], v[176:179]
    ds_read_b64_tr_b16 v[34:35], v19 offset:29184
    s_add_u32 s55, s68, 7
    s_and_b32 s55, s55, 7
    s_mul_i32 s55, s55, 196608
    s_add_u32 s55, s55, s65
    s_add_u32 m0, s67, 139264
    s_add_u32 s54, s55, 0
    buffer_load_dwordx4 v56, s[36:39], s54 offen offset:0 lds
    buffer_load_dwordx4 v57, s[36:39], s54 offen offset:1024 lds
    s_add_u32 m0, s67, 147456
    s_add_u32 s54, s55, 1024
    buffer_load_dwordx4 v56, s[36:39], s54 offen offset:0 lds
    buffer_load_dwordx4 v57, s[36:39], s54 offen offset:1024 lds
    s_add_u32 m0, s67, 155648
    s_add_u32 s54, s55, 2048
    buffer_load_dwordx4 v56, s[36:39], s54 offen offset:0 lds
    buffer_load_dwordx4 v57, s[36:39], s54 offen offset:1024 lds
    s_waitcnt lgkmcnt(10)
    v_mfma_f32_16x16x32_bf16 v[92:95], v[40:43], v[72:75], v[92:95]
    ds_read_b64_tr_b16 v[36:37], v16 offset:36864
    v_mfma_f32_16x16x32_bf16 v[140:143], v[40:43], v[76:79], v[140:143]
    v_mfma_f32_16x16x32_bf16 v[180:183], v[76:79], a[36:39], v[180:183]
    ds_read_b64_tr_b16 v[38:39], v16 offset:37376
    s_waitcnt lgkmcnt(10)
    v_mfma_f32_16x16x32_bf16 v[96:99], v[72:75], v[44:47], v[96:99]
    ds_read_b64_tr_b16 v[40:41], v17 offset:36864
    v_mfma_f32_16x16x32_bf16 v[144:147], v[76:79], v[44:47], v[144:147]
    ds_read_b64_tr_b16 v[42:43], v17 offset:37376
    s_waitcnt lgkmcnt(10)
    v_mfma_f32_16x16x32_bf16 v[100:103], v[72:75], v[48:51], v[100:103]
    ds_read_b64_tr_b16 v[44:45], v18 offset:36864
    v_mfma_f32_16x16x32_bf16 v[148:151], v[76:79], v[48:51], v[148:151]
    ds_read_b64_tr_b16 v[46:47], v18 offset:37376
    s_waitcnt lgkmcnt(10)
    v_mfma_f32_16x16x32_bf16 v[104:107], v[72:75], v[28:31], v[104:107]
    ds_read_b64_tr_b16 v[48:49], v19 offset:36864
    v_mfma_f32_16x16x32_bf16 v[152:155], v[76:79], v[28:31], v[152:155]
    ds_read_b64_tr_b16 v[50:51], v19 offset:37376
    s_waitcnt lgkmcnt(8)
    v_mfma_f32_16x16x32_bf16 v[108:111], v[72:75], v[32:35], v[108:111]
    ds_read_b64_tr_b16 v[28:29], v16 offset:57344
    v_mfma_f32_16x16x32_bf16 v[156:159], v[76:79], v[32:35], v[156:159]
    ds_read_b64_tr_b16 v[30:31], v16 offset:57856
    s_waitcnt lgkmcnt(8)
    v_mfma_f32_16x16x32_bf16 v[112:115], v[72:75], v[36:39], v[112:115]
    ds_read_b64_tr_b16 v[32:33], v17 offset:57344
    v_mfma_f32_16x16x32_bf16 v[160:163], v[76:79], v[36:39], v[160:163]
    ds_read_b64_tr_b16 v[34:35], v17 offset:57856
    s_waitcnt lgkmcnt(8)
    v_mfma_f32_16x16x32_bf16 v[116:119], v[72:75], v[40:43], v[116:119]
    ds_read_b64_tr_b16 v[36:37], v18 offset:57344
    v_mfma_f32_16x16x32_bf16 v[164:167], v[76:79], v[40:43], v[164:167]
    ds_read_b64_tr_b16 v[38:39], v18 offset:57856
    s_waitcnt lgkmcnt(8)
    v_mfma_f32_16x16x32_bf16 v[120:123], v[72:75], v[44:47], v[120:123]
    ds_read_b64_tr_b16 v[40:41], v19 offset:57344
    v_mfma_f32_16x16x32_bf16 v[168:171], v[76:79], v[44:47], v[168:171]
    ds_read_b64_tr_b16 v[42:43], v19 offset:57856
    s_waitcnt lgkmcnt(8)
    v_mfma_f32_16x16x32_bf16 v[124:127], v[72:75], v[48:51], v[124:127]
    v_add_u32 v16, 65536, v16
    v_add_u32 v17, 65536, v17
    v_add_u32 v18, 65536, v18
    v_add_u32 v19, 65536, v19
    ds_read_b64_tr_b16 v[44:45], v16 offset:0
    v_mfma_f32_16x16x32_bf16 v[172:175], v[76:79], v[48:51], v[172:175]
    ds_read_b64_tr_b16 v[46:47], v16 offset:512
    s_mov_b32 s44, s28
    s_and_b32 s45, s29, 0xffff
    s_mov_b32 s46, 0x100
    s_mov_b32 s47, 0x20000
    v_mov_b32 v232, 128
    buffer_load_dword v234, v232, s[44:47], 0 offen sc1
    s_waitcnt lgkmcnt(8)
    v_mfma_f32_16x16x32_bf16 v[80:83], v[28:31], v[64:67], v[80:83]
    ds_read_b64_tr_b16 v[48:49], v17 offset:0
    v_mfma_f32_16x16x32_bf16 v[128:131], v[28:31], v[68:71], v[128:131]
    ds_read_b64_tr_b16 v[50:51], v17 offset:512
    s_waitcnt lgkmcnt(8)
    v_mfma_f32_16x16x32_bf16 v[84:87], v[32:35], v[64:67], v[84:87]
    ds_read_b64_tr_b16 v[28:29], v18 offset:0
    v_mfma_f32_16x16x32_bf16 v[132:135], v[32:35], v[68:71], v[132:135]
    ds_read_b64_tr_b16 v[30:31], v18 offset:512
    ds_read_b128 v[72:75], v25 offset:40960
    ds_read_b128 v[76:79], v25 offset:43008
    s_waitcnt lgkmcnt(10)
    v_mfma_f32_16x16x32_bf16 v[88:91], v[36:39], v[64:67], v[88:91]
    ds_read_b64_tr_b16 v[32:33], v19 offset:0
    v_mfma_f32_16x16x32_bf16 v[136:139], v[36:39], v[68:71], v[136:139]
    v_mfma_f32_16x16x32_bf16 v[176:179], v[64:67], a[40:43], v[176:179]
    ds_read_b64_tr_b16 v[34:35], v19 offset:512
    s_waitcnt lgkmcnt(10)
    v_mfma_f32_16x16x32_bf16 v[92:95], v[40:43], v[64:67], v[92:95]
    ds_read_b64_tr_b16 v[36:37], v16 offset:8192
    v_mfma_f32_16x16x32_bf16 v[140:143], v[40:43], v[68:71], v[140:143]
    v_mfma_f32_16x16x32_bf16 v[180:183], v[68:71], a[40:43], v[180:183]
    ds_read_b64_tr_b16 v[38:39], v16 offset:8704
    s_waitcnt lgkmcnt(10)
    v_mfma_f32_16x16x32_bf16 v[96:99], v[64:67], v[44:47], v[96:99]
    ds_read_b64_tr_b16 v[40:41], v17 offset:8192
    v_mfma_f32_16x16x32_bf16 v[144:147], v[68:71], v[44:47], v[144:147]
    ds_read_b64_tr_b16 v[42:43], v17 offset:8704
    s_waitcnt lgkmcnt(10)
    v_mfma_f32_16x16x32_bf16 v[100:103], v[64:67], v[48:51], v[100:103]
    ds_read_b64_tr_b16 v[44:45], v18 offset:8192
    v_mfma_f32_16x16x32_bf16 v[148:151], v[68:71], v[48:51], v[148:151]
    ds_read_b64_tr_b16 v[46:47], v18 offset:8704
    s_waitcnt lgkmcnt(10)
    v_mfma_f32_16x16x32_bf16 v[104:107], v[64:67], v[28:31], v[104:107]
    ds_read_b64_tr_b16 v[48:49], v19 offset:8192
    v_mfma_f32_16x16x32_bf16 v[152:155], v[68:71], v[28:31], v[152:155]
    ds_read_b64_tr_b16 v[50:51], v19 offset:8704
    s_waitcnt lgkmcnt(8)
    v_mfma_f32_16x16x32_bf16 v[108:111], v[64:67], v[32:35], v[108:111]
    v_subrev_u32 v16, 65536, v16
    v_subrev_u32 v17, 65536, v17
    v_subrev_u32 v18, 65536, v18
    v_subrev_u32 v19, 65536, v19
    ds_read_b64_tr_b16 v[28:29], v16 offset:61440
    v_mfma_f32_16x16x32_bf16 v[156:159], v[68:71], v[32:35], v[156:159]
    ds_read_b64_tr_b16 v[30:31], v16 offset:61952
    s_waitcnt lgkmcnt(8)
    v_mfma_f32_16x16x32_bf16 v[112:115], v[64:67], v[36:39], v[112:115]
    ds_read_b64_tr_b16 v[32:33], v17 offset:61440
    v_mfma_f32_16x16x32_bf16 v[160:163], v[68:71], v[36:39], v[160:163]
    ds_read_b64_tr_b16 v[34:35], v17 offset:61952
    s_waitcnt lgkmcnt(8)
    v_mfma_f32_16x16x32_bf16 v[116:119], v[64:67], v[40:43], v[116:119]
    ds_read_b64_tr_b16 v[36:37], v18 offset:61440
    v_mfma_f32_16x16x32_bf16 v[164:167], v[68:71], v[40:43], v[164:167]
    ds_read_b64_tr_b16 v[38:39], v18 offset:61952
    s_waitcnt lgkmcnt(8)
    v_mfma_f32_16x16x32_bf16 v[120:123], v[64:67], v[44:47], v[120:123]
    ds_read_b64_tr_b16 v[40:41], v19 offset:61440
    v_mfma_f32_16x16x32_bf16 v[168:171], v[68:71], v[44:47], v[168:171]
    ds_read_b64_tr_b16 v[42:43], v19 offset:61952
    s_waitcnt lgkmcnt(8)
    v_mfma_f32_16x16x32_bf16 v[124:127], v[64:67], v[48:51], v[124:127]
    v_add_u32 v16, 65536, v16
    v_add_u32 v17, 65536, v17
    v_add_u32 v18, 65536, v18
    v_add_u32 v19, 65536, v19
    ds_read_b64_tr_b16 v[44:45], v16 offset:4096
    v_mfma_f32_16x16x32_bf16 v[172:175], v[68:71], v[48:51], v[172:175]
    ds_read_b64_tr_b16 v[46:47], v16 offset:4608
    s_waitcnt vmcnt(11)
    s_barrier
    s_waitcnt lgkmcnt(8)
    v_mfma_f32_16x16x32_bf16 v[80:83], v[28:31], v[72:75], v[80:83]
    ds_read_b64_tr_b16 v[48:49], v17 offset:4096
    v_mfma_f32_16x16x32_bf16 v[128:131], v[28:31], v[76:79], v[128:131]
    ds_read_b64_tr_b16 v[50:51], v17 offset:4608
    s_waitcnt lgkmcnt(8)
    v_mfma_f32_16x16x32_bf16 v[84:87], v[32:35], v[72:75], v[84:87]
    ds_read_b64_tr_b16 v[28:29], v18 offset:4096
    v_mfma_f32_16x16x32_bf16 v[132:135], v[32:35], v[76:79], v[132:135]
    ds_read_b64_tr_b16 v[30:31], v18 offset:4608
    v_add_u32 v24, 65536, v24
    v_add_u32 v25, 65536, v25
    ds_read_b128 v[64:67], v24 offset:16384
    ds_read_b128 v[68:71], v24 offset:18432
    s_waitcnt lgkmcnt(10)
    v_mfma_f32_16x16x32_bf16 v[88:91], v[36:39], v[72:75], v[88:91]
    ds_read_b64_tr_b16 v[32:33], v19 offset:4096
    v_mfma_f32_16x16x32_bf16 v[136:139], v[36:39], v[76:79], v[136:139]
    v_mfma_f32_16x16x32_bf16 v[176:179], v[72:75], a[44:47], v[176:179]
    ds_read_b64_tr_b16 v[34:35], v19 offset:4608
    s_waitcnt lgkmcnt(10)
    v_mfma_f32_16x16x32_bf16 v[92:95], v[40:43], v[72:75], v[92:95]
    ds_read_b64_tr_b16 v[36:37], v16 offset:12288
    v_mfma_f32_16x16x32_bf16 v[140:143], v[40:43], v[76:79], v[140:143]
    v_mfma_f32_16x16x32_bf16 v[180:183], v[76:79], a[44:47], v[180:183]
    ds_read_b64_tr_b16 v[38:39], v16 offset:12800
    s_waitcnt lgkmcnt(10)
    v_mfma_f32_16x16x32_bf16 v[96:99], v[72:75], v[44:47], v[96:99]
    ds_read_b64_tr_b16 v[40:41], v17 offset:12288
    v_mfma_f32_16x16x32_bf16 v[144:147], v[76:79], v[44:47], v[144:147]
    ds_read_b64_tr_b16 v[42:43], v17 offset:12800
    s_waitcnt lgkmcnt(10)
    v_mfma_f32_16x16x32_bf16 v[100:103], v[72:75], v[48:51], v[100:103]
    ds_read_b64_tr_b16 v[44:45], v18 offset:12288
    v_mfma_f32_16x16x32_bf16 v[148:151], v[76:79], v[48:51], v[148:151]
    ds_read_b64_tr_b16 v[46:47], v18 offset:12800
    s_waitcnt lgkmcnt(10)
    v_mfma_f32_16x16x32_bf16 v[104:107], v[72:75], v[28:31], v[104:107]
    ds_read_b64_tr_b16 v[48:49], v19 offset:12288
    v_mfma_f32_16x16x32_bf16 v[152:155], v[76:79], v[28:31], v[152:155]
    ds_read_b64_tr_b16 v[50:51], v19 offset:12800
    s_waitcnt lgkmcnt(8)
    v_mfma_f32_16x16x32_bf16 v[108:111], v[72:75], v[32:35], v[108:111]
    ds_read_b64_tr_b16 v[28:29], v16 offset:32768
    v_mfma_f32_16x16x32_bf16 v[156:159], v[76:79], v[32:35], v[156:159]
    ds_read_b64_tr_b16 v[30:31], v16 offset:33280
    s_waitcnt lgkmcnt(8)
    v_mfma_f32_16x16x32_bf16 v[112:115], v[72:75], v[36:39], v[112:115]
    ds_read_b64_tr_b16 v[32:33], v17 offset:32768
    v_mfma_f32_16x16x32_bf16 v[160:163], v[76:79], v[36:39], v[160:163]
    ds_read_b64_tr_b16 v[34:35], v17 offset:33280
    s_waitcnt lgkmcnt(8)
    v_mfma_f32_16x16x32_bf16 v[116:119], v[72:75], v[40:43], v[116:119]
    ds_read_b64_tr_b16 v[36:37], v18 offset:32768
    v_mfma_f32_16x16x32_bf16 v[164:167], v[76:79], v[40:43], v[164:167]
    ds_read_b64_tr_b16 v[38:39], v18 offset:33280
    s_waitcnt lgkmcnt(8)
    v_mfma_f32_16x16x32_bf16 v[120:123], v[72:75], v[44:47], v[120:123]
    ds_read_b64_tr_b16 v[40:41], v19 offset:32768
    v_mfma_f32_16x16x32_bf16 v[168:171], v[76:79], v[44:47], v[168:171]
    ds_read_b64_tr_b16 v[42:43], v19 offset:33280
    s_waitcnt lgkmcnt(8)
    v_mfma_f32_16x16x32_bf16 v[124:127], v[72:75], v[48:51], v[124:127]
    ds_read_b64_tr_b16 v[44:45], v16 offset:40960
    v_mfma_f32_16x16x32_bf16 v[172:175], v[76:79], v[48:51], v[172:175]
    ds_read_b64_tr_b16 v[46:47], v16 offset:41472
    s_waitcnt lgkmcnt(8)
    v_mfma_f32_16x16x32_bf16 v[80:83], v[28:31], v[64:67], v[80:83]
    ds_read_b64_tr_b16 v[48:49], v17 offset:40960
    v_mfma_f32_16x16x32_bf16 v[128:131], v[28:31], v[68:71], v[128:131]
    ds_read_b64_tr_b16 v[50:51], v17 offset:41472
    s_waitcnt lgkmcnt(8)
    v_mfma_f32_16x16x32_bf16 v[84:87], v[32:35], v[64:67], v[84:87]
    ds_read_b64_tr_b16 v[28:29], v18 offset:40960
    v_mfma_f32_16x16x32_bf16 v[132:135], v[32:35], v[68:71], v[132:135]
    ds_read_b64_tr_b16 v[30:31], v18 offset:41472
    ds_read_b128 v[72:75], v25 offset:16384
    ds_read_b128 v[76:79], v25 offset:18432
    s_waitcnt lgkmcnt(10)
    v_mfma_f32_16x16x32_bf16 v[88:91], v[36:39], v[64:67], v[88:91]
    ds_read_b64_tr_b16 v[32:33], v19 offset:40960
    v_mfma_f32_16x16x32_bf16 v[136:139], v[36:39], v[68:71], v[136:139]
    v_mfma_f32_16x16x32_bf16 v[176:179], v[64:67], a[48:51], v[176:179]
    ds_read_b64_tr_b16 v[34:35], v19 offset:41472
    s_waitcnt lgkmcnt(10)
    v_mfma_f32_16x16x32_bf16 v[92:95], v[40:43], v[64:67], v[92:95]
    ds_read_b64_tr_b16 v[36:37], v16 offset:49152
    v_mfma_f32_16x16x32_bf16 v[140:143], v[40:43], v[68:71], v[140:143]
    v_mfma_f32_16x16x32_bf16 v[180:183], v[68:71], a[48:51], v[180:183]
    ds_read_b64_tr_b16 v[38:39], v16 offset:49664
    s_waitcnt lgkmcnt(10)
    v_mfma_f32_16x16x32_bf16 v[96:99], v[64:67], v[44:47], v[96:99]
    ds_read_b64_tr_b16 v[40:41], v17 offset:49152
    v_mfma_f32_16x16x32_bf16 v[144:147], v[68:71], v[44:47], v[144:147]
    ds_read_b64_tr_b16 v[42:43], v17 offset:49664
    s_waitcnt lgkmcnt(10)
    v_mfma_f32_16x16x32_bf16 v[100:103], v[64:67], v[48:51], v[100:103]
    ds_read_b64_tr_b16 v[44:45], v18 offset:49152
    v_mfma_f32_16x16x32_bf16 v[148:151], v[68:71], v[48:51], v[148:151]
    ds_read_b64_tr_b16 v[46:47], v18 offset:49664
    s_waitcnt lgkmcnt(10)
    v_mfma_f32_16x16x32_bf16 v[104:107], v[64:67], v[28:31], v[104:107]
    ds_read_b64_tr_b16 v[48:49], v19 offset:49152
    v_mfma_f32_16x16x32_bf16 v[152:155], v[68:71], v[28:31], v[152:155]
    ds_read_b64_tr_b16 v[50:51], v19 offset:49664
    s_waitcnt lgkmcnt(8)
    v_mfma_f32_16x16x32_bf16 v[108:111], v[64:67], v[32:35], v[108:111]
    ds_read_b64_tr_b16 v[28:29], v16 offset:36864
    v_mfma_f32_16x16x32_bf16 v[156:159], v[68:71], v[32:35], v[156:159]
    ds_read_b64_tr_b16 v[30:31], v16 offset:37376
    s_waitcnt lgkmcnt(8)
    v_mfma_f32_16x16x32_bf16 v[112:115], v[64:67], v[36:39], v[112:115]
    ds_read_b64_tr_b16 v[32:33], v17 offset:36864
    v_mfma_f32_16x16x32_bf16 v[160:163], v[68:71], v[36:39], v[160:163]
    ds_read_b64_tr_b16 v[34:35], v17 offset:37376
    s_waitcnt lgkmcnt(8)
    v_mfma_f32_16x16x32_bf16 v[116:119], v[64:67], v[40:43], v[116:119]
    ds_read_b64_tr_b16 v[36:37], v18 offset:36864
    v_mfma_f32_16x16x32_bf16 v[164:167], v[68:71], v[40:43], v[164:167]
    ds_read_b64_tr_b16 v[38:39], v18 offset:37376
    s_waitcnt lgkmcnt(8)
    v_mfma_f32_16x16x32_bf16 v[120:123], v[64:67], v[44:47], v[120:123]
    ds_read_b64_tr_b16 v[40:41], v19 offset:36864
    v_mfma_f32_16x16x32_bf16 v[168:171], v[68:71], v[44:47], v[168:171]
    ds_read_b64_tr_b16 v[42:43], v19 offset:37376
    s_waitcnt lgkmcnt(8)
    v_mfma_f32_16x16x32_bf16 v[124:127], v[64:67], v[48:51], v[124:127]
    ds_read_b64_tr_b16 v[44:45], v16 offset:45056
    v_mfma_f32_16x16x32_bf16 v[172:175], v[68:71], v[48:51], v[172:175]
    ds_read_b64_tr_b16 v[46:47], v16 offset:45568
    s_waitcnt vmcnt(1)
    s_barrier
    s_waitcnt lgkmcnt(8)
    v_mfma_f32_16x16x32_bf16 v[80:83], v[28:31], v[72:75], v[80:83]
    ds_read_b64_tr_b16 v[48:49], v17 offset:45056
    v_mfma_f32_16x16x32_bf16 v[128:131], v[28:31], v[76:79], v[128:131]
    ds_read_b64_tr_b16 v[50:51], v17 offset:45568
    s_waitcnt lgkmcnt(8)
    v_mfma_f32_16x16x32_bf16 v[84:87], v[32:35], v[72:75], v[84:87]
    ds_read_b64_tr_b16 v[28:29], v18 offset:45056
    v_mfma_f32_16x16x32_bf16 v[132:135], v[32:35], v[76:79], v[132:135]
    ds_read_b64_tr_b16 v[30:31], v18 offset:45568
    ds_read_b128 v[64:67], v24 offset:57344
    ds_read_b128 v[68:71], v24 offset:59392
    s_waitcnt lgkmcnt(10)
    v_mfma_f32_16x16x32_bf16 v[88:91], v[36:39], v[72:75], v[88:91]
    ds_read_b64_tr_b16 v[32:33], v19 offset:45056
    v_mfma_f32_16x16x32_bf16 v[136:139], v[36:39], v[76:79], v[136:139]
    v_mfma_f32_16x16x32_bf16 v[176:179], v[72:75], a[52:55], v[176:179]
    ds_read_b64_tr_b16 v[34:35], v19 offset:45568
    s_waitcnt lgkmcnt(10)
    v_mfma_f32_16x16x32_bf16 v[92:95], v[40:43], v[72:75], v[92:95]
    ds_read_b64_tr_b16 v[36:37], v16 offset:53248
    v_mfma_f32_16x16x32_bf16 v[140:143], v[40:43], v[76:79], v[140:143]
    v_mfma_f32_16x16x32_bf16 v[180:183], v[76:79], a[52:55], v[180:183]
    ds_read_b64_tr_b16 v[38:39], v16 offset:53760
    s_waitcnt lgkmcnt(10)
    v_mfma_f32_16x16x32_bf16 v[96:99], v[72:75], v[44:47], v[96:99]
    ds_read_b64_tr_b16 v[40:41], v17 offset:53248
    v_mfma_f32_16x16x32_bf16 v[144:147], v[76:79], v[44:47], v[144:147]
    ds_read_b64_tr_b16 v[42:43], v17 offset:53760
    s_waitcnt lgkmcnt(10)
    v_mfma_f32_16x16x32_bf16 v[100:103], v[72:75], v[48:51], v[100:103]
    ds_read_b64_tr_b16 v[44:45], v18 offset:53248
    v_mfma_f32_16x16x32_bf16 v[148:151], v[76:79], v[48:51], v[148:151]
    ds_read_b64_tr_b16 v[46:47], v18 offset:53760
    s_waitcnt lgkmcnt(10)
    v_mfma_f32_16x16x32_bf16 v[104:107], v[72:75], v[28:31], v[104:107]
    ds_read_b64_tr_b16 v[48:49], v19 offset:53248
    v_mfma_f32_16x16x32_bf16 v[152:155], v[76:79], v[28:31], v[152:155]
    ds_read_b64_tr_b16 v[50:51], v19 offset:53760
    s_waitcnt lgkmcnt(8)
    v_mfma_f32_16x16x32_bf16 v[108:111], v[72:75], v[32:35], v[108:111]
    v_add_u32 v16, 65536, v16
    v_add_u32 v17, 65536, v17
    v_add_u32 v18, 65536, v18
    v_add_u32 v19, 65536, v19
    ds_read_b64_tr_b16 v[28:29], v16 offset:8192
    v_mfma_f32_16x16x32_bf16 v[156:159], v[76:79], v[32:35], v[156:159]
    ds_read_b64_tr_b16 v[30:31], v16 offset:8704
    s_waitcnt lgkmcnt(8)
    v_mfma_f32_16x16x32_bf16 v[112:115], v[72:75], v[36:39], v[112:115]
    ds_read_b64_tr_b16 v[32:33], v17 offset:8192
    v_mfma_f32_16x16x32_bf16 v[160:163], v[76:79], v[36:39], v[160:163]
    ds_read_b64_tr_b16 v[34:35], v17 offset:8704
    s_waitcnt lgkmcnt(8)
    v_mfma_f32_16x16x32_bf16 v[116:119], v[72:75], v[40:43], v[116:119]
    ds_read_b64_tr_b16 v[36:37], v18 offset:8192
    v_mfma_f32_16x16x32_bf16 v[164:167], v[76:79], v[40:43], v[164:167]
    ds_read_b64_tr_b16 v[38:39], v18 offset:8704
    s_waitcnt lgkmcnt(8)
    v_mfma_f32_16x16x32_bf16 v[120:123], v[72:75], v[44:47], v[120:123]
    ds_read_b64_tr_b16 v[40:41], v19 offset:8192
    v_mfma_f32_16x16x32_bf16 v[168:171], v[76:79], v[44:47], v[168:171]
    ds_read_b64_tr_b16 v[42:43], v19 offset:8704
    s_waitcnt lgkmcnt(8)
    v_mfma_f32_16x16x32_bf16 v[124:127], v[72:75], v[48:51], v[124:127]
    ds_read_b64_tr_b16 v[44:45], v16 offset:16384
    v_mfma_f32_16x16x32_bf16 v[172:175], v[76:79], v[48:51], v[172:175]
    ds_read_b64_tr_b16 v[46:47], v16 offset:16896
    s_waitcnt lgkmcnt(8)
    v_mfma_f32_16x16x32_bf16 v[80:83], v[28:31], v[64:67], v[80:83]
    ds_read_b64_tr_b16 v[48:49], v17 offset:16384
    v_mfma_f32_16x16x32_bf16 v[128:131], v[28:31], v[68:71], v[128:131]
    ds_read_b64_tr_b16 v[50:51], v17 offset:16896
    s_waitcnt lgkmcnt(8)
    v_mfma_f32_16x16x32_bf16 v[84:87], v[32:35], v[64:67], v[84:87]
    ds_read_b64_tr_b16 v[28:29], v18 offset:16384
    v_mfma_f32_16x16x32_bf16 v[132:135], v[32:35], v[68:71], v[132:135]
    ds_read_b64_tr_b16 v[30:31], v18 offset:16896
    ds_read_b128 v[72:75], v25 offset:57344
    ds_read_b128 v[76:79], v25 offset:59392
    s_waitcnt lgkmcnt(10)
    v_mfma_f32_16x16x32_bf16 v[88:91], v[36:39], v[64:67], v[88:91]
    ds_read_b64_tr_b16 v[32:33], v19 offset:16384
    v_mfma_f32_16x16x32_bf16 v[136:139], v[36:39], v[68:71], v[136:139]
    v_mfma_f32_16x16x32_bf16 v[176:179], v[64:67], a[56:59], v[176:179]
    ds_read_b64_tr_b16 v[34:35], v19 offset:16896
    s_waitcnt lgkmcnt(10)
    v_mfma_f32_16x16x32_bf16 v[92:95], v[40:43], v[64:67], v[92:95]
    ds_read_b64_tr_b16 v[36:37], v16 offset:24576
    v_mfma_f32_16x16x32_bf16 v[140:143], v[40:43], v[68:71], v[140:143]
    v_mfma_f32_16x16x32_bf16 v[180:183], v[68:71], a[56:59], v[180:183]
    ds_read_b64_tr_b16 v[38:39], v16 offset:25088
    s_waitcnt lgkmcnt(10)
    v_mfma_f32_16x16x32_bf16 v[96:99], v[64:67], v[44:47], v[96:99]
    ds_read_b64_tr_b16 v[40:41], v17 offset:24576
    v_mfma_f32_16x16x32_bf16 v[144:147], v[68:71], v[44:47], v[144:147]
    ds_read_b64_tr_b16 v[42:43], v17 offset:25088
    s_waitcnt lgkmcnt(10)
    v_mfma_f32_16x16x32_bf16 v[100:103], v[64:67], v[48:51], v[100:103]
    ds_read_b64_tr_b16 v[44:45], v18 offset:24576
    v_mfma_f32_16x16x32_bf16 v[148:151], v[68:71], v[48:51], v[148:151]
    ds_read_b64_tr_b16 v[46:47], v18 offset:25088
    s_waitcnt lgkmcnt(10)
    v_mfma_f32_16x16x32_bf16 v[104:107], v[64:67], v[28:31], v[104:107]
    ds_read_b64_tr_b16 v[48:49], v19 offset:24576
    v_mfma_f32_16x16x32_bf16 v[152:155], v[68:71], v[28:31], v[152:155]
    ds_read_b64_tr_b16 v[50:51], v19 offset:25088
    s_waitcnt lgkmcnt(8)
    v_mfma_f32_16x16x32_bf16 v[108:111], v[64:67], v[32:35], v[108:111]
    ds_read_b64_tr_b16 v[28:29], v16 offset:12288
    v_mfma_f32_16x16x32_bf16 v[156:159], v[68:71], v[32:35], v[156:159]
    ds_read_b64_tr_b16 v[30:31], v16 offset:12800
    s_waitcnt lgkmcnt(8)
    v_mfma_f32_16x16x32_bf16 v[112:115], v[64:67], v[36:39], v[112:115]
    ds_read_b64_tr_b16 v[32:33], v17 offset:12288
    v_mfma_f32_16x16x32_bf16 v[160:163], v[68:71], v[36:39], v[160:163]
    ds_read_b64_tr_b16 v[34:35], v17 offset:12800
    s_waitcnt lgkmcnt(8)
    v_mfma_f32_16x16x32_bf16 v[116:119], v[64:67], v[40:43], v[116:119]
    ds_read_b64_tr_b16 v[36:37], v18 offset:12288
    v_mfma_f32_16x16x32_bf16 v[164:167], v[68:71], v[40:43], v[164:167]
    ds_read_b64_tr_b16 v[38:39], v18 offset:12800
    s_waitcnt lgkmcnt(8)
    v_mfma_f32_16x16x32_bf16 v[120:123], v[64:67], v[44:47], v[120:123]
    ds_read_b64_tr_b16 v[40:41], v19 offset:12288
    v_mfma_f32_16x16x32_bf16 v[168:171], v[68:71], v[44:47], v[168:171]
    ds_read_b64_tr_b16 v[42:43], v19 offset:12800
    s_waitcnt lgkmcnt(8)
    v_mfma_f32_16x16x32_bf16 v[124:127], v[64:67], v[48:51], v[124:127]
    ds_read_b64_tr_b16 v[44:45], v16 offset:20480
    v_mfma_f32_16x16x32_bf16 v[172:175], v[68:71], v[48:51], v[172:175]
    ds_read_b64_tr_b16 v[46:47], v16 offset:20992
    s_waitcnt lgkmcnt(8)
    v_mfma_f32_16x16x32_bf16 v[80:83], v[28:31], v[72:75], v[80:83]
    ds_read_b64_tr_b16 v[48:49], v17 offset:20480
    v_mfma_f32_16x16x32_bf16 v[128:131], v[28:31], v[76:79], v[128:131]
    ds_read_b64_tr_b16 v[50:51], v17 offset:20992
    s_waitcnt lgkmcnt(8)
    v_mfma_f32_16x16x32_bf16 v[84:87], v[32:35], v[72:75], v[84:87]
    ds_read_b64_tr_b16 v[28:29], v18 offset:20480
    v_mfma_f32_16x16x32_bf16 v[132:135], v[32:35], v[76:79], v[132:135]
    ds_read_b64_tr_b16 v[30:31], v18 offset:20992
    s_waitcnt lgkmcnt(8)
    v_mfma_f32_16x16x32_bf16 v[88:91], v[36:39], v[72:75], v[88:91]
    ds_read_b64_tr_b16 v[32:33], v19 offset:20480
    v_mfma_f32_16x16x32_bf16 v[136:139], v[36:39], v[76:79], v[136:139]
    v_mfma_f32_16x16x32_bf16 v[176:179], v[72:75], a[60:63], v[176:179]
    ds_read_b64_tr_b16 v[34:35], v19 offset:20992
    s_waitcnt lgkmcnt(8)
    v_mfma_f32_16x16x32_bf16 v[92:95], v[40:43], v[72:75], v[92:95]
    ds_read_b64_tr_b16 v[36:37], v16 offset:28672
    v_mfma_f32_16x16x32_bf16 v[140:143], v[40:43], v[76:79], v[140:143]
    v_mfma_f32_16x16x32_bf16 v[180:183], v[76:79], a[60:63], v[180:183]
    ds_read_b64_tr_b16 v[38:39], v16 offset:29184
    s_waitcnt lgkmcnt(8)
    v_mfma_f32_16x16x32_bf16 v[96:99], v[72:75], v[44:47], v[96:99]
    ds_read_b64_tr_b16 v[40:41], v17 offset:28672
    v_mfma_f32_16x16x32_bf16 v[144:147], v[76:79], v[44:47], v[144:147]
    ds_read_b64_tr_b16 v[42:43], v17 offset:29184
    s_waitcnt lgkmcnt(8)
    v_mfma_f32_16x16x32_bf16 v[100:103], v[72:75], v[48:51], v[100:103]
    ds_read_b64_tr_b16 v[44:45], v18 offset:28672
    v_mfma_f32_16x16x32_bf16 v[148:151], v[76:79], v[48:51], v[148:151]
    ds_read_b64_tr_b16 v[46:47], v18 offset:29184
    s_waitcnt lgkmcnt(8)
    v_mfma_f32_16x16x32_bf16 v[104:107], v[72:75], v[28:31], v[104:107]
    ds_read_b64_tr_b16 v[48:49], v19 offset:28672
    v_mfma_f32_16x16x32_bf16 v[152:155], v[76:79], v[28:31], v[152:155]
    ds_read_b64_tr_b16 v[50:51], v19 offset:29184
    s_waitcnt lgkmcnt(8)
    v_mfma_f32_16x16x32_bf16 v[108:111], v[72:75], v[32:35], v[108:111]
    v_mfma_f32_16x16x32_bf16 v[156:159], v[76:79], v[32:35], v[156:159]
    s_waitcnt lgkmcnt(6)
    v_mfma_f32_16x16x32_bf16 v[112:115], v[72:75], v[36:39], v[112:115]
    v_mfma_f32_16x16x32_bf16 v[160:163], v[76:79], v[36:39], v[160:163]
    s_waitcnt lgkmcnt(4)
    v_mfma_f32_16x16x32_bf16 v[116:119], v[72:75], v[40:43], v[116:119]
    v_mfma_f32_16x16x32_bf16 v[164:167], v[76:79], v[40:43], v[164:167]
    s_waitcnt lgkmcnt(2)
    v_mfma_f32_16x16x32_bf16 v[120:123], v[72:75], v[44:47], v[120:123]
    v_mfma_f32_16x16x32_bf16 v[168:171], v[76:79], v[44:47], v[168:171]
    s_waitcnt lgkmcnt(0)
    v_mfma_f32_16x16x32_bf16 v[124:127], v[72:75], v[48:51], v[124:127]
    v_mfma_f32_16x16x32_bf16 v[172:175], v[76:79], v[48:51], v[172:175]
    s_barrier
    s_mov_b32 s60, 400000
    s_waitcnt vmcnt(0)
    s_branch L_rdyc_14
L_rdy_12:
    buffer_load_dword v234, v232, s[44:47], 0 offen sc1
    s_waitcnt vmcnt(0)
L_rdyc_14:
    v_cmp_ne_u32 vcc, 0, v234
    s_nop 3
    s_cmp_eq_u64 vcc, -1
    s_cbranch_scc1 L_rdyo_13
    s_sub_u32 s60, s60, 1
    s_cmp_eq_u32 s60, 0
    s_cbranch_scc1 L_rdyo_13
    s_branch L_rdy_12
L_rdyo_13:
    v_lshrrev_b32 v4, 3, v1
    v_and_b32 v5, 7, v1
    v_and_b32 v6, 6, v4
    v_xor_b32 v5, v5, v6
    v_lshlrev_b32 v5, 4, v5
    v_mul_u32_u24 v4, 1024, v4
    v_add_u32 v20, v4, v5
    v_add_u32 v21, 7168, v20
    v_add_u32 v22, 14336, v20
    v_add_u32 v23, 21504, v20
    s_and_b32 s55, s50, 7
    s_mov_b32 s36, s12
    s_and_b32 s37, s13, 0xffff
    s_mov_b32 s38, 0x80000
    s_mov_b32 s39, 0x20000
    s_lshl_b32 s52, s55, 7
    s_lshl_b32 s53, s48, 17
    s_add_u32 s64, s52, s53
    s_lshl_b32 s66, s48, 14
    v_mov_b32 v184, 0x3fb8aa3b
    v_mov_b32 v185, 0x3fb8aa3b
    v_mov_b32 v186, 0x358637bd
    v_mov_b32 v187, 0x358637bd
    v_pk_mul_f32 v[192:193], v[96:97], v[184:185]
    v_pk_mul_f32 v[194:195], v[98:99], v[184:185]
    v_pk_mul_f32 v[196:197], v[144:145], v[184:185]
    v_pk_mul_f32 v[198:199], v[146:147], v[184:185]
    s_add_u32 m0, s66, 65536
    s_add_u32 s6, s64, 0
    buffer_load_dwordx4 v20, s[36:39], s6 offen offset:0 lds
    v_exp_f32 v192, v192 clamp
    v_exp_f32 v193, v193 clamp
    v_exp_f32 v194, v194 clamp
    v_exp_f32 v195, v195 clamp
    buffer_load_dwordx4 v21, s[36:39], s6 offen offset:1024 lds
    v_exp_f32 v196, v196 clamp
    v_exp_f32 v197, v197 clamp
    v_exp_f32 v198, v198 clamp
    v_exp_f32 v199, v199 clamp
    buffer_load_dwordx4 v22, s[36:39], s6 offen offset:2048 lds
    v_max_f32 v96, 0, v96
    v_max_f32 v97, 0, v97
    v_max_f32 v98, 0, v98
    v_max_f32 v99, 0, v99
    v_max_f32 v144, 0, v144
    v_max_f32 v145, 0, v145
    v_max_f32 v146, 0, v146
    v_max_f32 v147, 0, v147
    buffer_load_dwordx4 v23, s[36:39], s6 offen offset:3072 lds
    v_pk_add_f32 v[96:97], v[96:97], v[192:193]
    v_pk_add_f32 v[98:99], v[98:99], v[194:195]
    v_pk_add_f32 v[144:145], v[144:145], v[196:197]
    v_pk_add_f32 v[146:147], v[146:147], v[198:199]
    v_pk_add_f32 v[96:97], v[96:97], v[186:187]
    v_pk_add_f32 v[98:99], v[98:99], v[186:187]
    v_pk_add_f32 v[144:145], v[144:145], v[186:187]
    v_pk_add_f32 v[146:147], v[146:147], v[186:187]
    v_cvt_pk_bf16_f32 v200, v96, v97
    v_cvt_pk_bf16_f32 v201, v98, v99
    v_cvt_pk_bf16_f32 v202, v144, v145
    v_cvt_pk_bf16_f32 v203, v146, v147
    v_cvt_pk_bf16_f32 v204, v112, v113
    v_cvt_pk_bf16_f32 v205, v114, v115
    v_cvt_pk_bf16_f32 v206, v160, v161
    v_cvt_pk_bf16_f32 v207, v162, v163
    s_nop 1
    v_mfma_f32_16x16x32_bf16 v[208:211], v[200:203], v[204:207], 0
    v_mfma_f32_16x16x32_bf16 v[224:227], v[200:203], v[60:63], 0
    v_pk_mul_f32 v[192:193], v[100:101], v[184:185]
    v_pk_mul_f32 v[194:195], v[102:103], v[184:185]
    v_pk_mul_f32 v[196:197], v[148:149], v[184:185]
    v_pk_mul_f32 v[198:199], v[150:151], v[184:185]
    v_exp_f32 v192, v192 clamp
    v_exp_f32 v193, v193 clamp
    v_exp_f32 v194, v194 clamp
    v_exp_f32 v195, v195 clamp
    v_exp_f32 v196, v196 clamp
    v_exp_f32 v197, v197 clamp
    v_exp_f32 v198, v198 clamp
    v_exp_f32 v199, v199 clamp
    v_max_f32 v100, 0, v100
    v_max_f32 v101, 0, v101
    v_max_f32 v102, 0, v102
    v_max_f32 v103, 0, v103
    v_max_f32 v148, 0, v148
    v_max_f32 v149, 0, v149
    v_max_f32 v150, 0, v150
    v_max_f32 v151, 0, v151
    v_pk_add_f32 v[100:101], v[100:101], v[192:193]
    v_pk_add_f32 v[102:103], v[102:103], v[194:195]
    v_pk_add_f32 v[148:149], v[148:149], v[196:197]
    v_pk_add_f32 v[150:151], v[150:151], v[198:199]
    v_pk_add_f32 v[100:101], v[100:101], v[186:187]
    v_pk_add_f32 v[102:103], v[102:103], v[186:187]
    v_pk_add_f32 v[148:149], v[148:149], v[186:187]
    v_pk_add_f32 v[150:151], v[150:151], v[186:187]
    v_cvt_pk_bf16_f32 v200, v100, v101
    v_cvt_pk_bf16_f32 v201, v102, v103
    v_cvt_pk_bf16_f32 v202, v148, v149
    v_cvt_pk_bf16_f32 v203, v150, v151
    v_cvt_pk_bf16_f32 v204, v116, v117
    v_cvt_pk_bf16_f32 v205, v118, v119
    v_cvt_pk_bf16_f32 v206, v164, v165
    v_cvt_pk_bf16_f32 v207, v166, v167
    s_nop 1
    v_mfma_f32_16x16x32_bf16 v[212:215], v[200:203], v[204:207], 0
    v_mfma_f32_16x16x32_bf16 v[228:231], v[200:203], v[60:63], 0
    v_pk_mul_f32 v[192:193], v[104:105], v[184:185]
    v_pk_mul_f32 v[194:195], v[106:107], v[184:185]
    v_pk_mul_f32 v[196:197], v[152:153], v[184:185]
    v_pk_mul_f32 v[198:199], v[154:155], v[184:185]
    s_add_u32 m0, s66, 69632
    s_add_u32 s6, s64, 32768
    buffer_load_dwordx4 v20, s[36:39], s6 offen offset:0 lds
    v_exp_f32 v192, v192 clamp
    v_exp_f32 v193, v193 clamp
    v_exp_f32 v194, v194 clamp
    v_exp_f32 v195, v195 clamp
    buffer_load_dwordx4 v21, s[36:39], s6 offen offset:1024 lds
    v_exp_f32 v196, v196 clamp
    v_exp_f32 v197, v197 clamp
    v_exp_f32 v198, v198 clamp
    v_exp_f32 v199, v199 clamp
    buffer_load_dwordx4 v22, s[36:39], s6 offen offset:2048 lds
    v_max_f32 v104, 0, v104
    v_max_f32 v105, 0, v105
    v_max_f32 v106, 0, v106
    v_max_f32 v107, 0, v107
    v_max_f32 v152, 0, v152
    v_max_f32 v153, 0, v153
    v_max_f32 v154, 0, v154
    v_max_f32 v155, 0, v155
    buffer_load_dwordx4 v23, s[36:39], s6 offen offset:3072 lds
    v_pk_add_f32 v[104:105], v[104:105], v[192:193]
    v_pk_add_f32 v[106:107], v[106:107], v[194:195]
    v_pk_add_f32 v[152:153], v[152:153], v[196:197]
    v_pk_add_f32 v[154:155], v[154:155], v[198:199]
    v_pk_add_f32 v[104:105], v[104:105], v[186:187]
    v_pk_add_f32 v[106:107], v[106:107], v[186:187]
    v_pk_add_f32 v[152:153], v[152:153], v[186:187]
    v_pk_add_f32 v[154:155], v[154:155], v[186:187]
    v_cvt_pk_bf16_f32 v200, v104, v105
    v_cvt_pk_bf16_f32 v201, v106, v107
    v_cvt_pk_bf16_f32 v202, v152, v153
    v_cvt_pk_bf16_f32 v203, v154, v155
    v_cvt_pk_bf16_f32 v204, v120, v121
    v_cvt_pk_bf16_f32 v205, v122, v123
    v_cvt_pk_bf16_f32 v206, v168, v169
    v_cvt_pk_bf16_f32 v207, v170, v171
    s_nop 1
    v_mfma_f32_16x16x32_bf16 v[216:219], v[200:203], v[204:207], 0
    v_mfma_f32_16x16x32_bf16 v[232:235], v[200:203], v[60:63], 0
    v_pk_mul_f32 v[192:193], v[108:109], v[184:185]
    v_pk_mul_f32 v[194:195], v[110:111], v[184:185]
    v_pk_mul_f32 v[196:197], v[156:157], v[184:185]
    v_pk_mul_f32 v[198:199], v[158:159], v[184:185]
    v_exp_f32 v192, v192 clamp
    v_exp_f32 v193, v193 clamp
    v_exp_f32 v194, v194 clamp
    v_exp_f32 v195, v195 clamp
    v_exp_f32 v196, v196 clamp
    v_exp_f32 v197, v197 clamp
    v_exp_f32 v198, v198 clamp
    v_exp_f32 v199, v199 clamp
    v_max_f32 v108, 0, v108
    v_max_f32 v109, 0, v109
    v_max_f32 v110, 0, v110
    v_max_f32 v111, 0, v111
    v_max_f32 v156, 0, v156
    v_max_f32 v157, 0, v157
    v_max_f32 v158, 0, v158
    v_max_f32 v159, 0, v159
    v_pk_add_f32 v[108:109], v[108:109], v[192:193]
    v_pk_add_f32 v[110:111], v[110:111], v[194:195]
    v_pk_add_f32 v[156:157], v[156:157], v[196:197]
    v_pk_add_f32 v[158:159], v[158:159], v[198:199]
    v_pk_add_f32 v[108:109], v[108:109], v[186:187]
    v_pk_add_f32 v[110:111], v[110:111], v[186:187]
    v_pk_add_f32 v[156:157], v[156:157], v[186:187]
    v_pk_add_f32 v[158:159], v[158:159], v[186:187]
    v_cvt_pk_bf16_f32 v200, v108, v109
    v_cvt_pk_bf16_f32 v201, v110, v111
    v_cvt_pk_bf16_f32 v202, v156, v157
    v_cvt_pk_bf16_f32 v203, v158, v159
    v_cvt_pk_bf16_f32 v204, v124, v125
    v_cvt_pk_bf16_f32 v205, v126, v127
    v_cvt_pk_bf16_f32 v206, v172, v173
    v_cvt_pk_bf16_f32 v207, v174, v175
    s_nop 1
    v_mfma_f32_16x16x32_bf16 v[220:223], v[200:203], v[204:207], 0
    v_mfma_f32_16x16x32_bf16 v[236:239], v[200:203], v[60:63], 0
    s_lshl_b32 s52, s48, 12
    s_add_u32 s52, s52, 131072
    v_add_u32 v4, s52, v27
    ds_write_b128 v4, v[208:211] offset:0
    ds_write_b128 v4, v[212:215] offset:1024
    ds_write_b128 v4, v[216:219] offset:2048
    s_nop 0
    ds_write_b128 v4, v[220:223] offset:3072
    s_lshl_b32 s52, s48, 8
    s_add_u32 s52, s52, 147456
    v_lshlrev_b32 v5, 4, v3
    v_add_u32 v5, s52, v5
    v_cmp_eq_u32 vcc, 0, v2
    s_nop 3
    s_and_saveexec_b64 s[54:55], vcc
    ds_write_b128 v5, v[224:227] offset:0
    ds_write_b128 v5, v[228:231] offset:64
    ds_write_b128 v5, v[232:235] offset:128
    ds_write_b128 v5, v[236:239] offset:192
    s_mov_b64 exec, s[54:55]
    s_waitcnt lgkmcnt(0)
    s_barrier
    s_lshl_b32 s52, s48, 10
    s_add_u32 s52, s52, 131072
    v_add_u32 v4, s52, v27
    ds_read_b128 v[192:195], v4 offset:0
    ds_read_b128 v[196:199], v4 offset:4096
    ds_read_b128 v[200:203], v4 offset:8192
    ds_read_b128 v[204:207], v4 offset:12288
    s_lshl_b32 s52, s48, 6
    s_add_u32 s52, s52, 147456
    v_lshlrev_b32 v5, 2, v2
    v_add_u32 v6, s52, v5
    ds_read_b32 v208, v6 offset:0
    ds_read_b32 v209, v6 offset:256
    ds_read_b32 v210, v6 offset:512
    ds_read_b32 v211, v6 offset:768
    s_waitcnt lgkmcnt(0)
    v_pk_add_f32 v[192:193], v[192:193], v[196:197]
    v_pk_add_f32 v[194:195], v[194:195], v[198:199]
    v_add_f32 v208, v208, v209
    v_pk_add_f32 v[192:193], v[192:193], v[200:201]
    v_pk_add_f32 v[194:195], v[194:195], v[202:203]
    v_add_f32 v208, v208, v210
    v_pk_add_f32 v[192:193], v[192:193], v[204:205]
    v_pk_add_f32 v[194:195], v[194:195], v[206:207]
    v_add_f32 v208, v208, v211
    s_lshl_b32 s52, s77, 2
    s_add_u32 s52, s52, s48
    s_lshl_b32 s53, s52, 10
    s_add_u32 s53, s53, 15728640
    s_lshl_b32 s54, s52, 6
    s_add_u32 s54, s54, 15761408
    v_lshlrev_b32 v4, 2, v1
    buffer_atomic_add_f32 v192, v4, s[40:43], s53 offen offset:0 sc0
    buffer_atomic_add_f32 v193, v4, s[40:43], s53 offen offset:256 sc0
    buffer_atomic_add_f32 v194, v4, s[40:43], s53 offen offset:512 sc0
    buffer_atomic_add_f32 v195, v4, s[40:43], s53 offen offset:768 sc0
    s_mov_b64 exec, 0xffff
    buffer_atomic_add_f32 v208, v5, s[40:43], s54 offen sc0
    s_mov_b64 exec, -1
    v_mul_f32 v212, 0xbfb8aa3b, v176
    v_mul_f32 v213, 0xbfb8aa3b, v177
    v_mul_f32 v214, 0xbfb8aa3b, v178
    v_mul_f32 v215, 0xbfb8aa3b, v179
    v_mul_f32 v216, 0xbfb8aa3b, v180
    v_mul_f32 v217, 0xbfb8aa3b, v181
    v_mul_f32 v218, 0xbfb8aa3b, v182
    v_mul_f32 v219, 0xbfb8aa3b, v183
    v_exp_f32 v212, v212
    v_exp_f32 v213, v213
    v_exp_f32 v214, v214
    v_exp_f32 v215, v215
    v_exp_f32 v216, v216
    v_exp_f32 v217, v217
    v_exp_f32 v218, v218
    v_exp_f32 v219, v219
    v_add_f32 v212, 1.0, v212
    v_add_f32 v213, 1.0, v213
    v_add_f32 v214, 1.0, v214
    v_add_f32 v215, 1.0, v215
    v_add_f32 v216, 1.0, v216
    v_add_f32 v217, 1.0, v217
    v_add_f32 v218, 1.0, v218
    v_add_f32 v219, 1.0, v219
    v_rcp_f32 v212, v212
    v_rcp_f32 v213, v213
    v_rcp_f32 v214, v214
    v_rcp_f32 v215, v215
    v_rcp_f32 v216, v216
    v_rcp_f32 v217, v217
    v_rcp_f32 v218, v218
    v_rcp_f32 v219, v219
    s_lshl_b32 s52, s76, 7
    s_lshl_b32 s53, s48, 5
    s_add_u32 s52, s52, s53
    s_lshl_b32 s52, s52, 2
    s_add_u32 s52, s52, 15794176
    v_cmp_eq_u32 vcc, 1, v2
    s_nop 1
    v_cndmask_b32 v212, v212, v216, vcc
    v_cndmask_b32 v213, v213, v217, vcc
    v_cndmask_b32 v214, v214, v218, vcc
    v_cndmask_b32 v215, v215, v219, vcc
    v_lshlrev_b32 v4, 4, v3
    v_lshl_add_u32 v4, v2, 6, v4
    v_cmp_gt_u32 vcc, 2, v2
    v_bfrev_b32 v5, 2
    s_nop 0
    v_cndmask_b32 v4, v5, v4, vcc
    s_cmp_eq_u32 s77, 0
    s_cselect_b32 s53, 0, 0x40000000
    v_or_b32 v4, s53, v4
    buffer_store_dwordx4 v[212:215], v4, s[40:43], s52 offen sc1
    v_pk_mul_f32 v[224:225], v[80:81], v[184:185]
    v_pk_mul_f32 v[226:227], v[82:83], v[184:185]
    v_pk_mul_f32 v[228:229], v[84:85], v[184:185]
    v_pk_mul_f32 v[230:231], v[86:87], v[184:185]
    s_add_u32 m0, s66, 73728
    s_add_u32 s6, s64, 65536
    buffer_load_dwordx4 v20, s[36:39], s6 offen offset:0 lds
    v_exp_f32 v224, v224 clamp
    v_exp_f32 v225, v225 clamp
    v_exp_f32 v226, v226 clamp
    v_exp_f32 v227, v227 clamp
    buffer_load_dwordx4 v21, s[36:39], s6 offen offset:1024 lds
    v_exp_f32 v228, v228 clamp
    v_exp_f32 v229, v229 clamp
    v_exp_f32 v230, v230 clamp
    v_exp_f32 v231, v231 clamp
    buffer_load_dwordx4 v22, s[36:39], s6 offen offset:2048 lds
    v_max_f32 v80, 0, v80
    v_max_f32 v81, 0, v81
    v_max_f32 v82, 0, v82
    v_max_f32 v83, 0, v83
    v_max_f32 v84, 0, v84
    v_max_f32 v85, 0, v85
    v_max_f32 v86, 0, v86
    v_max_f32 v87, 0, v87
    buffer_load_dwordx4 v23, s[36:39], s6 offen offset:3072 lds
    v_pk_add_f32 v[80:81], v[80:81], v[224:225]
    v_pk_add_f32 v[82:83], v[82:83], v[226:227]
    v_pk_add_f32 v[84:85], v[84:85], v[228:229]
    v_pk_add_f32 v[86:87], v[86:87], v[230:231]
    v_pk_add_f32 v[80:81], v[80:81], v[186:187]
    v_pk_add_f32 v[82:83], v[82:83], v[186:187]
    v_pk_add_f32 v[84:85], v[84:85], v[186:187]
    v_pk_add_f32 v[86:87], v[86:87], v[186:187]
    v_cvt_pk_bf16_f32 v64, v80, v81
    v_cvt_pk_bf16_f32 v65, v82, v83
    v_cvt_pk_bf16_f32 v66, v84, v85
    v_cvt_pk_bf16_f32 v67, v86, v87
    v_pk_mul_f32 v[224:225], v[88:89], v[184:185]
    v_pk_mul_f32 v[226:227], v[90:91], v[184:185]
    v_pk_mul_f32 v[228:229], v[92:93], v[184:185]
    v_pk_mul_f32 v[230:231], v[94:95], v[184:185]
    s_add_u32 m0, s66, 77824
    s_add_u32 s6, s64, 98304
    buffer_load_dwordx4 v20, s[36:39], s6 offen offset:0 lds
    v_exp_f32 v224, v224 clamp
    v_exp_f32 v225, v225 clamp
    v_exp_f32 v226, v226 clamp
    v_exp_f32 v227, v227 clamp
    buffer_load_dwordx4 v21, s[36:39], s6 offen offset:1024 lds
    v_exp_f32 v228, v228 clamp
    v_exp_f32 v229, v229 clamp
    v_exp_f32 v230, v230 clamp
    v_exp_f32 v231, v231 clamp
    buffer_load_dwordx4 v22, s[36:39], s6 offen offset:2048 lds
    v_max_f32 v88, 0, v88
    v_max_f32 v89, 0, v89
    v_max_f32 v90, 0, v90
    v_max_f32 v91, 0, v91
    v_max_f32 v92, 0, v92
    v_max_f32 v93, 0, v93
    v_max_f32 v94, 0, v94
    v_max_f32 v95, 0, v95
    buffer_load_dwordx4 v23, s[36:39], s6 offen offset:3072 lds
    v_pk_add_f32 v[88:89], v[88:89], v[224:225]
    v_pk_add_f32 v[90:91], v[90:91], v[226:227]
    v_pk_add_f32 v[92:93], v[92:93], v[228:229]
    v_pk_add_f32 v[94:95], v[94:95], v[230:231]
    v_pk_add_f32 v[88:89], v[88:89], v[186:187]
    v_pk_add_f32 v[90:91], v[90:91], v[186:187]
    v_pk_add_f32 v[92:93], v[92:93], v[186:187]
    v_pk_add_f32 v[94:95], v[94:95], v[186:187]
    v_cvt_pk_bf16_f32 v68, v88, v89
    v_cvt_pk_bf16_f32 v69, v90, v91
    v_cvt_pk_bf16_f32 v70, v92, v93
    v_cvt_pk_bf16_f32 v71, v94, v95
    v_pk_mul_f32 v[224:225], v[128:129], v[184:185]
    v_pk_mul_f32 v[226:227], v[130:131], v[184:185]
    v_pk_mul_f32 v[228:229], v[132:133], v[184:185]
    v_pk_mul_f32 v[230:231], v[134:135], v[184:185]
    v_exp_f32 v224, v224 clamp
    v_exp_f32 v225, v225 clamp
    v_exp_f32 v226, v226 clamp
    v_exp_f32 v227, v227 clamp
    v_exp_f32 v228, v228 clamp
    v_exp_f32 v229, v229 clamp
    v_exp_f32 v230, v230 clamp
    v_exp_f32 v231, v231 clamp
    v_max_f32 v128, 0, v128
    v_max_f32 v129, 0, v129
    v_max_f32 v130, 0, v130
    v_max_f32 v131, 0, v131
    v_max_f32 v132, 0, v132
    v_max_f32 v133, 0, v133
    v_max_f32 v134, 0, v134
    v_max_f32 v135, 0, v135
    v_pk_add_f32 v[128:129], v[128:129], v[224:225]
    v_pk_add_f32 v[130:131], v[130:131], v[226:227]
    v_pk_add_f32 v[132:133], v[132:133], v[228:229]
    v_pk_add_f32 v[134:135], v[134:135], v[230:231]
    v_pk_add_f32 v[128:129], v[128:129], v[186:187]
    v_pk_add_f32 v[130:131], v[130:131], v[186:187]
    v_pk_add_f32 v[132:133], v[132:133], v[186:187]
    v_pk_add_f32 v[134:135], v[134:135], v[186:187]
    v_cvt_pk_bf16_f32 v72, v128, v129
    v_cvt_pk_bf16_f32 v73, v130, v131
    v_cvt_pk_bf16_f32 v74, v132, v133
    v_cvt_pk_bf16_f32 v75, v134, v135
    v_pk_mul_f32 v[224:225], v[136:137], v[184:185]
    v_pk_mul_f32 v[226:227], v[138:139], v[184:185]
    v_pk_mul_f32 v[228:229], v[140:141], v[184:185]
    v_pk_mul_f32 v[230:231], v[142:143], v[184:185]
    v_exp_f32 v224, v224 clamp
    v_exp_f32 v225, v225 clamp
    v_exp_f32 v226, v226 clamp
    v_exp_f32 v227, v227 clamp
    v_exp_f32 v228, v228 clamp
    v_exp_f32 v229, v229 clamp
    v_exp_f32 v230, v230 clamp
    v_exp_f32 v231, v231 clamp
    v_max_f32 v136, 0, v136
    v_max_f32 v137, 0, v137
    v_max_f32 v138, 0, v138
    v_max_f32 v139, 0, v139
    v_max_f32 v140, 0, v140
    v_max_f32 v141, 0, v141
    v_max_f32 v142, 0, v142
    v_max_f32 v143, 0, v143
    v_pk_add_f32 v[136:137], v[136:137], v[224:225]
    v_pk_add_f32 v[138:139], v[138:139], v[226:227]
    v_pk_add_f32 v[140:141], v[140:141], v[228:229]
    v_pk_add_f32 v[142:143], v[142:143], v[230:231]
    v_pk_add_f32 v[136:137], v[136:137], v[186:187]
    v_pk_add_f32 v[138:139], v[138:139], v[186:187]
    v_pk_add_f32 v[140:141], v[140:141], v[186:187]
    v_pk_add_f32 v[142:143], v[142:143], v[186:187]
    v_cvt_pk_bf16_f32 v76, v136, v137
    v_cvt_pk_bf16_f32 v77, v138, v139
    v_cvt_pk_bf16_f32 v78, v140, v141
    v_cvt_pk_bf16_f32 v79, v142, v143
    s_waitcnt vmcnt(8)
    s_barrier
    s_cmp_lg_u32 s48, 0
    s_cbranch_scc1 L_sig_15
    s_lshl_b32 s52, s77, 7
    s_lshl_b32 s53, s76, 2
    s_add_u32 s52, s52, s53
    s_add_u32 s52, s52, 15769600
    v_mov_b32 v4, s52
    v_mov_b32 v5, 1
    s_mov_b64 exec, 1
    buffer_store_dword v5, v4, s[40:43], 0 offen sc1
    s_mov_b64 exec, -1
L_sig_15:
    s_lshl_b32 s67, s76, 3
    s_lshl_b32 s52, s48, 1
    s_add_u32 s67, s67, s52
    s_waitcnt vmcnt(0)
    s_mov_b32 s36, s20
    s_and_b32 s37, s21, 0xffff
    s_mov_b32 s38, 0x1c0000
    s_mov_b32 s39, 0x20000
    v_add_u32 v4, 0, v1
    v_mul_u32_u24 v5, 4682, v4
    v_lshrrev_b32 v5, 16, v5
    v_mul_u32_u24 v6, 14, v5
    v_sub_u32 v6, v4, v6
    v_mul_u32_u24 v5, 3584, v5
    v_lshl_add_u32 v5, v6, 4, v5
    v_subrev_u32 v20, 0, v5
    v_add_u32 v4, 64, v1
    v_mul_u32_u24 v5, 4682, v4
    v_lshrrev_b32 v5, 16, v5
    v_mul_u32_u24 v6, 14, v5
    v_sub_u32 v6, v4, v6
    v_mul_u32_u24 v5, 3584, v5
    v_lshl_add_u32 v5, v6, 4, v5
    v_subrev_u32 v21, 1024, v5
    v_add_u32 v4, 128, v1
    v_mul_u32_u24 v5, 4682, v4
    v_lshrrev_b32 v5, 16, v5
    v_mul_u32_u24 v6, 14, v5
    v_sub_u32 v6, v4, v6
    v_mul_u32_u24 v5, 3584, v5
    v_lshl_add_u32 v5, v6, 4, v5
    v_subrev_u32 v22, 2048, v5
    v_add_u32 v4, 192, v1
    v_mul_u32_u24 v5, 4682, v4
    v_lshrrev_b32 v5, 16, v5
    v_mul_u32_u24 v6, 14, v5
    v_sub_u32 v6, v4, v6
    v_mul_u32_u24 v5, 3584, v5
    v_lshl_add_u32 v5, v6, 4, v5
    v_subrev_u32 v23, 3072, v5
    v_add_u32 v4, 256, v1
    v_mul_u32_u24 v5, 4682, v4
    v_lshrrev_b32 v5, 16, v5
    v_mul_u32_u24 v6, 14, v5
    v_sub_u32 v6, v4, v6
    v_mul_u32_u24 v5, 3584, v5
    v_lshl_add_u32 v5, v6, 4, v5
    v_subrev_u32 v24, 0, v5
    v_add_u32 v4, 320, v1
    v_mul_u32_u24 v5, 4682, v4
    v_lshrrev_b32 v5, 16, v5
    v_mul_u32_u24 v6, 14, v5
    v_sub_u32 v6, v4, v6
    v_mul_u32_u24 v5, 3584, v5
    v_lshl_add_u32 v5, v6, 4, v5
    v_subrev_u32 v25, 1024, v5
    v_add_u32 v4, 384, v1
    v_mul_u32_u24 v5, 4682, v4
    v_lshrrev_b32 v5, 16, v5
    v_mul_u32_u24 v6, 14, v5
    v_sub_u32 v6, v4, v6
    v_mul_u32_u24 v5, 3584, v5
    v_lshl_add_u32 v5, v6, 4, v5
    v_subrev_u32 v26, 2048, v5
    s_mul_i32 s64, s51, 224
    s_mul_i32 s52, s48, 114688
    s_add_u32 s64, s64, s52
    s_mul_i32 s66, s48, 7168
    s_add_u32 s6, s64, 0
    s_add_u32 m0, s66, 0
    s_nop 0
    buffer_load_dwordx4 v20, s[36:39], s6 offen offset:0 lds
    buffer_load_dwordx4 v21, s[36:39], s6 offen offset:1024 lds
    buffer_load_dwordx4 v22, s[36:39], s6 offen offset:2048 lds
    buffer_load_dwordx4 v23, s[36:39], s6 offen offset:3072 lds
    s_add_u32 m0, s66, 4096
    s_nop 0
    buffer_load_dwordx4 v24, s[36:39], s6 offen offset:0 lds
    buffer_load_dwordx4 v25, s[36:39], s6 offen offset:1024 lds
    buffer_load_dwordx4 v26, s[36:39], s6 offen offset:2048 lds
    s_add_u32 s6, s64, 458752
    s_add_u32 m0, s66, 28672
    s_nop 0
    buffer_load_dwordx4 v20, s[36:39], s6 offen offset:0 lds
    buffer_load_dwordx4 v21, s[36:39], s6 offen offset:1024 lds
    buffer_load_dwordx4 v22, s[36:39], s6 offen offset:2048 lds
    buffer_load_dwordx4 v23, s[36:39], s6 offen offset:3072 lds
    s_add_u32 m0, s66, 32768
    s_nop 0
    buffer_load_dwordx4 v24, s[36:39], s6 offen offset:0 lds
    buffer_load_dwordx4 v25, s[36:39], s6 offen offset:1024 lds
    buffer_load_dwordx4 v26, s[36:39], s6 offen offset:2048 lds
    v_lshlrev_b32 v8, 2, v2
    s_lshl_b32 s52, s77, 7
    s_add_u32 s52, s52, 15769600
    v_add_u32 v8, s52, v8
    s_cmp_lg_u32 s48, 0
    s_cbranch_scc1 L_wait_16
    s_mov_b32 s60, 400000
L_poll_17:
    buffer_load_dword v12, v8, s[40:43], 0 offen sc1
    s_waitcnt vmcnt(0)
    v_cmp_ne_u32 vcc, 0, v12
    s_nop 3
    s_cmp_eq_u64 vcc, -1
    s_cbranch_scc1 L_pout_18
    s_sub_u32 s60, s60, 1
    s_cmp_eq_u32 s60, 0
    s_cbranch_scc1 L_pout_18
    s_branch L_poll_17
L_pout_18:
L_wait_16:
    s_barrier
    s_lshl_b32 s52, s77, 12
    s_add_u32 s52, s52, 15728640
    s_lshl_b32 s53, s77, 8
    s_add_u32 s53, s53, 15761408
    v_lshlrev_b32 v6, 2, v1
    v_and_b32 v4, 1, v2
    v_lshlrev_b32 v5, 6, v4
    v_lshl_add_u32 v5, v3, 4, v5
    buffer_load_dword v100, v6, s[40:43], s52 offen offset:0 sc1
    buffer_load_dword v101, v6, s[40:43], s52 offen offset:256 sc1
    buffer_load_dword v102, v6, s[40:43], s52 offen offset:512 sc1
    buffer_load_dword v103, v6, s[40:43], s52 offen offset:768 sc1
    buffer_load_dword v104, v6, s[40:43], s52 offen offset:1024 sc1
    buffer_load_dword v105, v6, s[40:43], s52 offen offset:1280 sc1
    buffer_load_dword v106, v6, s[40:43], s52 offen offset:1536 sc1
    buffer_load_dword v107, v6, s[40:43], s52 offen offset:1792 sc1
    buffer_load_dword v108, v6, s[40:43], s52 offen offset:2048 sc1
    buffer_load_dword v109, v6, s[40:43], s52 offen offset:2304 sc1
    buffer_load_dword v110, v6, s[40:43], s52 offen offset:2560 sc1
    buffer_load_dword v111, v6, s[40:43], s52 offen offset:2816 sc1
    buffer_load_dword v112, v6, s[40:43], s52 offen offset:3072 sc1
    buffer_load_dword v113, v6, s[40:43], s52 offen offset:3328 sc1
    buffer_load_dword v114, v6, s[40:43], s52 offen offset:3584 sc1
    buffer_load_dword v115, v6, s[40:43], s52 offen offset:3840 sc1
    buffer_load_dwordx4 v[116:119], v5, s[40:43], s53 offen offset:0 sc1
    buffer_load_dwordx4 v[120:123], v5, s[40:43], s53 offen offset:128 sc1
    v_subrev_u32 v7, 1, v4
    v_not_b32 v8, v7
    v_mov_b32 v96, 0x358637bd
    v_mov_b32 v97, 0x358637bd
    v_mov_b32 v98, 0x358637bd
    v_mov_b32 v99, 0x358637bd
    s_lshl_b32 s56, s67, 14
    s_lshl_b32 s53, s77, 11
    s_add_u32 s56, s56, s53
    s_add_u32 s56, s56, 6291456
    s_add_u32 s57, s56, 16384
    s_mov_b32 s70, s56
    s_mov_b32 s71, s57
    s_lshr_b32 s54, s48, 1
    s_lshl_b32 s54, s54, 15
    s_add_u32 s54, s54, 65536
    v_lshrrev_b32 v12, 2, v1
    v_and_b32 v12, 3, v12
    v_and_b32 v13, 1, v3
    v_lshlrev_b32 v13, 1, v13
    v_lshrrev_b32 v14, 1, v12
    v_or_b32 v13, v13, v14
    v_lshl_add_u32 v14, v3, 2, v12
    v_lshlrev_b32 v14, 7, v14
    v_and_b32 v15, 3, v1
    v_lshl_add_u32 v14, v15, 3, v14
    v_add_u32 v14, s54, v14
    v_xor_b32 v15, 0, v13
    v_lshl_add_u32 v16, v15, 5, v14
    v_xor_b32 v15, 1, v13
    v_lshl_add_u32 v17, v15, 5, v14
    v_xor_b32 v15, 2, v13
    v_lshl_add_u32 v18, v15, 5, v14
    v_xor_b32 v15, 3, v13
    v_lshl_add_u32 v19, v15, 5, v14
    ds_read_b64_tr_b16 a[128:129], v16 offset:0
    ds_read_b64_tr_b16 a[130:131], v16 offset:2048
    ds_read_b64_tr_b16 a[132:133], v17 offset:0
    ds_read_b64_tr_b16 a[134:135], v17 offset:2048
    ds_read_b64_tr_b16 a[136:137], v18 offset:0
    ds_read_b64_tr_b16 a[138:139], v18 offset:2048
    ds_read_b64_tr_b16 a[140:141], v19 offset:0
    ds_read_b64_tr_b16 a[142:143], v19 offset:2048
    ds_read_b64_tr_b16 a[144:145], v16 offset:4096
    ds_read_b64_tr_b16 a[146:147], v16 offset:6144
    ds_read_b64_tr_b16 a[148:149], v17 offset:4096
    ds_read_b64_tr_b16 a[150:151], v17 offset:6144
    s_waitcnt lgkmcnt(11)
    ds_read_b64_tr_b16 a[152:153], v18 offset:4096
    s_waitcnt lgkmcnt(11)
    ds_read_b64_tr_b16 a[154:155], v18 offset:6144
    s_waitcnt lgkmcnt(11)
    ds_read_b64_tr_b16 a[156:157], v19 offset:4096
    s_waitcnt lgkmcnt(11)
    ds_read_b64_tr_b16 a[158:159], v19 offset:6144
    s_waitcnt lgkmcnt(11)
    ds_read_b64_tr_b16 a[160:161], v16 offset:8192
    s_waitcnt lgkmcnt(11)
    ds_read_b64_tr_b16 a[162:163], v16 offset:10240
    s_waitcnt lgkmcnt(11)
    ds_read_b64_tr_b16 a[164:165], v17 offset:8192
    s_waitcnt lgkmcnt(11)
    ds_read_b64_tr_b16 a[166:167], v17 offset:10240
    s_waitcnt lgkmcnt(11)
    ds_read_b64_tr_b16 a[168:169], v18 offset:8192
    s_waitcnt lgkmcnt(11)
    ds_read_b64_tr_b16 a[170:171], v18 offset:10240
    s_waitcnt lgkmcnt(11)
    ds_read_b64_tr_b16 a[172:173], v19 offset:8192
    s_waitcnt lgkmcnt(11)
    ds_read_b64_tr_b16 a[174:175], v19 offset:10240
    s_waitcnt lgkmcnt(11)
    ds_read_b64_tr_b16 a[176:177], v16 offset:12288
    s_waitcnt lgkmcnt(11)
    ds_read_b64_tr_b16 a[178:179], v16 offset:14336
    s_waitcnt lgkmcnt(11)
    ds_read_b64_tr_b16 a[180:181], v17 offset:12288
    s_waitcnt lgkmcnt(11)
    ds_read_b64_tr_b16 a[182:183], v17 offset:14336
    s_waitcnt lgkmcnt(11)
    ds_read_b64_tr_b16 a[184:185], v18 offset:12288
    s_waitcnt lgkmcnt(11)
    ds_read_b64_tr_b16 a[186:187], v18 offset:14336
    s_waitcnt lgkmcnt(11)
    ds_read_b64_tr_b16 a[188:189], v19 offset:12288
    s_waitcnt lgkmcnt(11)
    ds_read_b64_tr_b16 a[190:191], v19 offset:14336
    s_waitcnt lgkmcnt(11)
    ds_read_b64_tr_b16 a[192:193], v16 offset:16384
    s_waitcnt lgkmcnt(11)
    ds_read_b64_tr_b16 a[194:195], v16 offset:18432
    s_waitcnt lgkmcnt(11)
    ds_read_b64_tr_b16 a[196:197], v17 offset:16384
    s_waitcnt lgkmcnt(11)
    ds_read_b64_tr_b16 a[198:199], v17 offset:18432
    s_waitcnt lgkmcnt(11)
    ds_read_b64_tr_b16 a[200:201], v18 offset:16384
    s_waitcnt lgkmcnt(11)
    ds_read_b64_tr_b16 a[202:203], v18 offset:18432
    s_waitcnt lgkmcnt(11)
    ds_read_b64_tr_b16 a[204:205], v19 offset:16384
    s_waitcnt lgkmcnt(11)
    ds_read_b64_tr_b16 a[206:207], v19 offset:18432
    s_waitcnt lgkmcnt(11)
    ds_read_b64_tr_b16 a[208:209], v16 offset:20480
    s_waitcnt lgkmcnt(11)
    ds_read_b64_tr_b16 a[210:211], v16 offset:22528
    s_waitcnt lgkmcnt(11)
    ds_read_b64_tr_b16 a[212:213], v17 offset:20480
    s_waitcnt lgkmcnt(11)
    ds_read_b64_tr_b16 a[214:215], v17 offset:22528
    s_waitcnt lgkmcnt(11)
    ds_read_b64_tr_b16 a[216:217], v18 offset:20480
    s_waitcnt lgkmcnt(11)
    ds_read_b64_tr_b16 a[218:219], v18 offset:22528
    s_waitcnt lgkmcnt(11)
    ds_read_b64_tr_b16 a[220:221], v19 offset:20480
    s_waitcnt lgkmcnt(11)
    ds_read_b64_tr_b16 a[222:223], v19 offset:22528
    s_waitcnt lgkmcnt(11)
    ds_read_b64_tr_b16 a[224:225], v16 offset:24576
    s_waitcnt lgkmcnt(11)
    ds_read_b64_tr_b16 a[226:227], v16 offset:26624
    s_waitcnt lgkmcnt(11)
    ds_read_b64_tr_b16 a[228:229], v17 offset:24576
    s_waitcnt lgkmcnt(11)
    ds_read_b64_tr_b16 a[230:231], v17 offset:26624
    s_waitcnt lgkmcnt(11)
    ds_read_b64_tr_b16 a[232:233], v18 offset:24576
    s_waitcnt lgkmcnt(11)
    ds_read_b64_tr_b16 a[234:235], v18 offset:26624
    s_waitcnt lgkmcnt(11)
    ds_read_b64_tr_b16 a[236:237], v19 offset:24576
    s_waitcnt lgkmcnt(11)
    ds_read_b64_tr_b16 a[238:239], v19 offset:26624
    s_waitcnt lgkmcnt(11)
    ds_read_b64_tr_b16 a[240:241], v16 offset:28672
    s_waitcnt lgkmcnt(11)
    ds_read_b64_tr_b16 a[242:243], v16 offset:30720
    s_waitcnt lgkmcnt(11)
    ds_read_b64_tr_b16 a[244:245], v17 offset:28672
    s_waitcnt lgkmcnt(11)
    ds_read_b64_tr_b16 a[246:247], v17 offset:30720
    s_waitcnt lgkmcnt(11)
    ds_read_b64_tr_b16 a[248:249], v18 offset:28672
    s_waitcnt lgkmcnt(11)
    ds_read_b64_tr_b16 a[250:251], v18 offset:30720
    s_waitcnt lgkmcnt(11)
    ds_read_b64_tr_b16 a[252:253], v19 offset:28672
    s_waitcnt lgkmcnt(11)
    ds_read_b64_tr_b16 a[254:255], v19 offset:30720
    s_waitcnt lgkmcnt(11)
    s_waitcnt lgkmcnt(0)
    s_barrier
    s_add_u32 s6, s64, 917504
    s_add_u32 m0, s66, 57344
    s_nop 0
    buffer_load_dwordx4 v20, s[36:39], s6 offen offset:0 lds
    buffer_load_dwordx4 v21, s[36:39], s6 offen offset:1024 lds
    buffer_load_dwordx4 v22, s[36:39], s6 offen offset:2048 lds
    buffer_load_dwordx4 v23, s[36:39], s6 offen offset:3072 lds
    s_add_u32 m0, s66, 61440
    s_nop 0
    buffer_load_dwordx4 v24, s[36:39], s6 offen offset:0 lds
    buffer_load_dwordx4 v25, s[36:39], s6 offen offset:1024 lds
    buffer_load_dwordx4 v26, s[36:39], s6 offen offset:2048 lds
    s_add_u32 s6, s64, 1376256
    s_add_u32 m0, s66, 86016
    s_nop 0
    buffer_load_dwordx4 v20, s[36:39], s6 offen offset:0 lds
    buffer_load_dwordx4 v21, s[36:39], s6 offen offset:1024 lds
    buffer_load_dwordx4 v22, s[36:39], s6 offen offset:2048 lds
    buffer_load_dwordx4 v23, s[36:39], s6 offen offset:3072 lds
    s_add_u32 m0, s66, 90112
    s_nop 0
    buffer_load_dwordx4 v24, s[36:39], s6 offen offset:0 lds
    buffer_load_dwordx4 v25, s[36:39], s6 offen offset:1024 lds
    buffer_load_dwordx4 v26, s[36:39], s6 offen offset:2048 lds
    s_mov_b32 s56, s70
    s_mov_b32 s57, s71
    s_waitcnt vmcnt(14)
    v_cvt_pk_bf16_f32 v124, v100, v101
    v_cvt_pk_bf16_f32 v125, v102, v103
    v_cvt_pk_bf16_f32 v126, v104, v105
    v_cvt_pk_bf16_f32 v127, v106, v107
    v_cvt_pk_bf16_f32 v128, v108, v109
    v_cvt_pk_bf16_f32 v129, v110, v111
    v_cvt_pk_bf16_f32 v130, v112, v113
    v_cvt_pk_bf16_f32 v131, v114, v115
    v_cvt_pk_bf16_f32 v116, v116, v117
    v_cvt_pk_bf16_f32 v117, v118, v119
    v_and_b32 v132, v7, v116
    v_and_b32 v133, v7, v117
    v_and_b32 v134, v8, v116
    v_and_b32 v135, v8, v117
    v_cvt_pk_bf16_f32 v120, v120, v121
    v_cvt_pk_bf16_f32 v121, v122, v123
    v_and_b32 v136, v7, v120
    v_and_b32 v137, v7, v121
    v_and_b32 v138, v8, v120
    v_and_b32 v139, v8, v121
    v_mfma_f32_16x16x32_bf16 v[172:175], v[132:135], v[64:67], v[96:99]
    s_nop 0
    v_mfma_f32_16x16x32_bf16 v[176:179], v[136:139], v[68:71], v[96:99]
    v_mfma_f32_16x16x32_bf16 v[180:183], v[132:135], v[72:75], v[96:99]
    v_mfma_f32_16x16x32_bf16 v[184:187], v[136:139], v[76:79], v[96:99]
    v_mfma_f32_16x16x16_bf16 v[140:143], v[124:125], v[64:65], 0
    v_mfma_f32_16x16x16_bf16 v[144:147], v[126:127], v[66:67], 0
    v_mfma_f32_16x16x16_bf16 v[148:151], v[128:129], v[68:69], 0
    v_mfma_f32_16x16x16_bf16 v[152:155], v[130:131], v[70:71], 0
    v_mfma_f32_16x16x16_bf16 v[156:159], v[124:125], v[72:73], 0
    v_mfma_f32_16x16x16_bf16 v[160:163], v[126:127], v[74:75], 0
    v_mfma_f32_16x16x16_bf16 v[164:167], v[128:129], v[76:77], 0
    v_mfma_f32_16x16x16_bf16 v[168:171], v[130:131], v[78:79], 0
    v_rcp_f32 v172, v172
    v_rcp_f32 v173, v173
    v_rcp_f32 v176, v176
    v_rcp_f32 v177, v177
    v_rcp_f32 v180, v180
    v_rcp_f32 v181, v181
    v_rcp_f32 v184, v184
    v_rcp_f32 v185, v185
    v_mul_f32 v140, v140, v172
    v_mul_f32 v141, v141, v172
    v_mul_f32 v142, v142, v172
    v_mul_f32 v143, v143, v172
    v_cvt_pk_bf16_f32 v188, v140, v141
    v_cvt_pk_bf16_f32 v189, v142, v143
    v_mul_f32 v144, v144, v173
    v_mul_f32 v145, v145, v173
    v_mul_f32 v146, v146, v173
    v_mul_f32 v147, v147, v173
    v_cvt_pk_bf16_f32 v190, v144, v145
    v_cvt_pk_bf16_f32 v191, v146, v147
    buffer_store_dwordx4 v[188:191], v27, s[40:43], s56 offen offset:0 sc1
    v_mul_f32 v148, v148, v176
    v_mul_f32 v149, v149, v176
    v_mul_f32 v150, v150, v176
    v_mul_f32 v151, v151, v176
    v_cvt_pk_bf16_f32 v192, v148, v149
    v_cvt_pk_bf16_f32 v193, v150, v151
    v_mul_f32 v152, v152, v177
    v_mul_f32 v153, v153, v177
    v_mul_f32 v154, v154, v177
    v_mul_f32 v155, v155, v177
    v_cvt_pk_bf16_f32 v194, v152, v153
    v_cvt_pk_bf16_f32 v195, v154, v155
    buffer_store_dwordx4 v[192:195], v27, s[40:43], s56 offen offset:1024 sc1
    v_mul_f32 v156, v156, v180
    v_mul_f32 v157, v157, v180
    v_mul_f32 v158, v158, v180
    v_mul_f32 v159, v159, v180
    v_cvt_pk_bf16_f32 v196, v156, v157
    v_cvt_pk_bf16_f32 v197, v158, v159
    v_mul_f32 v160, v160, v181
    v_mul_f32 v161, v161, v181
    v_mul_f32 v162, v162, v181
    v_mul_f32 v163, v163, v181
    v_cvt_pk_bf16_f32 v198, v160, v161
    v_cvt_pk_bf16_f32 v199, v162, v163
    buffer_store_dwordx4 v[196:199], v27, s[40:43], s57 offen offset:0 sc1
    v_mul_f32 v164, v164, v184
    v_mul_f32 v165, v165, v184
    v_mul_f32 v166, v166, v184
    v_mul_f32 v167, v167, v184
    v_cvt_pk_bf16_f32 v200, v164, v165
    v_cvt_pk_bf16_f32 v201, v166, v167
    v_mul_f32 v168, v168, v185
    v_mul_f32 v169, v169, v185
    v_mul_f32 v170, v170, v185
    v_mul_f32 v171, v171, v185
    v_cvt_pk_bf16_f32 v202, v168, v169
    v_cvt_pk_bf16_f32 v203, v170, v171
    buffer_store_dwordx4 v[200:203], v27, s[40:43], s57 offen offset:1024 sc1
    s_waitcnt vmcnt(0)
    s_barrier
    s_cmp_lg_u32 s48, 0
    s_cbranch_scc1 L_sig_19
    s_lshl_b32 s52, s76, 7
    s_lshl_b32 s53, s77, 2
    s_add_u32 s52, s52, s53
    s_add_u32 s52, s52, 15770624
    v_mov_b32 v4, s52
    v_mov_b32 v5, 1
    s_mov_b64 exec, 1
    buffer_store_dword v5, v4, s[40:43], 0 offen sc1
    s_mov_b64 exec, -1
L_sig_19:
L_tail:
    s_lshl_b32 s67, s3, 3
    s_lshl_b32 s52, s48, 1
    s_add_u32 s67, s67, s52
    s_and_b32 s70, s51, 1
    v_lshlrev_b32 v26, 3, v1
    v_lshrrev_b32 v4, 2, v1
    v_and_b32 v4, 3, v4
    v_lshl_add_u32 v4, v3, 2, v4
    v_mul_u32_u24 v4, 224, v4
    v_and_b32 v5, 3, v1
    v_lshl_add_u32 v4, v5, 3, v4
    s_lshl_b32 s52, s70, 5
    v_add_u32 v16, s52, v4
    v_add_u32 v17, 57344, v16
    s_mul_i32 s52, s70, 192
    s_sub_u32 s52, 192, s52
    v_add_u32 v18, s52, v4
    v_add_u32 v19, 57344, v18
    s_lshl_b32 s52, s48, 5
    v_add_u32 v20, s52, v4
    s_add_u32 s53, s48, 4
    s_min_u32 s53, s53, 6
    s_lshl_b32 s53, s53, 5
    v_add_u32 v21, s53, v4
    v_mov_b32 v108, 0x3f803f80
    v_mov_b32 v109, 0x3f803f80
    v_mov_b32 v110, 0x3f803f80
    v_mov_b32 v111, 0x3f803f80
    v_mov_b32 v112, 0
    v_mov_b32 v113, 0
    v_mov_b32 v114, 0
    v_mov_b32 v115, 0
    v_mov_b32 v116, 0
    v_mov_b32 v117, 0
    v_mov_b32 v118, 0
    v_mov_b32 v119, 0
    v_and_b32 v8, 7, v1
    v_lshlrev_b32 v8, 2, v8
    s_lshl_b32 s53, s49, 7
    s_add_u32 s53, s53, 15770624
    v_add_u32 v212, s53, v8
    s_lshl_b32 s53, s3, 7
    s_add_u32 s52, s53, 15765504
    v_add_u32 v8, s52, v8
    s_cmp_lg_u32 s48, 0
    s_cbranch_scc1 L_wait_20
    s_mov_b32 s60, 400000
L_poll_21:
    buffer_load_dword v12, v8, s[40:43], 0 offen sc1
    s_waitcnt vmcnt(0)
    v_cmp_ne_u32 vcc, 0, v12
    s_nop 3
    s_cmp_eq_u64 vcc, -1
    s_cbranch_scc1 L_pout_22
    s_sub_u32 s60, s60, 1
    s_cmp_eq_u32 s60, 0
    s_cbranch_scc1 L_pout_22
    s_branch L_poll_21
L_pout_22:
L_wait_20:
    s_barrier
    s_mul_i32 s68, s67, 16384
    s_add_u32 s68, s68, 4194304
    s_add_u32 s69, s68, 16384
    buffer_load_dwordx4 a[0:3], v27, s[40:43], s68 offen offset:0 sc1
    buffer_load_dwordx4 a[4:7], v27, s[40:43], s69 offen offset:0 sc1
    buffer_load_dwordx4 a[8:11], v27, s[40:43], s68 offen offset:1024 sc1
    buffer_load_dwordx4 a[12:15], v27, s[40:43], s69 offen offset:1024 sc1
    buffer_load_dwordx4 a[16:19], v27, s[40:43], s68 offen offset:2048 sc1
    buffer_load_dwordx4 a[20:23], v27, s[40:43], s69 offen offset:2048 sc1
    buffer_load_dwordx4 a[24:27], v27, s[40:43], s68 offen offset:3072 sc1
    buffer_load_dwordx4 a[28:31], v27, s[40:43], s69 offen offset:3072 sc1
    s_add_u32 s68, s68, 4096
    s_add_u32 s69, s69, 4096
    buffer_load_dwordx4 a[32:35], v27, s[40:43], s68 offen offset:0 sc1
    buffer_load_dwordx4 a[36:39], v27, s[40:43], s69 offen offset:0 sc1
    buffer_load_dwordx4 a[40:43], v27, s[40:43], s68 offen offset:1024 sc1
    buffer_load_dwordx4 a[44:47], v27, s[40:43], s69 offen offset:1024 sc1
    s_waitcnt vmcnt(12)
    s_barrier
    ds_read_b64_tr_b16 v[28:29], v20 offset:0
    ds_read_b64_tr_b16 v[30:31], v20 offset:3584
    ds_read_b64_tr_b16 v[32:33], v21 offset:0
    ds_read_b64_tr_b16 v[34:35], v21 offset:3584
    ds_read_b64_tr_b16 v[36:37], v20 offset:7168
    ds_read_b64_tr_b16 v[38:39], v20 offset:10752
    ds_read_b64_tr_b16 v[40:41], v21 offset:7168
    ds_read_b64_tr_b16 v[42:43], v21 offset:10752
    ds_read_b64_tr_b16 v[44:45], v20 offset:14336
    ds_read_b64_tr_b16 v[46:47], v20 offset:17920
    s_waitcnt lgkmcnt(8)
    v_mfma_f32_16x16x32_bf16 v[112:115], v[28:31], v[108:111], v[112:115]
    ds_read_b64_tr_b16 v[48:49], v21 offset:14336
    ds_read_b64_tr_b16 v[50:51], v21 offset:17920
    s_waitcnt lgkmcnt(8)
    v_mfma_f32_16x16x32_bf16 v[116:119], v[32:35], v[108:111], v[116:119]
    ds_read_b64_tr_b16 v[28:29], v20 offset:21504
    ds_read_b64_tr_b16 v[30:31], v20 offset:25088
    s_waitcnt lgkmcnt(8)
    v_mfma_f32_16x16x32_bf16 v[112:115], v[36:39], v[108:111], v[112:115]
    ds_read_b64_tr_b16 v[32:33], v21 offset:21504
    ds_read_b64_tr_b16 v[34:35], v21 offset:25088
    s_waitcnt lgkmcnt(8)
    v_mfma_f32_16x16x32_bf16 v[116:119], v[40:43], v[108:111], v[116:119]
    ds_read_b64_tr_b16 v[36:37], v20 offset:28672
    ds_read_b64_tr_b16 v[38:39], v20 offset:32256
    s_waitcnt lgkmcnt(8)
    v_mfma_f32_16x16x32_bf16 v[112:115], v[44:47], v[108:111], v[112:115]
    ds_read_b64_tr_b16 v[40:41], v21 offset:28672
    ds_read_b64_tr_b16 v[42:43], v21 offset:32256
    s_waitcnt lgkmcnt(8)
    v_mfma_f32_16x16x32_bf16 v[116:119], v[48:51], v[108:111], v[116:119]
    ds_read_b64_tr_b16 v[44:45], v20 offset:35840
    ds_read_b64_tr_b16 v[46:47], v20 offset:39424
    s_waitcnt lgkmcnt(8)
    v_mfma_f32_16x16x32_bf16 v[112:115], v[28:31], v[108:111], v[112:115]
    ds_read_b64_tr_b16 v[48:49], v21 offset:35840
    ds_read_b64_tr_b16 v[50:51], v21 offset:39424
    s_waitcnt lgkmcnt(8)
    v_mfma_f32_16x16x32_bf16 v[116:119], v[32:35], v[108:111], v[116:119]
    ds_read_b64_tr_b16 v[28:29], v20 offset:43008
    ds_read_b64_tr_b16 v[30:31], v20 offset:46592
    s_waitcnt lgkmcnt(8)
    v_mfma_f32_16x16x32_bf16 v[112:115], v[36:39], v[108:111], v[112:115]
    ds_read_b64_tr_b16 v[32:33], v21 offset:43008
    ds_read_b64_tr_b16 v[34:35], v21 offset:46592
    s_waitcnt lgkmcnt(8)
    v_mfma_f32_16x16x32_bf16 v[116:119], v[40:43], v[108:111], v[116:119]
    ds_read_b64_tr_b16 v[36:37], v20 offset:50176
    ds_read_b64_tr_b16 v[38:39], v20 offset:53760
    s_waitcnt lgkmcnt(8)
    v_mfma_f32_16x16x32_bf16 v[112:115], v[44:47], v[108:111], v[112:115]
    ds_read_b64_tr_b16 v[40:41], v21 offset:50176
    ds_read_b64_tr_b16 v[42:43], v21 offset:53760
    s_waitcnt lgkmcnt(8)
    v_mfma_f32_16x16x32_bf16 v[116:119], v[48:51], v[108:111], v[116:119]
    v_add_u32 v20, 57344, v20
    ds_read_b64_tr_b16 v[44:45], v20 offset:0
    ds_read_b64_tr_b16 v[46:47], v20 offset:3584
    s_waitcnt lgkmcnt(8)
    v_mfma_f32_16x16x32_bf16 v[112:115], v[28:31], v[108:111], v[112:115]
    v_add_u32 v21, 57344, v21
    ds_read_b64_tr_b16 v[48:49], v21 offset:0
    ds_read_b64_tr_b16 v[50:51], v21 offset:3584
    s_waitcnt lgkmcnt(8)
    v_mfma_f32_16x16x32_bf16 v[116:119], v[32:35], v[108:111], v[116:119]
    ds_read_b64_tr_b16 v[28:29], v20 offset:7168
    ds_read_b64_tr_b16 v[30:31], v20 offset:10752
    s_waitcnt lgkmcnt(8)
    v_mfma_f32_16x16x32_bf16 v[112:115], v[36:39], v[108:111], v[112:115]
    ds_read_b64_tr_b16 v[32:33], v21 offset:7168
    ds_read_b64_tr_b16 v[34:35], v21 offset:10752
    s_waitcnt lgkmcnt(8)
    v_mfma_f32_16x16x32_bf16 v[116:119], v[40:43], v[108:111], v[116:119]
    ds_read_b64_tr_b16 v[36:37], v20 offset:14336
    ds_read_b64_tr_b16 v[38:39], v20 offset:17920
    s_waitcnt lgkmcnt(8)
    v_mfma_f32_16x16x32_bf16 v[112:115], v[44:47], v[108:111], v[112:115]
    ds_read_b64_tr_b16 v[40:41], v21 offset:14336
    ds_read_b64_tr_b16 v[42:43], v21 offset:17920
    s_waitcnt lgkmcnt(8)
    v_mfma_f32_16x16x32_bf16 v[116:119], v[48:51], v[108:111], v[116:119]
    ds_read_b64_tr_b16 v[44:45], v20 offset:21504
    ds_read_b64_tr_b16 v[46:47], v20 offset:25088
    s_waitcnt lgkmcnt(8)
    v_mfma_f32_16x16x32_bf16 v[112:115], v[28:31], v[108:111], v[112:115]
    ds_read_b64_tr_b16 v[48:49], v21 offset:21504
    ds_read_b64_tr_b16 v[50:51], v21 offset:25088
    s_waitcnt lgkmcnt(8)
    v_mfma_f32_16x16x32_bf16 v[116:119], v[32:35], v[108:111], v[116:119]
    ds_read_b64_tr_b16 v[28:29], v20 offset:28672
    ds_read_b64_tr_b16 v[30:31], v20 offset:32256
    s_waitcnt lgkmcnt(8)
    v_mfma_f32_16x16x32_bf16 v[112:115], v[36:39], v[108:111], v[112:115]
    ds_read_b64_tr_b16 v[32:33], v21 offset:28672
    ds_read_b64_tr_b16 v[34:35], v21 offset:32256
    s_waitcnt lgkmcnt(8)
    v_mfma_f32_16x16x32_bf16 v[116:119], v[40:43], v[108:111], v[116:119]
    ds_read_b64_tr_b16 v[36:37], v20 offset:35840
    ds_read_b64_tr_b16 v[38:39], v20 offset:39424
    s_waitcnt lgkmcnt(8)
    v_mfma_f32_16x16x32_bf16 v[112:115], v[44:47], v[108:111], v[112:115]
    ds_read_b64_tr_b16 v[40:41], v21 offset:35840
    ds_read_b64_tr_b16 v[42:43], v21 offset:39424
    s_waitcnt lgkmcnt(8)
    v_mfma_f32_16x16x32_bf16 v[116:119], v[48:51], v[108:111], v[116:119]
    ds_read_b64_tr_b16 v[44:45], v20 offset:43008
    ds_read_b64_tr_b16 v[46:47], v20 offset:46592
    s_waitcnt lgkmcnt(8)
    v_mfma_f32_16x16x32_bf16 v[112:115], v[28:31], v[108:111], v[112:115]
    ds_read_b64_tr_b16 v[48:49], v21 offset:43008
    ds_read_b64_tr_b16 v[50:51], v21 offset:46592
    s_waitcnt lgkmcnt(8)
    v_mfma_f32_16x16x32_bf16 v[116:119], v[32:35], v[108:111], v[116:119]
    ds_read_b64_tr_b16 v[28:29], v20 offset:50176
    ds_read_b64_tr_b16 v[30:31], v20 offset:53760
    s_waitcnt lgkmcnt(8)
    v_mfma_f32_16x16x32_bf16 v[112:115], v[36:39], v[108:111], v[112:115]
    ds_read_b64_tr_b16 v[32:33], v21 offset:50176
    ds_read_b64_tr_b16 v[34:35], v21 offset:53760
    s_waitcnt lgkmcnt(8)
    v_mfma_f32_16x16x32_bf16 v[116:119], v[40:43], v[108:111], v[116:119]
    s_waitcnt lgkmcnt(6)
    v_mfma_f32_16x16x32_bf16 v[112:115], v[44:47], v[108:111], v[112:115]
    s_waitcnt lgkmcnt(4)
    v_mfma_f32_16x16x32_bf16 v[116:119], v[48:51], v[108:111], v[116:119]
    s_waitcnt lgkmcnt(2)
    v_mfma_f32_16x16x32_bf16 v[112:115], v[28:31], v[108:111], v[112:115]
    s_waitcnt lgkmcnt(0)
    v_mfma_f32_16x16x32_bf16 v[116:119], v[32:35], v[108:111], v[116:119]
    v_lshlrev_b32 v4, 4, v3
    v_add_u32 v4, 159744, v4
    s_lshl_b32 s52, s48, 6
    v_add_u32 v5, s52, v4
    s_add_u32 s53, s48, 4
    s_min_u32 s53, s53, 6
    s_lshl_b32 s53, s53, 6
    v_add_u32 v6, s53, v4
    v_cmp_eq_u32 vcc, 0, v2
    s_nop 3
    s_and_saveexec_b64 s[54:55], vcc
    ds_write_b128 v5, v[112:115]
    ds_write_b128 v6, v[116:119]
    s_mov_b64 exec, s[54:55]
    s_waitcnt lgkmcnt(0)
    s_barrier
    s_lshl_b32 s52, s70, 6
    v_add_u32 v5, s52, v4
    s_mul_i32 s52, s70, 384
    s_sub_u32 s52, 384, s52
    v_add_u32 v6, s52, v4
    ds_read_b128 v[144:147], v5 offset:0
    ds_read_b128 v[148:151], v5 offset:64
    ds_read_b128 v[152:155], v5 offset:128
    ds_read_b128 v[156:159], v5 offset:192
    ds_read_b128 v[160:163], v5 offset:256
    ds_read_b128 v[164:167], v5 offset:320
    ds_read_b128 v[168:171], v6
    s_waitcnt lgkmcnt(0)
    s_barrier
    s_mov_b32 s36, s22
    s_and_b32 s37, s23, 0xffff
    s_mov_b32 s38, 0x1c0000
    s_mov_b32 s39, 0x20000
    v_lshrrev_b32 v4, 3, v1
    v_and_b32 v5, 7, v1
    v_and_b32 v6, 6, v4
    v_xor_b32 v5, v5, v6
    v_lshlrev_b32 v5, 4, v5
    v_mul_u32_u24 v4, 1024, v4
    v_add_u32 v20, v4, v5
    v_add_u32 v21, 7168, v20
    v_add_u32 v22, 14336, v20
    v_add_u32 v23, 21504, v20
    s_and_b32 s72, s50, 7
    s_lshl_b32 s72, s72, 7
    s_lshl_b32 s52, s48, 15
    s_add_u32 s72, s72, s52
    s_lshl_b32 s73, s48, 12
    ds_read_b64_tr_b16 v[28:29], v16 offset:0
    ds_read_b64_tr_b16 v[30:31], v16 offset:3584
    ds_read_b64_tr_b16 v[32:33], v16 offset:32
    ds_read_b64_tr_b16 v[34:35], v16 offset:3616
    ds_read_b64_tr_b16 v[36:37], v16 offset:64
    ds_read_b64_tr_b16 v[38:39], v16 offset:3648
    ds_read_b64_tr_b16 v[40:41], v16 offset:96
    ds_read_b64_tr_b16 v[42:43], v16 offset:3680
    ds_read_b64_tr_b16 v[44:45], v16 offset:128
    ds_read_b64_tr_b16 v[46:47], v16 offset:3712
    s_waitcnt vmcnt(10)
    s_waitcnt lgkmcnt(8)
    v_mfma_f32_16x16x32_bf16 v[52:55], v[28:31], a[0:3], 0
    ds_read_b64_tr_b16 v[48:49], v16 offset:160
    v_mfma_f32_16x16x32_bf16 v[80:83], v[28:31], a[4:7], 0
    ds_read_b64_tr_b16 v[50:51], v16 offset:3744
    s_waitcnt lgkmcnt(8)
    v_mfma_f32_16x16x32_bf16 v[56:59], v[32:35], a[0:3], 0
    ds_read_b64_tr_b16 v[28:29], v18 offset:0
    v_mfma_f32_16x16x32_bf16 v[84:87], v[32:35], a[4:7], 0
    ds_read_b64_tr_b16 v[30:31], v18 offset:3584
    buffer_load_dwordx4 a[48:51], v27, s[40:43], s68 offen offset:2048 sc1
    buffer_load_dwordx4 a[52:55], v27, s[40:43], s69 offen offset:2048 sc1
    s_waitcnt lgkmcnt(8)
    v_mfma_f32_16x16x32_bf16 v[60:63], v[36:39], a[0:3], 0
    ds_read_b64_tr_b16 v[32:33], v16 offset:7168
    v_mfma_f32_16x16x32_bf16 v[88:91], v[36:39], a[4:7], 0
    ds_read_b64_tr_b16 v[34:35], v16 offset:10752
    s_waitcnt lgkmcnt(8)
    v_mfma_f32_16x16x32_bf16 v[64:67], v[40:43], a[0:3], 0
    ds_read_b64_tr_b16 v[36:37], v16 offset:7200
    v_mfma_f32_16x16x32_bf16 v[92:95], v[40:43], a[4:7], 0
    ds_read_b64_tr_b16 v[38:39], v16 offset:10784
    s_waitcnt lgkmcnt(8)
    v_mfma_f32_16x16x32_bf16 v[68:71], v[44:47], a[0:3], 0
    ds_read_b64_tr_b16 v[40:41], v16 offset:7232
    v_mfma_f32_16x16x32_bf16 v[96:99], v[44:47], a[4:7], 0
    ds_read_b64_tr_b16 v[42:43], v16 offset:10816
    s_waitcnt lgkmcnt(8)
    v_mfma_f32_16x16x32_bf16 v[72:75], v[48:51], a[0:3], 0
    ds_read_b64_tr_b16 v[44:45], v16 offset:7264
    v_mfma_f32_16x16x32_bf16 v[100:103], v[48:51], a[4:7], 0
    ds_read_b64_tr_b16 v[46:47], v16 offset:10848
    s_waitcnt lgkmcnt(8)
    v_mfma_f32_16x16x32_bf16 v[76:79], v[28:31], a[0:3], 0
    ds_read_b64_tr_b16 v[48:49], v16 offset:7296
    v_mfma_f32_16x16x32_bf16 v[104:107], v[28:31], a[4:7], 0
    ds_read_b64_tr_b16 v[50:51], v16 offset:10880
    s_waitcnt vmcnt(10)
    s_waitcnt lgkmcnt(8)
    v_mfma_f32_16x16x32_bf16 v[52:55], v[32:35], a[8:11], v[52:55]
    ds_read_b64_tr_b16 v[28:29], v16 offset:7328
    v_mfma_f32_16x16x32_bf16 v[80:83], v[32:35], a[12:15], v[80:83]
    ds_read_b64_tr_b16 v[30:31], v16 offset:10912
    s_waitcnt lgkmcnt(8)
    v_mfma_f32_16x16x32_bf16 v[56:59], v[36:39], a[8:11], v[56:59]
    ds_read_b64_tr_b16 v[32:33], v18 offset:7168
    v_mfma_f32_16x16x32_bf16 v[84:87], v[36:39], a[12:15], v[84:87]
    ds_read_b64_tr_b16 v[34:35], v18 offset:10752
    buffer_load_dwordx4 a[56:59], v27, s[40:43], s68 offen offset:3072 sc1
    buffer_load_dwordx4 a[60:63], v27, s[40:43], s69 offen offset:3072 sc1
    s_waitcnt lgkmcnt(8)
    v_mfma_f32_16x16x32_bf16 v[60:63], v[40:43], a[8:11], v[60:63]
    ds_read_b64_tr_b16 v[36:37], v16 offset:14336
    v_mfma_f32_16x16x32_bf16 v[88:91], v[40:43], a[12:15], v[88:91]
    ds_read_b64_tr_b16 v[38:39], v16 offset:17920
    buffer_load_dword v213, v212, s[40:43], 0 offen sc1
    s_waitcnt lgkmcnt(8)
    v_mfma_f32_16x16x32_bf16 v[64:67], v[44:47], a[8:11], v[64:67]
    ds_read_b64_tr_b16 v[40:41], v16 offset:14368
    v_mfma_f32_16x16x32_bf16 v[92:95], v[44:47], a[12:15], v[92:95]
    ds_read_b64_tr_b16 v[42:43], v16 offset:17952
    s_waitcnt lgkmcnt(8)
    v_mfma_f32_16x16x32_bf16 v[68:71], v[48:51], a[8:11], v[68:71]
    ds_read_b64_tr_b16 v[44:45], v16 offset:14400
    v_mfma_f32_16x16x32_bf16 v[96:99], v[48:51], a[12:15], v[96:99]
    ds_read_b64_tr_b16 v[46:47], v16 offset:17984
    s_waitcnt lgkmcnt(8)
    v_mfma_f32_16x16x32_bf16 v[72:75], v[28:31], a[8:11], v[72:75]
    ds_read_b64_tr_b16 v[48:49], v16 offset:14432
    v_mfma_f32_16x16x32_bf16 v[100:103], v[28:31], a[12:15], v[100:103]
    ds_read_b64_tr_b16 v[50:51], v16 offset:18016
    s_waitcnt lgkmcnt(8)
    v_mfma_f32_16x16x32_bf16 v[76:79], v[32:35], a[8:11], v[76:79]
    ds_read_b64_tr_b16 v[28:29], v16 offset:14464
    v_mfma_f32_16x16x32_bf16 v[104:107], v[32:35], a[12:15], v[104:107]
    ds_read_b64_tr_b16 v[30:31], v16 offset:18048
    s_waitcnt vmcnt(11)
    s_waitcnt lgkmcnt(8)
    v_mfma_f32_16x16x32_bf16 v[52:55], v[36:39], a[16:19], v[52:55]
    ds_read_b64_tr_b16 v[32:33], v16 offset:14496
    v_mfma_f32_16x16x32_bf16 v[80:83], v[36:39], a[20:23], v[80:83]
    ds_read_b64_tr_b16 v[34:35], v16 offset:18080
    s_waitcnt lgkmcnt(8)
    v_mfma_f32_16x16x32_bf16 v[56:59], v[40:43], a[16:19], v[56:59]
    ds_read_b64_tr_b16 v[36:37], v18 offset:14336
    v_mfma_f32_16x16x32_bf16 v[84:87], v[40:43], a[20:23], v[84:87]
    ds_read_b64_tr_b16 v[38:39], v18 offset:17920
    s_add_u32 s68, s68, 4096
    s_add_u32 s69, s69, 4096
    buffer_load_dwordx4 a[64:67], v27, s[40:43], s68 offen offset:0 sc1
    buffer_load_dwordx4 a[68:71], v27, s[40:43], s69 offen offset:0 sc1
    s_waitcnt lgkmcnt(8)
    v_mfma_f32_16x16x32_bf16 v[60:63], v[44:47], a[16:19], v[60:63]
    ds_read_b64_tr_b16 v[40:41], v16 offset:21504
    v_mfma_f32_16x16x32_bf16 v[88:91], v[44:47], a[20:23], v[88:91]
    ds_read_b64_tr_b16 v[42:43], v16 offset:25088
    s_waitcnt lgkmcnt(8)
    v_mfma_f32_16x16x32_bf16 v[64:67], v[48:51], a[16:19], v[64:67]
    ds_read_b64_tr_b16 v[44:45], v16 offset:21536
    v_mfma_f32_16x16x32_bf16 v[92:95], v[48:51], a[20:23], v[92:95]
    ds_read_b64_tr_b16 v[46:47], v16 offset:25120
    s_waitcnt lgkmcnt(8)
    v_mfma_f32_16x16x32_bf16 v[68:71], v[28:31], a[16:19], v[68:71]
    ds_read_b64_tr_b16 v[48:49], v16 offset:21568
    v_mfma_f32_16x16x32_bf16 v[96:99], v[28:31], a[20:23], v[96:99]
    ds_read_b64_tr_b16 v[50:51], v16 offset:25152
    s_waitcnt lgkmcnt(8)
    v_mfma_f32_16x16x32_bf16 v[72:75], v[32:35], a[16:19], v[72:75]
    ds_read_b64_tr_b16 v[28:29], v16 offset:21600
    v_mfma_f32_16x16x32_bf16 v[100:103], v[32:35], a[20:23], v[100:103]
    ds_read_b64_tr_b16 v[30:31], v16 offset:25184
    s_waitcnt lgkmcnt(8)
    v_mfma_f32_16x16x32_bf16 v[76:79], v[36:39], a[16:19], v[76:79]
    ds_read_b64_tr_b16 v[32:33], v16 offset:21632
    v_mfma_f32_16x16x32_bf16 v[104:107], v[36:39], a[20:23], v[104:107]
    ds_read_b64_tr_b16 v[34:35], v16 offset:25216
    s_waitcnt vmcnt(11)
    s_waitcnt lgkmcnt(8)
    v_mfma_f32_16x16x32_bf16 v[52:55], v[40:43], a[24:27], v[52:55]
    ds_read_b64_tr_b16 v[36:37], v16 offset:21664
    v_mfma_f32_16x16x32_bf16 v[80:83], v[40:43], a[28:31], v[80:83]
    ds_read_b64_tr_b16 v[38:39], v16 offset:25248
    s_waitcnt lgkmcnt(8)
    v_mfma_f32_16x16x32_bf16 v[56:59], v[44:47], a[24:27], v[56:59]
    ds_read_b64_tr_b16 v[40:41], v18 offset:21504
    v_mfma_f32_16x16x32_bf16 v[84:87], v[44:47], a[28:31], v[84:87]
    ds_read_b64_tr_b16 v[42:43], v18 offset:25088
    buffer_load_dwordx4 a[72:75], v27, s[40:43], s68 offen offset:1024 sc1
    buffer_load_dwordx4 a[76:79], v27, s[40:43], s69 offen offset:1024 sc1
    s_waitcnt lgkmcnt(8)
    v_mfma_f32_16x16x32_bf16 v[60:63], v[48:51], a[24:27], v[60:63]
    ds_read_b64_tr_b16 v[44:45], v16 offset:28672
    v_mfma_f32_16x16x32_bf16 v[88:91], v[48:51], a[28:31], v[88:91]
    ds_read_b64_tr_b16 v[46:47], v16 offset:32256
    s_waitcnt lgkmcnt(8)
    v_mfma_f32_16x16x32_bf16 v[64:67], v[28:31], a[24:27], v[64:67]
    ds_read_b64_tr_b16 v[48:49], v16 offset:28704
    v_mfma_f32_16x16x32_bf16 v[92:95], v[28:31], a[28:31], v[92:95]
    ds_read_b64_tr_b16 v[50:51], v16 offset:32288
    s_waitcnt lgkmcnt(8)
    v_mfma_f32_16x16x32_bf16 v[68:71], v[32:35], a[24:27], v[68:71]
    ds_read_b64_tr_b16 v[28:29], v16 offset:28736
    v_mfma_f32_16x16x32_bf16 v[96:99], v[32:35], a[28:31], v[96:99]
    ds_read_b64_tr_b16 v[30:31], v16 offset:32320
    s_add_u32 m0, s73, 114688
    s_add_u32 s6, s72, 1179648
    buffer_load_dwordx4 v20, s[36:39], s6 offen offset:0 lds
    s_waitcnt lgkmcnt(8)
    v_mfma_f32_16x16x32_bf16 v[72:75], v[36:39], a[24:27], v[72:75]
    ds_read_b64_tr_b16 v[32:33], v16 offset:28768
    v_mfma_f32_16x16x32_bf16 v[100:103], v[36:39], a[28:31], v[100:103]
    ds_read_b64_tr_b16 v[34:35], v16 offset:32352
    s_waitcnt lgkmcnt(8)
    v_mfma_f32_16x16x32_bf16 v[76:79], v[40:43], a[24:27], v[76:79]
    ds_read_b64_tr_b16 v[36:37], v16 offset:28800
    v_mfma_f32_16x16x32_bf16 v[104:107], v[40:43], a[28:31], v[104:107]
    ds_read_b64_tr_b16 v[38:39], v16 offset:32384
    s_waitcnt vmcnt(12)
    s_waitcnt lgkmcnt(8)
    v_mfma_f32_16x16x32_bf16 v[52:55], v[44:47], a[32:35], v[52:55]
    ds_read_b64_tr_b16 v[40:41], v16 offset:28832
    v_mfma_f32_16x16x32_bf16 v[80:83], v[44:47], a[36:39], v[80:83]
    ds_read_b64_tr_b16 v[42:43], v16 offset:32416
    s_waitcnt lgkmcnt(8)
    v_mfma_f32_16x16x32_bf16 v[56:59], v[48:51], a[32:35], v[56:59]
    ds_read_b64_tr_b16 v[44:45], v18 offset:28672
    v_mfma_f32_16x16x32_bf16 v[84:87], v[48:51], a[36:39], v[84:87]
    ds_read_b64_tr_b16 v[46:47], v18 offset:32256
    buffer_load_dwordx4 a[80:83], v27, s[40:43], s68 offen offset:2048 sc1
    buffer_load_dwordx4 a[84:87], v27, s[40:43], s69 offen offset:2048 sc1
    s_waitcnt lgkmcnt(8)
    v_mfma_f32_16x16x32_bf16 v[60:63], v[28:31], a[32:35], v[60:63]
    ds_read_b64_tr_b16 v[48:49], v16 offset:35840
    v_mfma_f32_16x16x32_bf16 v[88:91], v[28:31], a[36:39], v[88:91]
    ds_read_b64_tr_b16 v[50:51], v16 offset:39424
    s_waitcnt lgkmcnt(8)
    v_mfma_f32_16x16x32_bf16 v[64:67], v[32:35], a[32:35], v[64:67]
    ds_read_b64_tr_b16 v[28:29], v16 offset:35872
    v_mfma_f32_16x16x32_bf16 v[92:95], v[32:35], a[36:39], v[92:95]
    ds_read_b64_tr_b16 v[30:31], v16 offset:39456
    s_waitcnt lgkmcnt(8)
    v_mfma_f32_16x16x32_bf16 v[68:71], v[36:39], a[32:35], v[68:71]
    ds_read_b64_tr_b16 v[32:33], v16 offset:35904
    v_mfma_f32_16x16x32_bf16 v[96:99], v[36:39], a[36:39], v[96:99]
    ds_read_b64_tr_b16 v[34:35], v16 offset:39488
    buffer_load_dwordx4 v21, s[36:39], s6 offen offset:1024 lds
    s_waitcnt lgkmcnt(8)
    v_mfma_f32_16x16x32_bf16 v[72:75], v[40:43], a[32:35], v[72:75]
    ds_read_b64_tr_b16 v[36:37], v16 offset:35936
    v_mfma_f32_16x16x32_bf16 v[100:103], v[40:43], a[36:39], v[100:103]
    ds_read_b64_tr_b16 v[38:39], v16 offset:39520
    s_waitcnt lgkmcnt(8)
    v_mfma_f32_16x16x32_bf16 v[76:79], v[44:47], a[32:35], v[76:79]
    ds_read_b64_tr_b16 v[40:41], v16 offset:35968
    v_mfma_f32_16x16x32_bf16 v[104:107], v[44:47], a[36:39], v[104:107]
    ds_read_b64_tr_b16 v[42:43], v16 offset:39552
    s_waitcnt vmcnt(13)
    s_waitcnt lgkmcnt(8)
    v_mfma_f32_16x16x32_bf16 v[52:55], v[48:51], a[40:43], v[52:55]
    ds_read_b64_tr_b16 v[44:45], v16 offset:36000
    v_mfma_f32_16x16x32_bf16 v[80:83], v[48:51], a[44:47], v[80:83]
    ds_read_b64_tr_b16 v[46:47], v16 offset:39584
    s_waitcnt lgkmcnt(8)
    v_mfma_f32_16x16x32_bf16 v[56:59], v[28:31], a[40:43], v[56:59]
    ds_read_b64_tr_b16 v[48:49], v18 offset:35840
    v_mfma_f32_16x16x32_bf16 v[84:87], v[28:31], a[44:47], v[84:87]
    ds_read_b64_tr_b16 v[50:51], v18 offset:39424
    buffer_load_dwordx4 a[88:91], v27, s[40:43], s68 offen offset:3072 sc1
    buffer_load_dwordx4 a[92:95], v27, s[40:43], s69 offen offset:3072 sc1
    s_waitcnt lgkmcnt(8)
    v_mfma_f32_16x16x32_bf16 v[60:63], v[32:35], a[40:43], v[60:63]
    ds_read_b64_tr_b16 v[28:29], v16 offset:43008
    v_mfma_f32_16x16x32_bf16 v[88:91], v[32:35], a[44:47], v[88:91]
    ds_read_b64_tr_b16 v[30:31], v16 offset:46592
    s_waitcnt lgkmcnt(8)
    v_mfma_f32_16x16x32_bf16 v[64:67], v[36:39], a[40:43], v[64:67]
    ds_read_b64_tr_b16 v[32:33], v16 offset:43040
    v_mfma_f32_16x16x32_bf16 v[92:95], v[36:39], a[44:47], v[92:95]
    ds_read_b64_tr_b16 v[34:35], v16 offset:46624
    s_waitcnt lgkmcnt(8)
    v_mfma_f32_16x16x32_bf16 v[68:71], v[40:43], a[40:43], v[68:71]
    ds_read_b64_tr_b16 v[36:37], v16 offset:43072
    v_mfma_f32_16x16x32_bf16 v[96:99], v[40:43], a[44:47], v[96:99]
    ds_read_b64_tr_b16 v[38:39], v16 offset:46656
    buffer_load_dwordx4 v22, s[36:39], s6 offen offset:2048 lds
    s_waitcnt lgkmcnt(8)
    v_mfma_f32_16x16x32_bf16 v[72:75], v[44:47], a[40:43], v[72:75]
    ds_read_b64_tr_b16 v[40:41], v16 offset:43104
    v_mfma_f32_16x16x32_bf16 v[100:103], v[44:47], a[44:47], v[100:103]
    ds_read_b64_tr_b16 v[42:43], v16 offset:46688
    s_waitcnt lgkmcnt(8)
    v_mfma_f32_16x16x32_bf16 v[76:79], v[48:51], a[40:43], v[76:79]
    ds_read_b64_tr_b16 v[44:45], v16 offset:43136
    v_mfma_f32_16x16x32_bf16 v[104:107], v[48:51], a[44:47], v[104:107]
    ds_read_b64_tr_b16 v[46:47], v16 offset:46720
    s_waitcnt vmcnt(14)
    s_waitcnt lgkmcnt(8)
    v_mfma_f32_16x16x32_bf16 v[52:55], v[28:31], a[48:51], v[52:55]
    ds_read_b64_tr_b16 v[48:49], v16 offset:43168
    v_mfma_f32_16x16x32_bf16 v[80:83], v[28:31], a[52:55], v[80:83]
    ds_read_b64_tr_b16 v[50:51], v16 offset:46752
    s_waitcnt lgkmcnt(8)
    v_mfma_f32_16x16x32_bf16 v[56:59], v[32:35], a[48:51], v[56:59]
    ds_read_b64_tr_b16 v[28:29], v18 offset:43008
    v_mfma_f32_16x16x32_bf16 v[84:87], v[32:35], a[52:55], v[84:87]
    ds_read_b64_tr_b16 v[30:31], v18 offset:46592
    s_add_u32 s68, s68, 4096
    s_add_u32 s69, s69, 4096
    buffer_load_dwordx4 a[96:99], v27, s[40:43], s68 offen offset:0 sc1
    buffer_load_dwordx4 a[100:103], v27, s[40:43], s69 offen offset:0 sc1
    s_waitcnt lgkmcnt(8)
    v_mfma_f32_16x16x32_bf16 v[60:63], v[36:39], a[48:51], v[60:63]
    ds_read_b64_tr_b16 v[32:33], v16 offset:50176
    v_mfma_f32_16x16x32_bf16 v[88:91], v[36:39], a[52:55], v[88:91]
    ds_read_b64_tr_b16 v[34:35], v16 offset:53760
    s_waitcnt lgkmcnt(8)
    v_mfma_f32_16x16x32_bf16 v[64:67], v[40:43], a[48:51], v[64:67]
    ds_read_b64_tr_b16 v[36:37], v16 offset:50208
    v_mfma_f32_16x16x32_bf16 v[92:95], v[40:43], a[52:55], v[92:95]
    ds_read_b64_tr_b16 v[38:39], v16 offset:53792
    s_waitcnt lgkmcnt(8)
    v_mfma_f32_16x16x32_bf16 v[68:71], v[44:47], a[48:51], v[68:71]
    ds_read_b64_tr_b16 v[40:41], v16 offset:50240
    v_mfma_f32_16x16x32_bf16 v[96:99], v[44:47], a[52:55], v[96:99]
    ds_read_b64_tr_b16 v[42:43], v16 offset:53824
    buffer_load_dwordx4 v23, s[36:39], s6 offen offset:3072 lds
    s_waitcnt lgkmcnt(8)
    v_mfma_f32_16x16x32_bf16 v[72:75], v[48:51], a[48:51], v[72:75]
    ds_read_b64_tr_b16 v[44:45], v16 offset:50272
    v_mfma_f32_16x16x32_bf16 v[100:103], v[48:51], a[52:55], v[100:103]
    ds_read_b64_tr_b16 v[46:47], v16 offset:53856
    s_waitcnt lgkmcnt(8)
    v_mfma_f32_16x16x32_bf16 v[76:79], v[28:31], a[48:51], v[76:79]
    ds_read_b64_tr_b16 v[48:49], v16 offset:50304
    v_mfma_f32_16x16x32_bf16 v[104:107], v[28:31], a[52:55], v[104:107]
    ds_read_b64_tr_b16 v[50:51], v16 offset:53888
    s_waitcnt vmcnt(15)
    s_waitcnt lgkmcnt(8)
    v_mfma_f32_16x16x32_bf16 v[52:55], v[32:35], a[56:59], v[52:55]
    ds_read_b64_tr_b16 v[28:29], v16 offset:50336
    v_mfma_f32_16x16x32_bf16 v[80:83], v[32:35], a[60:63], v[80:83]
    ds_read_b64_tr_b16 v[30:31], v16 offset:53920
    s_waitcnt lgkmcnt(8)
    v_mfma_f32_16x16x32_bf16 v[56:59], v[36:39], a[56:59], v[56:59]
    ds_read_b64_tr_b16 v[32:33], v18 offset:50176
    v_mfma_f32_16x16x32_bf16 v[84:87], v[36:39], a[60:63], v[84:87]
    ds_read_b64_tr_b16 v[34:35], v18 offset:53760
    buffer_load_dwordx4 a[104:107], v27, s[40:43], s68 offen offset:1024 sc1
    buffer_load_dwordx4 a[108:111], v27, s[40:43], s69 offen offset:1024 sc1
    s_waitcnt lgkmcnt(8)
    v_mfma_f32_16x16x32_bf16 v[60:63], v[40:43], a[56:59], v[60:63]
    ds_read_b64_tr_b16 v[36:37], v17 offset:0
    v_mfma_f32_16x16x32_bf16 v[88:91], v[40:43], a[60:63], v[88:91]
    ds_read_b64_tr_b16 v[38:39], v17 offset:3584
    s_waitcnt vmcnt(16)
    s_mov_b32 s60, 400000
    s_branch L_gc_25
L_gp_23:
    buffer_load_dword v213, v212, s[40:43], 0 offen sc1
    s_waitcnt vmcnt(0)
L_gc_25:
    v_cmp_ne_u32 vcc, 0, v213
    s_nop 3
    s_cmp_eq_u64 vcc, -1
    s_cbranch_scc1 L_go_24
    s_sub_u32 s60, s60, 1
    s_cmp_eq_u32 s60, 0
    s_cbranch_scc1 L_go_24
    s_branch L_gp_23
L_go_24:
    s_waitcnt lgkmcnt(8)
    v_mfma_f32_16x16x32_bf16 v[64:67], v[44:47], a[56:59], v[64:67]
    ds_read_b64_tr_b16 v[40:41], v17 offset:32
    v_mfma_f32_16x16x32_bf16 v[92:95], v[44:47], a[60:63], v[92:95]
    ds_read_b64_tr_b16 v[42:43], v17 offset:3616
    s_waitcnt lgkmcnt(8)
    v_mfma_f32_16x16x32_bf16 v[68:71], v[48:51], a[56:59], v[68:71]
    ds_read_b64_tr_b16 v[44:45], v17 offset:64
    v_mfma_f32_16x16x32_bf16 v[96:99], v[48:51], a[60:63], v[96:99]
    ds_read_b64_tr_b16 v[46:47], v17 offset:3648
    s_add_u32 m0, s73, 131072
    s_add_u32 s6, s72, 1310720
    buffer_load_dwordx4 v20, s[36:39], s6 offen offset:0 lds
    s_waitcnt lgkmcnt(8)
    v_mfma_f32_16x16x32_bf16 v[72:75], v[28:31], a[56:59], v[72:75]
    ds_read_b64_tr_b16 v[48:49], v17 offset:96
    v_mfma_f32_16x16x32_bf16 v[100:103], v[28:31], a[60:63], v[100:103]
    ds_read_b64_tr_b16 v[50:51], v17 offset:3680
    s_waitcnt lgkmcnt(8)
    v_mfma_f32_16x16x32_bf16 v[76:79], v[32:35], a[56:59], v[76:79]
    ds_read_b64_tr_b16 v[28:29], v17 offset:128
    v_mfma_f32_16x16x32_bf16 v[104:107], v[32:35], a[60:63], v[104:107]
    ds_read_b64_tr_b16 v[30:31], v17 offset:3712
    s_lshl_b32 s100, s49, 3
    s_lshr_b32 s7, s50, 3
    s_lshl_b32 s7, s7, 2
    s_add_u32 s100, s100, s7
    s_and_b32 s7, s48, 1
    s_lshl_b32 s7, s7, 1
    s_add_u32 s100, s100, s7
    s_lshl_b32 s100, s100, 14
    s_lshr_b32 s7, s48, 1
    s_lshl_b32 s7, s7, 13
    s_add_u32 s100, s100, s7
    s_add_u32 s100, s100, 6291456
    s_add_u32 s101, s100, 16384
    s_waitcnt vmcnt(15)
    s_waitcnt lgkmcnt(8)
    v_mfma_f32_16x16x32_bf16 v[52:55], v[36:39], a[64:67], v[52:55]
    ds_read_b64_tr_b16 v[32:33], v17 offset:160
    v_mfma_f32_16x16x32_bf16 v[80:83], v[36:39], a[68:71], v[80:83]
    ds_read_b64_tr_b16 v[34:35], v17 offset:3744
    s_waitcnt lgkmcnt(8)
    v_mfma_f32_16x16x32_bf16 v[56:59], v[40:43], a[64:67], v[56:59]
    ds_read_b64_tr_b16 v[36:37], v19 offset:0
    v_mfma_f32_16x16x32_bf16 v[84:87], v[40:43], a[68:71], v[84:87]
    ds_read_b64_tr_b16 v[38:39], v19 offset:3584
    buffer_load_dwordx4 a[112:115], v27, s[40:43], s68 offen offset:2048 sc1
    buffer_load_dwordx4 a[116:119], v27, s[40:43], s69 offen offset:2048 sc1
    s_waitcnt lgkmcnt(8)
    v_mfma_f32_16x16x32_bf16 v[60:63], v[44:47], a[64:67], v[60:63]
    ds_read_b64_tr_b16 v[40:41], v17 offset:7168
    v_mfma_f32_16x16x32_bf16 v[88:91], v[44:47], a[68:71], v[88:91]
    ds_read_b64_tr_b16 v[42:43], v17 offset:10752
    buffer_load_dwordx4 a[4:7], v27, s[40:43], s101 offen offset:0 sc1
    s_waitcnt lgkmcnt(8)
    v_mfma_f32_16x16x32_bf16 v[64:67], v[48:51], a[64:67], v[64:67]
    ds_read_b64_tr_b16 v[44:45], v17 offset:7200
    v_mfma_f32_16x16x32_bf16 v[92:95], v[48:51], a[68:71], v[92:95]
    ds_read_b64_tr_b16 v[46:47], v17 offset:10784
    s_waitcnt lgkmcnt(8)
    v_mfma_f32_16x16x32_bf16 v[68:71], v[28:31], a[64:67], v[68:71]
    ds_read_b64_tr_b16 v[48:49], v17 offset:7232
    v_mfma_f32_16x16x32_bf16 v[96:99], v[28:31], a[68:71], v[96:99]
    ds_read_b64_tr_b16 v[50:51], v17 offset:10816
    buffer_load_dwordx4 v21, s[36:39], s6 offen offset:1024 lds
    s_waitcnt lgkmcnt(8)
    v_mfma_f32_16x16x32_bf16 v[72:75], v[32:35], a[64:67], v[72:75]
    ds_read_b64_tr_b16 v[28:29], v17 offset:7264
    v_mfma_f32_16x16x32_bf16 v[100:103], v[32:35], a[68:71], v[100:103]
    ds_read_b64_tr_b16 v[30:31], v17 offset:10848
    buffer_load_dwordx4 a[0:3], v27, s[40:43], s100 offen offset:0 sc1
    s_waitcnt lgkmcnt(8)
    v_mfma_f32_16x16x32_bf16 v[76:79], v[36:39], a[64:67], v[76:79]
    ds_read_b64_tr_b16 v[32:33], v17 offset:7296
    v_mfma_f32_16x16x32_bf16 v[104:107], v[36:39], a[68:71], v[104:107]
    ds_read_b64_tr_b16 v[34:35], v17 offset:10880
    buffer_load_dwordx4 a[8:11], v27, s[40:43], s100 offen offset:1024 sc1
    s_waitcnt vmcnt(19)
    s_waitcnt lgkmcnt(8)
    v_mfma_f32_16x16x32_bf16 v[52:55], v[40:43], a[72:75], v[52:55]
    ds_read_b64_tr_b16 v[36:37], v17 offset:7328
    v_mfma_f32_16x16x32_bf16 v[80:83], v[40:43], a[76:79], v[80:83]
    ds_read_b64_tr_b16 v[38:39], v17 offset:10912
    s_waitcnt lgkmcnt(8)
    v_mfma_f32_16x16x32_bf16 v[56:59], v[44:47], a[72:75], v[56:59]
    ds_read_b64_tr_b16 v[40:41], v19 offset:7168
    v_mfma_f32_16x16x32_bf16 v[84:87], v[44:47], a[76:79], v[84:87]
    ds_read_b64_tr_b16 v[42:43], v19 offset:10752
    buffer_load_dwordx4 a[120:123], v27, s[40:43], s68 offen offset:3072 sc1
    buffer_load_dwordx4 a[124:127], v27, s[40:43], s69 offen offset:3072 sc1
    s_waitcnt lgkmcnt(8)
    v_mfma_f32_16x16x32_bf16 v[60:63], v[48:51], a[72:75], v[60:63]
    ds_read_b64_tr_b16 v[44:45], v17 offset:14336
    v_mfma_f32_16x16x32_bf16 v[88:91], v[48:51], a[76:79], v[88:91]
    ds_read_b64_tr_b16 v[46:47], v17 offset:17920
    s_waitcnt lgkmcnt(8)
    v_mfma_f32_16x16x32_bf16 v[64:67], v[28:31], a[72:75], v[64:67]
    ds_read_b64_tr_b16 v[48:49], v17 offset:14368
    v_mfma_f32_16x16x32_bf16 v[92:95], v[28:31], a[76:79], v[92:95]
    ds_read_b64_tr_b16 v[50:51], v17 offset:17952
    s_waitcnt lgkmcnt(8)
    v_mfma_f32_16x16x32_bf16 v[68:71], v[32:35], a[72:75], v[68:71]
    ds_read_b64_tr_b16 v[28:29], v17 offset:14400
    v_mfma_f32_16x16x32_bf16 v[96:99], v[32:35], a[76:79], v[96:99]
    ds_read_b64_tr_b16 v[30:31], v17 offset:17984
    buffer_load_dwordx4 v22, s[36:39], s6 offen offset:2048 lds
    s_waitcnt lgkmcnt(8)
    v_mfma_f32_16x16x32_bf16 v[72:75], v[36:39], a[72:75], v[72:75]
    ds_read_b64_tr_b16 v[32:33], v17 offset:14432
    v_mfma_f32_16x16x32_bf16 v[100:103], v[36:39], a[76:79], v[100:103]
    ds_read_b64_tr_b16 v[34:35], v17 offset:18016
    buffer_load_dwordx4 a[12:15], v27, s[40:43], s101 offen offset:1024 sc1
    s_waitcnt lgkmcnt(8)
    v_mfma_f32_16x16x32_bf16 v[76:79], v[40:43], a[72:75], v[76:79]
    ds_read_b64_tr_b16 v[36:37], v17 offset:14464
    v_mfma_f32_16x16x32_bf16 v[104:107], v[40:43], a[76:79], v[104:107]
    ds_read_b64_tr_b16 v[38:39], v17 offset:18048
    buffer_load_dwordx4 a[20:23], v27, s[40:43], s101 offen offset:2048 sc1
    s_waitcnt vmcnt(21)
    s_waitcnt lgkmcnt(8)
    v_mfma_f32_16x16x32_bf16 v[52:55], v[44:47], a[80:83], v[52:55]
    ds_read_b64_tr_b16 v[40:41], v17 offset:14496
    v_mfma_f32_16x16x32_bf16 v[80:83], v[44:47], a[84:87], v[80:83]
    ds_read_b64_tr_b16 v[42:43], v17 offset:18080
    s_waitcnt lgkmcnt(8)
    v_mfma_f32_16x16x32_bf16 v[56:59], v[48:51], a[80:83], v[56:59]
    ds_read_b64_tr_b16 v[44:45], v19 offset:14336
    v_mfma_f32_16x16x32_bf16 v[84:87], v[48:51], a[84:87], v[84:87]
    ds_read_b64_tr_b16 v[46:47], v19 offset:17920
    s_waitcnt lgkmcnt(8)
    v_mfma_f32_16x16x32_bf16 v[60:63], v[28:31], a[80:83], v[60:63]
    ds_read_b64_tr_b16 v[48:49], v17 offset:21504
    v_mfma_f32_16x16x32_bf16 v[88:91], v[28:31], a[84:87], v[88:91]
    ds_read_b64_tr_b16 v[50:51], v17 offset:25088
    buffer_load_dwordx4 a[16:19], v27, s[40:43], s100 offen offset:2048 sc1
    s_waitcnt lgkmcnt(8)
    v_mfma_f32_16x16x32_bf16 v[64:67], v[32:35], a[80:83], v[64:67]
    ds_read_b64_tr_b16 v[28:29], v17 offset:21536
    v_mfma_f32_16x16x32_bf16 v[92:95], v[32:35], a[84:87], v[92:95]
    ds_read_b64_tr_b16 v[30:31], v17 offset:25120
    v_lshlrev_b32 v4, 3, v2
    v_lshl_add_u32 v4, v3, 15, v4
    s_lshl_b32 s52, s67, 7
    s_add_u32 s52, s52, 15859712
    s_add_u32 s53, s52, 0
    buffer_load_dwordx2 v[196:197], v4, s[40:43], s53 offen offset:0 sc1
    buffer_load_dwordx2 v[200:201], v4, s[40:43], s53 offen offset:128 sc1
    s_add_u32 s53, s52, 16384
    buffer_load_dwordx2 v[198:199], v4, s[40:43], s53 offen offset:0 sc1
    buffer_load_dwordx2 v[202:203], v4, s[40:43], s53 offen offset:128 sc1
    s_waitcnt lgkmcnt(8)
    v_mfma_f32_16x16x32_bf16 v[68:71], v[36:39], a[80:83], v[68:71]
    ds_read_b64_tr_b16 v[32:33], v17 offset:21568
    v_mfma_f32_16x16x32_bf16 v[96:99], v[36:39], a[84:87], v[96:99]
    ds_read_b64_tr_b16 v[34:35], v17 offset:25152
    buffer_load_dwordx4 v23, s[36:39], s6 offen offset:3072 lds
    s_waitcnt lgkmcnt(8)
    v_mfma_f32_16x16x32_bf16 v[72:75], v[40:43], a[80:83], v[72:75]
    ds_read_b64_tr_b16 v[36:37], v17 offset:21600
    v_mfma_f32_16x16x32_bf16 v[100:103], v[40:43], a[84:87], v[100:103]
    ds_read_b64_tr_b16 v[38:39], v17 offset:25184
    s_waitcnt lgkmcnt(8)
    v_mfma_f32_16x16x32_bf16 v[76:79], v[44:47], a[80:83], v[76:79]
    ds_read_b64_tr_b16 v[40:41], v17 offset:21632
    v_mfma_f32_16x16x32_bf16 v[104:107], v[44:47], a[84:87], v[104:107]
    ds_read_b64_tr_b16 v[42:43], v17 offset:25216
    s_waitcnt vmcnt(24)
    s_waitcnt lgkmcnt(8)
    v_mfma_f32_16x16x32_bf16 v[52:55], v[48:51], a[88:91], v[52:55]
    ds_read_b64_tr_b16 v[44:45], v17 offset:21664
    v_mfma_f32_16x16x32_bf16 v[80:83], v[48:51], a[92:95], v[80:83]
    ds_read_b64_tr_b16 v[46:47], v17 offset:25248
    s_waitcnt lgkmcnt(8)
    v_mfma_f32_16x16x32_bf16 v[56:59], v[28:31], a[88:91], v[56:59]
    ds_read_b64_tr_b16 v[48:49], v19 offset:21504
    v_mfma_f32_16x16x32_bf16 v[84:87], v[28:31], a[92:95], v[84:87]
    ds_read_b64_tr_b16 v[50:51], v19 offset:25088
    s_waitcnt lgkmcnt(8)
    v_mfma_f32_16x16x32_bf16 v[60:63], v[32:35], a[88:91], v[60:63]
    ds_read_b64_tr_b16 v[28:29], v17 offset:28672
    v_mfma_f32_16x16x32_bf16 v[88:91], v[32:35], a[92:95], v[88:91]
    ds_read_b64_tr_b16 v[30:31], v17 offset:32256
    buffer_load_dwordx4 a[28:31], v27, s[40:43], s101 offen offset:3072 sc1
    s_waitcnt lgkmcnt(8)
    v_mfma_f32_16x16x32_bf16 v[64:67], v[36:39], a[88:91], v[64:67]
    ds_read_b64_tr_b16 v[32:33], v17 offset:28704
    v_mfma_f32_16x16x32_bf16 v[92:95], v[36:39], a[92:95], v[92:95]
    ds_read_b64_tr_b16 v[34:35], v17 offset:32288
    s_waitcnt lgkmcnt(8)
    v_mfma_f32_16x16x32_bf16 v[68:71], v[40:43], a[88:91], v[68:71]
    ds_read_b64_tr_b16 v[36:37], v17 offset:28736
    v_mfma_f32_16x16x32_bf16 v[96:99], v[40:43], a[92:95], v[96:99]
    ds_read_b64_tr_b16 v[38:39], v17 offset:32320
    s_add_u32 m0, s73, 147456
    s_add_u32 s6, s72, 1441792
    buffer_load_dwordx4 v20, s[36:39], s6 offen offset:0 lds
    s_waitcnt lgkmcnt(8)
    v_mfma_f32_16x16x32_bf16 v[72:75], v[44:47], a[88:91], v[72:75]
    ds_read_b64_tr_b16 v[40:41], v17 offset:28768
    v_mfma_f32_16x16x32_bf16 v[100:103], v[44:47], a[92:95], v[100:103]
    ds_read_b64_tr_b16 v[42:43], v17 offset:32352
    buffer_load_dwordx4 a[24:27], v27, s[40:43], s100 offen offset:3072 sc1
    s_waitcnt lgkmcnt(8)
    v_mfma_f32_16x16x32_bf16 v[76:79], v[48:51], a[88:91], v[76:79]
    ds_read_b64_tr_b16 v[44:45], v17 offset:28800
    v_mfma_f32_16x16x32_bf16 v[104:107], v[48:51], a[92:95], v[104:107]
    ds_read_b64_tr_b16 v[46:47], v17 offset:32384
    s_add_u32 s100, s100, 4096
    s_add_u32 s101, s101, 4096
    buffer_load_dwordx4 a[32:35], v27, s[40:43], s100 offen offset:0 sc1
    s_waitcnt vmcnt(25)
    s_waitcnt lgkmcnt(8)
    v_mfma_f32_16x16x32_bf16 v[52:55], v[28:31], a[96:99], v[52:55]
    ds_read_b64_tr_b16 v[48:49], v17 offset:28832
    v_mfma_f32_16x16x32_bf16 v[80:83], v[28:31], a[100:103], v[80:83]
    ds_read_b64_tr_b16 v[50:51], v17 offset:32416
    s_waitcnt lgkmcnt(8)
    v_mfma_f32_16x16x32_bf16 v[56:59], v[32:35], a[96:99], v[56:59]
    ds_read_b64_tr_b16 v[28:29], v19 offset:28672
    v_mfma_f32_16x16x32_bf16 v[84:87], v[32:35], a[100:103], v[84:87]
    ds_read_b64_tr_b16 v[30:31], v19 offset:32256
    s_waitcnt lgkmcnt(8)
    v_mfma_f32_16x16x32_bf16 v[60:63], v[36:39], a[96:99], v[60:63]
    ds_read_b64_tr_b16 v[32:33], v17 offset:35840
    v_mfma_f32_16x16x32_bf16 v[88:91], v[36:39], a[100:103], v[88:91]
    ds_read_b64_tr_b16 v[34:35], v17 offset:39424
    s_waitcnt lgkmcnt(8)
    v_mfma_f32_16x16x32_bf16 v[64:67], v[40:43], a[96:99], v[64:67]
    ds_read_b64_tr_b16 v[36:37], v17 offset:35872
    v_mfma_f32_16x16x32_bf16 v[92:95], v[40:43], a[100:103], v[92:95]
    ds_read_b64_tr_b16 v[38:39], v17 offset:39456
    s_waitcnt lgkmcnt(8)
    v_mfma_f32_16x16x32_bf16 v[68:71], v[44:47], a[96:99], v[68:71]
    ds_read_b64_tr_b16 v[40:41], v17 offset:35904
    v_mfma_f32_16x16x32_bf16 v[96:99], v[44:47], a[100:103], v[96:99]
    ds_read_b64_tr_b16 v[42:43], v17 offset:39488
    buffer_load_dwordx4 v21, s[36:39], s6 offen offset:1024 lds
    s_waitcnt lgkmcnt(8)
    v_mfma_f32_16x16x32_bf16 v[72:75], v[48:51], a[96:99], v[72:75]
    ds_read_b64_tr_b16 v[44:45], v17 offset:35936
    v_mfma_f32_16x16x32_bf16 v[100:103], v[48:51], a[100:103], v[100:103]
    ds_read_b64_tr_b16 v[46:47], v17 offset:39520
    buffer_load_dwordx4 a[36:39], v27, s[40:43], s101 offen offset:0 sc1
    s_waitcnt lgkmcnt(8)
    v_mfma_f32_16x16x32_bf16 v[76:79], v[28:31], a[96:99], v[76:79]
    ds_read_b64_tr_b16 v[48:49], v17 offset:35968
    v_mfma_f32_16x16x32_bf16 v[104:107], v[28:31], a[100:103], v[104:107]
    ds_read_b64_tr_b16 v[50:51], v17 offset:39552
    buffer_load_dwordx4 a[44:47], v27, s[40:43], s101 offen offset:1024 sc1
    s_waitcnt vmcnt(25)
    s_waitcnt lgkmcnt(8)
    v_mfma_f32_16x16x32_bf16 v[52:55], v[32:35], a[104:107], v[52:55]
    ds_read_b64_tr_b16 v[28:29], v17 offset:36000
    v_mfma_f32_16x16x32_bf16 v[80:83], v[32:35], a[108:111], v[80:83]
    ds_read_b64_tr_b16 v[30:31], v17 offset:39584
    s_waitcnt lgkmcnt(8)
    v_mfma_f32_16x16x32_bf16 v[56:59], v[36:39], a[104:107], v[56:59]
    ds_read_b64_tr_b16 v[32:33], v19 offset:35840
    v_mfma_f32_16x16x32_bf16 v[84:87], v[36:39], a[108:111], v[84:87]
    ds_read_b64_tr_b16 v[34:35], v19 offset:39424
    s_waitcnt lgkmcnt(8)
    v_mfma_f32_16x16x32_bf16 v[60:63], v[40:43], a[104:107], v[60:63]
    ds_read_b64_tr_b16 v[36:37], v17 offset:43008
    v_mfma_f32_16x16x32_bf16 v[88:91], v[40:43], a[108:111], v[88:91]
    ds_read_b64_tr_b16 v[38:39], v17 offset:46592
    buffer_load_dwordx4 a[40:43], v27, s[40:43], s100 offen offset:1024 sc1
    s_waitcnt lgkmcnt(8)
    v_mfma_f32_16x16x32_bf16 v[64:67], v[44:47], a[104:107], v[64:67]
    ds_read_b64_tr_b16 v[40:41], v17 offset:43040
    v_mfma_f32_16x16x32_bf16 v[92:95], v[44:47], a[108:111], v[92:95]
    ds_read_b64_tr_b16 v[42:43], v17 offset:46624
    s_waitcnt lgkmcnt(8)
    v_mfma_f32_16x16x32_bf16 v[68:71], v[48:51], a[104:107], v[68:71]
    ds_read_b64_tr_b16 v[44:45], v17 offset:43072
    v_mfma_f32_16x16x32_bf16 v[96:99], v[48:51], a[108:111], v[96:99]
    ds_read_b64_tr_b16 v[46:47], v17 offset:46656
    buffer_load_dwordx4 v22, s[36:39], s6 offen offset:2048 lds
    s_waitcnt lgkmcnt(8)
    v_mfma_f32_16x16x32_bf16 v[72:75], v[28:31], a[104:107], v[72:75]
    ds_read_b64_tr_b16 v[48:49], v17 offset:43104
    v_mfma_f32_16x16x32_bf16 v[100:103], v[28:31], a[108:111], v[100:103]
    ds_read_b64_tr_b16 v[50:51], v17 offset:46688
    s_waitcnt lgkmcnt(8)
    v_mfma_f32_16x16x32_bf16 v[76:79], v[32:35], a[104:107], v[76:79]
    ds_read_b64_tr_b16 v[28:29], v17 offset:43136
    v_mfma_f32_16x16x32_bf16 v[104:107], v[32:35], a[108:111], v[104:107]
    ds_read_b64_tr_b16 v[30:31], v17 offset:46720
    s_waitcnt vmcnt(24)
    s_waitcnt lgkmcnt(8)
    v_mfma_f32_16x16x32_bf16 v[52:55], v[36:39], a[112:115], v[52:55]
    ds_read_b64_tr_b16 v[32:33], v17 offset:43168
    v_mfma_f32_16x16x32_bf16 v[80:83], v[36:39], a[116:119], v[80:83]
    ds_read_b64_tr_b16 v[34:35], v17 offset:46752
    s_waitcnt lgkmcnt(8)
    v_mfma_f32_16x16x32_bf16 v[56:59], v[40:43], a[112:115], v[56:59]
    ds_read_b64_tr_b16 v[36:37], v19 offset:43008
    v_mfma_f32_16x16x32_bf16 v[84:87], v[40:43], a[116:119], v[84:87]
    ds_read_b64_tr_b16 v[38:39], v19 offset:46592
    s_waitcnt lgkmcnt(8)
    v_mfma_f32_16x16x32_bf16 v[60:63], v[44:47], a[112:115], v[60:63]
    ds_read_b64_tr_b16 v[40:41], v17 offset:50176
    v_mfma_f32_16x16x32_bf16 v[88:91], v[44:47], a[116:119], v[88:91]
    ds_read_b64_tr_b16 v[42:43], v17 offset:53760
    buffer_load_dwordx4 a[52:55], v27, s[40:43], s101 offen offset:2048 sc1
    s_waitcnt lgkmcnt(8)
    v_mfma_f32_16x16x32_bf16 v[64:67], v[48:51], a[112:115], v[64:67]
    ds_read_b64_tr_b16 v[44:45], v17 offset:50208
    v_mfma_f32_16x16x32_bf16 v[92:95], v[48:51], a[116:119], v[92:95]
    ds_read_b64_tr_b16 v[46:47], v17 offset:53792
    s_waitcnt lgkmcnt(8)
    v_mfma_f32_16x16x32_bf16 v[68:71], v[28:31], a[112:115], v[68:71]
    ds_read_b64_tr_b16 v[48:49], v17 offset:50240
    v_mfma_f32_16x16x32_bf16 v[96:99], v[28:31], a[116:119], v[96:99]
    ds_read_b64_tr_b16 v[50:51], v17 offset:53824
    buffer_load_dwordx4 v23, s[36:39], s6 offen offset:3072 lds
    s_waitcnt lgkmcnt(8)
    v_mfma_f32_16x16x32_bf16 v[72:75], v[32:35], a[112:115], v[72:75]
    ds_read_b64_tr_b16 v[28:29], v17 offset:50272
    v_mfma_f32_16x16x32_bf16 v[100:103], v[32:35], a[116:119], v[100:103]
    ds_read_b64_tr_b16 v[30:31], v17 offset:53856
    buffer_load_dwordx4 a[48:51], v27, s[40:43], s100 offen offset:2048 sc1
    s_waitcnt lgkmcnt(8)
    v_mfma_f32_16x16x32_bf16 v[76:79], v[36:39], a[112:115], v[76:79]
    ds_read_b64_tr_b16 v[32:33], v17 offset:50304
    v_mfma_f32_16x16x32_bf16 v[104:107], v[36:39], a[116:119], v[104:107]
    ds_read_b64_tr_b16 v[34:35], v17 offset:53888
    buffer_load_dwordx4 a[56:59], v27, s[40:43], s100 offen offset:3072 sc1
    s_waitcnt vmcnt(22)
    s_waitcnt lgkmcnt(8)
    v_mfma_f32_16x16x32_bf16 v[52:55], v[40:43], a[120:123], v[52:55]
    ds_read_b64_tr_b16 v[36:37], v17 offset:50336
    v_mfma_f32_16x16x32_bf16 v[80:83], v[40:43], a[124:127], v[80:83]
    ds_read_b64_tr_b16 v[38:39], v17 offset:53920
    s_waitcnt lgkmcnt(8)
    v_mfma_f32_16x16x32_bf16 v[56:59], v[44:47], a[120:123], v[56:59]
    ds_read_b64_tr_b16 v[40:41], v19 offset:50176
    v_mfma_f32_16x16x32_bf16 v[84:87], v[44:47], a[124:127], v[84:87]
    ds_read_b64_tr_b16 v[42:43], v19 offset:53760
    s_waitcnt lgkmcnt(8)
    v_mfma_f32_16x16x32_bf16 v[60:63], v[48:51], a[120:123], v[60:63]
    v_mfma_f32_16x16x32_bf16 v[88:91], v[48:51], a[124:127], v[88:91]
    s_waitcnt lgkmcnt(6)
    v_mfma_f32_16x16x32_bf16 v[64:67], v[28:31], a[120:123], v[64:67]
    v_mfma_f32_16x16x32_bf16 v[92:95], v[28:31], a[124:127], v[92:95]
    s_waitcnt lgkmcnt(4)
    v_mfma_f32_16x16x32_bf16 v[68:71], v[32:35], a[120:123], v[68:71]
    v_mfma_f32_16x16x32_bf16 v[96:99], v[32:35], a[124:127], v[96:99]
    s_waitcnt lgkmcnt(2)
    v_mfma_f32_16x16x32_bf16 v[72:75], v[36:39], a[120:123], v[72:75]
    v_mfma_f32_16x16x32_bf16 v[100:103], v[36:39], a[124:127], v[100:103]
    buffer_load_dwordx4 a[60:63], v27, s[40:43], s101 offen offset:3072 sc1
    s_waitcnt lgkmcnt(0)
    v_mfma_f32_16x16x32_bf16 v[76:79], v[40:43], a[120:123], v[76:79]
    v_mfma_f32_16x16x32_bf16 v[104:107], v[40:43], a[124:127], v[104:107]
    s_barrier
    s_waitcnt vmcnt(15)
    v_pk_add_f32 v[120:121], v[196:197], v[198:199]
    v_mov_b32 v132, v120
    s_nop 1
    v_permlane16_swap_b32 v120, v132
    v_add_f32 v120, v120, v132
    v_mov_b32 v132, v120
    s_nop 1
    v_permlane32_swap_b32 v120, v132
    v_add_f32 v120, v120, v132
    v_mov_b32 v133, v121
    s_nop 1
    v_permlane16_swap_b32 v121, v133
    v_add_f32 v121, v121, v133
    v_mov_b32 v133, v121
    s_nop 1
    v_permlane32_swap_b32 v121, v133
    v_add_f32 v121, v121, v133
    v_mul_f32 v128, 0xbb000000, v120
    v_mul_f32 v132, 0x3b000000, v121
    v_fma_f32 v132, -v128, v128, v132
    v_max_f32 v132, 0, v132
    v_add_f32 v132, 0x3727c5ac, v132
    v_rsq_f32 v129, v132
    v_pk_add_f32 v[124:125], v[200:201], v[202:203]
    v_mov_b32 v132, v124
    s_nop 1
    v_permlane16_swap_b32 v124, v132
    v_add_f32 v124, v124, v132
    v_mov_b32 v132, v124
    s_nop 1
    v_permlane32_swap_b32 v124, v132
    v_add_f32 v124, v124, v132
    v_mov_b32 v133, v125
    s_nop 1
    v_permlane16_swap_b32 v125, v133
    v_add_f32 v125, v125, v133
    v_mov_b32 v133, v125
    s_nop 1
    v_permlane32_swap_b32 v125, v133
    v_add_f32 v125, v125, v133
    v_mul_f32 v130, 0xbb000000, v124
    v_mul_f32 v132, 0x3b000000, v125
    v_fma_f32 v132, -v130, v130, v132
    v_max_f32 v132, 0, v132
    v_add_f32 v132, 0x3727c5ac, v132
    v_rsq_f32 v131, v132
    v_mov_b32 v134, 0xbdd2d3e8
    v_mov_b32 v135, 0xbdd2d3e8
    v_mov_b32 v136, 0xc0135761
    v_mov_b32 v137, 0xc0135761
    v_mov_b32 v138, 0x3f800000
    v_mov_b32 v139, 0x3f800000
    s_mul_i32 s56, s67, 57344
    s_add_u32 s56, s56, 8388608
    s_mul_i32 s55, s51, 7
    s_add_u32 s57, s55, s70
    s_lshl_b32 s57, s57, 9
    s_add_u32 s57, s57, s56
    s_add_u32 s58, s57, 57344
    s_mul_i32 s54, s70, 6
    s_sub_u32 s54, 6, s54
    s_add_u32 s55, s55, s54
    s_lshr_b32 s55, s55, 1
    s_lshl_b32 s55, s55, 10
    s_lshl_b32 s54, s70, 9
    s_add_u32 s55, s55, s54
    s_add_u32 s59, s55, s56
    s_add_u32 s60, s59, 57344
    v_pk_fma_f32 v[52:53], v[144:145], v[128:129], v[52:53] op_sel_hi:[1,0,1]
    v_pk_fma_f32 v[54:55], v[146:147], v[128:129], v[54:55] op_sel_hi:[1,0,1]
    v_pk_mul_f32 v[52:53], v[52:53], v[128:129] op_sel:[0,1] op_sel_hi:[1,1]
    v_pk_mul_f32 v[54:55], v[54:55], v[128:129] op_sel:[0,1] op_sel_hi:[1,1]
    v_pk_fma_f32 v[56:57], v[148:149], v[128:129], v[56:57] op_sel_hi:[1,0,1]
    v_pk_fma_f32 v[58:59], v[150:151], v[128:129], v[58:59] op_sel_hi:[1,0,1]
    v_pk_mul_f32 v[56:57], v[56:57], v[128:129] op_sel:[0,1] op_sel_hi:[1,1]
    v_pk_mul_f32 v[58:59], v[58:59], v[128:129] op_sel:[0,1] op_sel_hi:[1,1]
    v_pk_mul_f32 v[176:177], v[52:53], v[52:53]
    v_pk_mul_f32 v[178:179], v[54:55], v[54:55]
    v_pk_mul_f32 v[180:181], v[56:57], v[56:57]
    v_pk_mul_f32 v[182:183], v[58:59], v[58:59]
    v_pk_fma_f32 v[176:177], v[176:177], v[134:135], v[136:137]
    v_pk_fma_f32 v[178:179], v[178:179], v[134:135], v[136:137]
    v_pk_fma_f32 v[180:181], v[180:181], v[134:135], v[136:137]
    v_pk_fma_f32 v[182:183], v[182:183], v[134:135], v[136:137]
    s_add_u32 m0, s73, 0
    s_add_u32 s6, s72, 0
    buffer_load_dwordx4 v20, s[36:39], s6 offen offset:0 lds
    v_pk_mul_f32 v[176:177], v[176:177], v[52:53]
    v_pk_mul_f32 v[178:179], v[178:179], v[54:55]
    v_pk_mul_f32 v[180:181], v[180:181], v[56:57]
    v_pk_mul_f32 v[182:183], v[182:183], v[58:59]
    v_exp_f32 v176, v176
    v_exp_f32 v177, v177
    v_exp_f32 v178, v178
    v_exp_f32 v179, v179
    v_exp_f32 v180, v180
    v_exp_f32 v181, v181
    v_exp_f32 v182, v182
    v_exp_f32 v183, v183
    buffer_load_dwordx4 v21, s[36:39], s6 offen offset:1024 lds
    v_pk_add_f32 v[176:177], v[176:177], v[138:139]
    v_pk_add_f32 v[178:179], v[178:179], v[138:139]
    v_pk_add_f32 v[180:181], v[180:181], v[138:139]
    v_pk_add_f32 v[182:183], v[182:183], v[138:139]
    buffer_load_dwordx4 v22, s[36:39], s6 offen offset:2048 lds
    v_rcp_f32 v176, v176
    v_rcp_f32 v177, v177
    v_rcp_f32 v178, v178
    v_rcp_f32 v179, v179
    v_rcp_f32 v180, v180
    v_rcp_f32 v181, v181
    v_rcp_f32 v182, v182
    v_rcp_f32 v183, v183
    buffer_load_dwordx4 v23, s[36:39], s6 offen offset:3072 lds
    v_pk_mul_f32 v[52:53], v[52:53], v[176:177]
    v_pk_mul_f32 v[54:55], v[54:55], v[178:179]
    v_pk_mul_f32 v[56:57], v[56:57], v[180:181]
    v_pk_mul_f32 v[58:59], v[58:59], v[182:183]
    v_cvt_pk_bf16_f32 v184, v52, v53
    v_cvt_pk_bf16_f32 v185, v54, v55
    v_cvt_pk_bf16_f32 v186, v56, v57
    v_cvt_pk_bf16_f32 v187, v58, v59
    buffer_store_dwordx4 v[184:187], v27, s[40:43], s57 offen offset:0 sc1
    v_pk_fma_f32 v[80:81], v[144:145], v[130:131], v[80:81] op_sel_hi:[1,0,1]
    v_pk_fma_f32 v[82:83], v[146:147], v[130:131], v[82:83] op_sel_hi:[1,0,1]
    v_pk_mul_f32 v[80:81], v[80:81], v[130:131] op_sel:[0,1] op_sel_hi:[1,1]
    v_pk_mul_f32 v[82:83], v[82:83], v[130:131] op_sel:[0,1] op_sel_hi:[1,1]
    v_pk_fma_f32 v[84:85], v[148:149], v[130:131], v[84:85] op_sel_hi:[1,0,1]
    v_pk_fma_f32 v[86:87], v[150:151], v[130:131], v[86:87] op_sel_hi:[1,0,1]
    v_pk_mul_f32 v[84:85], v[84:85], v[130:131] op_sel:[0,1] op_sel_hi:[1,1]
    v_pk_mul_f32 v[86:87], v[86:87], v[130:131] op_sel:[0,1] op_sel_hi:[1,1]
    v_pk_mul_f32 v[176:177], v[80:81], v[80:81]
    v_pk_mul_f32 v[178:179], v[82:83], v[82:83]
    v_pk_mul_f32 v[180:181], v[84:85], v[84:85]
    v_pk_mul_f32 v[182:183], v[86:87], v[86:87]
    v_pk_fma_f32 v[176:177], v[176:177], v[134:135], v[136:137]
    v_pk_fma_f32 v[178:179], v[178:179], v[134:135], v[136:137]
    v_pk_fma_f32 v[180:181], v[180:181], v[134:135], v[136:137]
    v_pk_fma_f32 v[182:183], v[182:183], v[134:135], v[136:137]
    s_add_u32 m0, s73, 16384
    s_add_u32 s6, s72, 131072
    buffer_load_dwordx4 v20, s[36:39], s6 offen offset:0 lds
    v_pk_mul_f32 v[176:177], v[176:177], v[80:81]
    v_pk_mul_f32 v[178:179], v[178:179], v[82:83]
    v_pk_mul_f32 v[180:181], v[180:181], v[84:85]
    v_pk_mul_f32 v[182:183], v[182:183], v[86:87]
    v_exp_f32 v176, v176
    v_exp_f32 v177, v177
    v_exp_f32 v178, v178
    v_exp_f32 v179, v179
    v_exp_f32 v180, v180
    v_exp_f32 v181, v181
    v_exp_f32 v182, v182
    v_exp_f32 v183, v183
    buffer_load_dwordx4 v21, s[36:39], s6 offen offset:1024 lds
    v_pk_add_f32 v[176:177], v[176:177], v[138:139]
    v_pk_add_f32 v[178:179], v[178:179], v[138:139]
    v_pk_add_f32 v[180:181], v[180:181], v[138:139]
    v_pk_add_f32 v[182:183], v[182:183], v[138:139]
    buffer_load_dwordx4 v22, s[36:39], s6 offen offset:2048 lds
    v_rcp_f32 v176, v176
    v_rcp_f32 v177, v177
    v_rcp_f32 v178, v178
    v_rcp_f32 v179, v179
    v_rcp_f32 v180, v180
    v_rcp_f32 v181, v181
    v_rcp_f32 v182, v182
    v_rcp_f32 v183, v183
    buffer_load_dwordx4 v23, s[36:39], s6 offen offset:3072 lds
    v_pk_mul_f32 v[80:81], v[80:81], v[176:177]
    v_pk_mul_f32 v[82:83], v[82:83], v[178:179]
    v_pk_mul_f32 v[84:85], v[84:85], v[180:181]
    v_pk_mul_f32 v[86:87], v[86:87], v[182:183]
    v_cvt_pk_bf16_f32 v188, v80, v81
    v_cvt_pk_bf16_f32 v189, v82, v83
    v_cvt_pk_bf16_f32 v190, v84, v85
    v_cvt_pk_bf16_f32 v191, v86, v87
    buffer_store_dwordx4 v[188:191], v27, s[40:43], s58 offen offset:0 sc1
    v_pk_fma_f32 v[60:61], v[152:153], v[128:129], v[60:61] op_sel_hi:[1,0,1]
    v_pk_fma_f32 v[62:63], v[154:155], v[128:129], v[62:63] op_sel_hi:[1,0,1]
    v_pk_mul_f32 v[60:61], v[60:61], v[128:129] op_sel:[0,1] op_sel_hi:[1,1]
    v_pk_mul_f32 v[62:63], v[62:63], v[128:129] op_sel:[0,1] op_sel_hi:[1,1]
    v_pk_fma_f32 v[64:65], v[156:157], v[128:129], v[64:65] op_sel_hi:[1,0,1]
    v_pk_fma_f32 v[66:67], v[158:159], v[128:129], v[66:67] op_sel_hi:[1,0,1]
    v_pk_mul_f32 v[64:65], v[64:65], v[128:129] op_sel:[0,1] op_sel_hi:[1,1]
    v_pk_mul_f32 v[66:67], v[66:67], v[128:129] op_sel:[0,1] op_sel_hi:[1,1]
    v_pk_mul_f32 v[176:177], v[60:61], v[60:61]
    v_pk_mul_f32 v[178:179], v[62:63], v[62:63]
    v_pk_mul_f32 v[180:181], v[64:65], v[64:65]
    v_pk_mul_f32 v[182:183], v[66:67], v[66:67]
    v_pk_fma_f32 v[176:177], v[176:177], v[134:135], v[136:137]
    v_pk_fma_f32 v[178:179], v[178:179], v[134:135], v[136:137]
    v_pk_fma_f32 v[180:181], v[180:181], v[134:135], v[136:137]
    v_pk_fma_f32 v[182:183], v[182:183], v[134:135], v[136:137]
    s_add_u32 m0, s73, 81920
    s_add_u32 s6, s72, 917504
    buffer_load_dwordx4 v20, s[36:39], s6 offen offset:0 lds
    v_pk_mul_f32 v[176:177], v[176:177], v[60:61]
    v_pk_mul_f32 v[178:179], v[178:179], v[62:63]
    v_pk_mul_f32 v[180:181], v[180:181], v[64:65]
    v_pk_mul_f32 v[182:183], v[182:183], v[66:67]
    v_exp_f32 v176, v176
    v_exp_f32 v177, v177
    v_exp_f32 v178, v178
    v_exp_f32 v179, v179
    v_exp_f32 v180, v180
    v_exp_f32 v181, v181
    v_exp_f32 v182, v182
    v_exp_f32 v183, v183
    buffer_load_dwordx4 v21, s[36:39], s6 offen offset:1024 lds
    v_pk_add_f32 v[176:177], v[176:177], v[138:139]
    v_pk_add_f32 v[178:179], v[178:179], v[138:139]
    v_pk_add_f32 v[180:181], v[180:181], v[138:139]
    v_pk_add_f32 v[182:183], v[182:183], v[138:139]
    buffer_load_dwordx4 v22, s[36:39], s6 offen offset:2048 lds
    v_rcp_f32 v176, v176
    v_rcp_f32 v177, v177
    v_rcp_f32 v178, v178
    v_rcp_f32 v179, v179
    v_rcp_f32 v180, v180
    v_rcp_f32 v181, v181
    v_rcp_f32 v182, v182
    v_rcp_f32 v183, v183
    buffer_load_dwordx4 v23, s[36:39], s6 offen offset:3072 lds
    v_pk_mul_f32 v[60:61], v[60:61], v[176:177]
    v_pk_mul_f32 v[62:63], v[62:63], v[178:179]
    v_pk_mul_f32 v[64:65], v[64:65], v[180:181]
    v_pk_mul_f32 v[66:67], v[66:67], v[182:183]
    v_cvt_pk_bf16_f32 v184, v60, v61
    v_cvt_pk_bf16_f32 v185, v62, v63
    v_cvt_pk_bf16_f32 v186, v64, v65
    v_cvt_pk_bf16_f32 v187, v66, v67
    buffer_store_dwordx4 v[184:187], v27, s[40:43], s57 offen offset:1024 sc1
    v_pk_fma_f32 v[88:89], v[152:153], v[130:131], v[88:89] op_sel_hi:[1,0,1]
    v_pk_fma_f32 v[90:91], v[154:155], v[130:131], v[90:91] op_sel_hi:[1,0,1]
    v_pk_mul_f32 v[88:89], v[88:89], v[130:131] op_sel:[0,1] op_sel_hi:[1,1]
    v_pk_mul_f32 v[90:91], v[90:91], v[130:131] op_sel:[0,1] op_sel_hi:[1,1]
    v_pk_fma_f32 v[92:93], v[156:157], v[130:131], v[92:93] op_sel_hi:[1,0,1]
    v_pk_fma_f32 v[94:95], v[158:159], v[130:131], v[94:95] op_sel_hi:[1,0,1]
    v_pk_mul_f32 v[92:93], v[92:93], v[130:131] op_sel:[0,1] op_sel_hi:[1,1]
    v_pk_mul_f32 v[94:95], v[94:95], v[130:131] op_sel:[0,1] op_sel_hi:[1,1]
    v_pk_mul_f32 v[176:177], v[88:89], v[88:89]
    v_pk_mul_f32 v[178:179], v[90:91], v[90:91]
    v_pk_mul_f32 v[180:181], v[92:93], v[92:93]
    v_pk_mul_f32 v[182:183], v[94:95], v[94:95]
    v_pk_fma_f32 v[176:177], v[176:177], v[134:135], v[136:137]
    v_pk_fma_f32 v[178:179], v[178:179], v[134:135], v[136:137]
    v_pk_fma_f32 v[180:181], v[180:181], v[134:135], v[136:137]
    v_pk_fma_f32 v[182:183], v[182:183], v[134:135], v[136:137]
    s_add_u32 m0, s73, 98304
    s_add_u32 s6, s72, 1048576
    buffer_load_dwordx4 v20, s[36:39], s6 offen offset:0 lds
    v_pk_mul_f32 v[176:177], v[176:177], v[88:89]
    v_pk_mul_f32 v[178:179], v[178:179], v[90:91]
    v_pk_mul_f32 v[180:181], v[180:181], v[92:93]
    v_pk_mul_f32 v[182:183], v[182:183], v[94:95]
    v_exp_f32 v176, v176
    v_exp_f32 v177, v177
    v_exp_f32 v178, v178
    v_exp_f32 v179, v179
    v_exp_f32 v180, v180
    v_exp_f32 v181, v181
    v_exp_f32 v182, v182
    v_exp_f32 v183, v183
    buffer_load_dwordx4 v21, s[36:39], s6 offen offset:1024 lds
    v_pk_add_f32 v[176:177], v[176:177], v[138:139]
    v_pk_add_f32 v[178:179], v[178:179], v[138:139]
    v_pk_add_f32 v[180:181], v[180:181], v[138:139]
    v_pk_add_f32 v[182:183], v[182:183], v[138:139]
    buffer_load_dwordx4 v22, s[36:39], s6 offen offset:2048 lds
    v_rcp_f32 v176, v176
    v_rcp_f32 v177, v177
    v_rcp_f32 v178, v178
    v_rcp_f32 v179, v179
    v_rcp_f32 v180, v180
    v_rcp_f32 v181, v181
    v_rcp_f32 v182, v182
    v_rcp_f32 v183, v183
    buffer_load_dwordx4 v23, s[36:39], s6 offen offset:3072 lds
    v_pk_mul_f32 v[88:89], v[88:89], v[176:177]
    v_pk_mul_f32 v[90:91], v[90:91], v[178:179]
    v_pk_mul_f32 v[92:93], v[92:93], v[180:181]
    v_pk_mul_f32 v[94:95], v[94:95], v[182:183]
    v_cvt_pk_bf16_f32 v188, v88, v89
    v_cvt_pk_bf16_f32 v189, v90, v91
    v_cvt_pk_bf16_f32 v190, v92, v93
    v_cvt_pk_bf16_f32 v191, v94, v95
    buffer_store_dwordx4 v[188:191], v27, s[40:43], s58 offen offset:1024 sc1
    v_pk_fma_f32 v[68:69], v[160:161], v[128:129], v[68:69] op_sel_hi:[1,0,1]
    v_pk_fma_f32 v[70:71], v[162:163], v[128:129], v[70:71] op_sel_hi:[1,0,1]
    v_pk_mul_f32 v[68:69], v[68:69], v[128:129] op_sel:[0,1] op_sel_hi:[1,1]
    v_pk_mul_f32 v[70:71], v[70:71], v[128:129] op_sel:[0,1] op_sel_hi:[1,1]
    v_pk_fma_f32 v[72:73], v[164:165], v[128:129], v[72:73] op_sel_hi:[1,0,1]
    v_pk_fma_f32 v[74:75], v[166:167], v[128:129], v[74:75] op_sel_hi:[1,0,1]
    v_pk_mul_f32 v[72:73], v[72:73], v[128:129] op_sel:[0,1] op_sel_hi:[1,1]
    v_pk_mul_f32 v[74:75], v[74:75], v[128:129] op_sel:[0,1] op_sel_hi:[1,1]
    v_pk_mul_f32 v[176:177], v[68:69], v[68:69]
    v_pk_mul_f32 v[178:179], v[70:71], v[70:71]
    v_pk_mul_f32 v[180:181], v[72:73], v[72:73]
    v_pk_mul_f32 v[182:183], v[74:75], v[74:75]
    v_pk_fma_f32 v[176:177], v[176:177], v[134:135], v[136:137]
    v_pk_fma_f32 v[178:179], v[178:179], v[134:135], v[136:137]
    v_pk_fma_f32 v[180:181], v[180:181], v[134:135], v[136:137]
    v_pk_fma_f32 v[182:183], v[182:183], v[134:135], v[136:137]
    v_pk_mul_f32 v[176:177], v[176:177], v[68:69]
    v_pk_mul_f32 v[178:179], v[178:179], v[70:71]
    v_pk_mul_f32 v[180:181], v[180:181], v[72:73]
    v_pk_mul_f32 v[182:183], v[182:183], v[74:75]
    v_exp_f32 v176, v176
    v_exp_f32 v177, v177
    v_exp_f32 v178, v178
    v_exp_f32 v179, v179
    v_exp_f32 v180, v180
    v_exp_f32 v181, v181
    v_exp_f32 v182, v182
    v_exp_f32 v183, v183
    v_pk_add_f32 v[176:177], v[176:177], v[138:139]
    v_pk_add_f32 v[178:179], v[178:179], v[138:139]
    v_pk_add_f32 v[180:181], v[180:181], v[138:139]
    v_pk_add_f32 v[182:183], v[182:183], v[138:139]
    v_rcp_f32 v176, v176
    v_rcp_f32 v177, v177
    v_rcp_f32 v178, v178
    v_rcp_f32 v179, v179
    v_rcp_f32 v180, v180
    v_rcp_f32 v181, v181
    v_rcp_f32 v182, v182
    v_rcp_f32 v183, v183
    v_pk_mul_f32 v[68:69], v[68:69], v[176:177]
    v_pk_mul_f32 v[70:71], v[70:71], v[178:179]
    v_pk_mul_f32 v[72:73], v[72:73], v[180:181]
    v_pk_mul_f32 v[74:75], v[74:75], v[182:183]
    v_cvt_pk_bf16_f32 v184, v68, v69
    v_cvt_pk_bf16_f32 v185, v70, v71
    v_cvt_pk_bf16_f32 v186, v72, v73
    v_cvt_pk_bf16_f32 v187, v74, v75
    buffer_store_dwordx4 v[184:187], v27, s[40:43], s57 offen offset:2048 sc1
    v_pk_fma_f32 v[96:97], v[160:161], v[130:131], v[96:97] op_sel_hi:[1,0,1]
    v_pk_fma_f32 v[98:99], v[162:163], v[130:131], v[98:99] op_sel_hi:[1,0,1]
    v_pk_mul_f32 v[96:97], v[96:97], v[130:131] op_sel:[0,1] op_sel_hi:[1,1]
    v_pk_mul_f32 v[98:99], v[98:99], v[130:131] op_sel:[0,1] op_sel_hi:[1,1]
    v_pk_fma_f32 v[100:101], v[164:165], v[130:131], v[100:101] op_sel_hi:[1,0,1]
    v_pk_fma_f32 v[102:103], v[166:167], v[130:131], v[102:103] op_sel_hi:[1,0,1]
    v_pk_mul_f32 v[100:101], v[100:101], v[130:131] op_sel:[0,1] op_sel_hi:[1,1]
    v_pk_mul_f32 v[102:103], v[102:103], v[130:131] op_sel:[0,1] op_sel_hi:[1,1]
    v_pk_mul_f32 v[176:177], v[96:97], v[96:97]
    v_pk_mul_f32 v[178:179], v[98:99], v[98:99]
    v_pk_mul_f32 v[180:181], v[100:101], v[100:101]
    v_pk_mul_f32 v[182:183], v[102:103], v[102:103]
    v_pk_fma_f32 v[176:177], v[176:177], v[134:135], v[136:137]
    v_pk_fma_f32 v[178:179], v[178:179], v[134:135], v[136:137]
    v_pk_fma_f32 v[180:181], v[180:181], v[134:135], v[136:137]
    v_pk_fma_f32 v[182:183], v[182:183], v[134:135], v[136:137]
    v_pk_mul_f32 v[176:177], v[176:177], v[96:97]
    v_pk_mul_f32 v[178:179], v[178:179], v[98:99]
    v_pk_mul_f32 v[180:181], v[180:181], v[100:101]
    v_pk_mul_f32 v[182:183], v[182:183], v[102:103]
    v_exp_f32 v176, v176
    v_exp_f32 v177, v177
    v_exp_f32 v178, v178
    v_exp_f32 v179, v179
    v_exp_f32 v180, v180
    v_exp_f32 v181, v181
    v_exp_f32 v182, v182
    v_exp_f32 v183, v183
    v_pk_add_f32 v[176:177], v[176:177], v[138:139]
    v_pk_add_f32 v[178:179], v[178:179], v[138:139]
    v_pk_add_f32 v[180:181], v[180:181], v[138:139]
    v_pk_add_f32 v[182:183], v[182:183], v[138:139]
    v_rcp_f32 v176, v176
    v_rcp_f32 v177, v177
    v_rcp_f32 v178, v178
    v_rcp_f32 v179, v179
    v_rcp_f32 v180, v180
    v_rcp_f32 v181, v181
    v_rcp_f32 v182, v182
    v_rcp_f32 v183, v183
    v_pk_mul_f32 v[96:97], v[96:97], v[176:177]
    v_pk_mul_f32 v[98:99], v[98:99], v[178:179]
    v_pk_mul_f32 v[100:101], v[100:101], v[180:181]
    v_pk_mul_f32 v[102:103], v[102:103], v[182:183]
    v_cvt_pk_bf16_f32 v188, v96, v97
    v_cvt_pk_bf16_f32 v189, v98, v99
    v_cvt_pk_bf16_f32 v190, v100, v101
    v_cvt_pk_bf16_f32 v191, v102, v103
    buffer_store_dwordx4 v[188:191], v27, s[40:43], s58 offen offset:2048 sc1
    v_pk_fma_f32 v[76:77], v[168:169], v[128:129], v[76:77] op_sel_hi:[1,0,1]
    v_pk_fma_f32 v[78:79], v[170:171], v[128:129], v[78:79] op_sel_hi:[1,0,1]
    v_pk_mul_f32 v[76:77], v[76:77], v[128:129] op_sel:[0,1] op_sel_hi:[1,1]
    v_pk_mul_f32 v[78:79], v[78:79], v[128:129] op_sel:[0,1] op_sel_hi:[1,1]
    v_pk_fma_f32 v[104:105], v[168:169], v[130:131], v[104:105] op_sel_hi:[1,0,1]
    v_pk_fma_f32 v[106:107], v[170:171], v[130:131], v[106:107] op_sel_hi:[1,0,1]
    v_pk_mul_f32 v[104:105], v[104:105], v[130:131] op_sel:[0,1] op_sel_hi:[1,1]
    v_pk_mul_f32 v[106:107], v[106:107], v[130:131] op_sel:[0,1] op_sel_hi:[1,1]
    v_pk_mul_f32 v[176:177], v[76:77], v[76:77]
    v_pk_mul_f32 v[178:179], v[78:79], v[78:79]
    v_pk_mul_f32 v[180:181], v[104:105], v[104:105]
    v_pk_mul_f32 v[182:183], v[106:107], v[106:107]
    v_pk_fma_f32 v[176:177], v[176:177], v[134:135], v[136:137]
    v_pk_fma_f32 v[178:179], v[178:179], v[134:135], v[136:137]
    v_pk_fma_f32 v[180:181], v[180:181], v[134:135], v[136:137]
    v_pk_fma_f32 v[182:183], v[182:183], v[134:135], v[136:137]
    v_pk_mul_f32 v[176:177], v[176:177], v[76:77]
    v_pk_mul_f32 v[178:179], v[178:179], v[78:79]
    v_pk_mul_f32 v[180:181], v[180:181], v[104:105]
    v_pk_mul_f32 v[182:183], v[182:183], v[106:107]
    v_exp_f32 v176, v176
    v_exp_f32 v177, v177
    v_exp_f32 v178, v178
    v_exp_f32 v179, v179
    v_exp_f32 v180, v180
    v_exp_f32 v181, v181
    v_exp_f32 v182, v182
    v_exp_f32 v183, v183
    v_pk_add_f32 v[176:177], v[176:177], v[138:139]
    v_pk_add_f32 v[178:179], v[178:179], v[138:139]
    v_pk_add_f32 v[180:181], v[180:181], v[138:139]
    v_pk_add_f32 v[182:183], v[182:183], v[138:139]
    v_rcp_f32 v176, v176
    v_rcp_f32 v177, v177
    v_rcp_f32 v178, v178
    v_rcp_f32 v179, v179
    v_rcp_f32 v180, v180
    v_rcp_f32 v181, v181
    v_rcp_f32 v182, v182
    v_rcp_f32 v183, v183
    v_pk_mul_f32 v[76:77], v[76:77], v[176:177]
    v_pk_mul_f32 v[78:79], v[78:79], v[178:179]
    v_pk_mul_f32 v[104:105], v[104:105], v[180:181]
    v_pk_mul_f32 v[106:107], v[106:107], v[182:183]
    v_cvt_pk_bf16_f32 v192, v76, v77
    v_cvt_pk_bf16_f32 v193, v78, v79
    buffer_store_dwordx2 v[192:193], v26, s[40:43], s59 offen sc1
    v_cvt_pk_bf16_f32 v194, v104, v105
    v_cvt_pk_bf16_f32 v195, v106, v107
    buffer_store_dwordx2 v[194:195], v26, s[40:43], s60 offen sc1
    s_waitcnt vmcnt(0)
    s_barrier
    s_cmp_lg_u32 s48, 0
    s_cbranch_scc1 L_sig_26
    s_lshl_b32 s52, s3, 7
    s_lshl_b32 s53, s51, 2
    s_add_u32 s52, s52, s53
    s_add_u32 s52, s52, 15767552
    v_mov_b32 v4, s52
    v_mov_b32 v5, 1
    s_mov_b64 exec, 1
    buffer_store_dword v5, v4, s[40:43], 0 offen sc1
    s_mov_b64 exec, -1
L_sig_26:
    v_mfma_f32_16x16x32_bf16 v[148:151], a[128:131], a[0:3], 0
    v_mfma_f32_16x16x32_bf16 v[164:167], a[128:131], a[4:7], 0
    s_add_u32 m0, s73, 32768
    s_add_u32 s6, s72, 262144
    buffer_load_dwordx4 v20, s[36:39], s6 offen offset:0 lds
    v_mfma_f32_16x16x32_bf16 v[152:155], a[132:135], a[0:3], 0
    v_mfma_f32_16x16x32_bf16 v[168:171], a[132:135], a[4:7], 0
    buffer_load_dwordx4 v21, s[36:39], s6 offen offset:1024 lds
    v_mfma_f32_16x16x32_bf16 v[156:159], a[136:139], a[0:3], 0
    v_mfma_f32_16x16x32_bf16 v[172:175], a[136:139], a[4:7], 0
    buffer_load_dwordx4 v22, s[36:39], s6 offen offset:2048 lds
    v_mfma_f32_16x16x32_bf16 v[160:163], a[140:143], a[0:3], 0
    v_mfma_f32_16x16x32_bf16 v[176:179], a[140:143], a[4:7], 0
    buffer_load_dwordx4 v23, s[36:39], s6 offen offset:3072 lds
    v_mfma_f32_16x16x32_bf16 v[148:151], a[144:147], a[8:11], v[148:151]
    v_mfma_f32_16x16x32_bf16 v[164:167], a[144:147], a[12:15], v[164:167]
    s_add_u32 m0, s73, 49152
    s_add_u32 s6, s72, 393216
    buffer_load_dwordx4 v20, s[36:39], s6 offen offset:0 lds
    v_mfma_f32_16x16x32_bf16 v[152:155], a[148:151], a[8:11], v[152:155]
    v_mfma_f32_16x16x32_bf16 v[168:171], a[148:151], a[12:15], v[168:171]
    buffer_load_dwordx4 v21, s[36:39], s6 offen offset:1024 lds
    v_mfma_f32_16x16x32_bf16 v[156:159], a[152:155], a[8:11], v[156:159]
    v_mfma_f32_16x16x32_bf16 v[172:175], a[152:155], a[12:15], v[172:175]
    buffer_load_dwordx4 v22, s[36:39], s6 offen offset:2048 lds
    v_mfma_f32_16x16x32_bf16 v[160:163], a[156:159], a[8:11], v[160:163]
    v_mfma_f32_16x16x32_bf16 v[176:179], a[156:159], a[12:15], v[176:179]
    buffer_load_dwordx4 v23, s[36:39], s6 offen offset:3072 lds
    v_mfma_f32_16x16x32_bf16 v[148:151], a[160:163], a[16:19], v[148:151]
    v_mfma_f32_16x16x32_bf16 v[164:167], a[160:163], a[20:23], v[164:167]
    s_add_u32 m0, s73, 65536
    s_add_u32 s6, s72, 524288
    buffer_load_dwordx4 v20, s[36:39], s6 offen offset:0 lds
    v_mfma_f32_16x16x32_bf16 v[152:155], a[164:167], a[16:19], v[152:155]
    v_mfma_f32_16x16x32_bf16 v[168:171], a[164:167], a[20:23], v[168:171]
    buffer_load_dwordx4 v21, s[36:39], s6 offen offset:1024 lds
    v_mfma_f32_16x16x32_bf16 v[156:159], a[168:171], a[16:19], v[156:159]
    v_mfma_f32_16x16x32_bf16 v[172:175], a[168:171], a[20:23], v[172:175]
    buffer_load_dwordx4 v22, s[36:39], s6 offen offset:2048 lds
    v_mfma_f32_16x16x32_bf16 v[160:163], a[172:175], a[16:19], v[160:163]
    v_mfma_f32_16x16x32_bf16 v[176:179], a[172:175], a[20:23], v[176:179]
    buffer_load_dwordx4 v23, s[36:39], s6 offen offset:3072 lds
    v_mfma_f32_16x16x32_bf16 v[148:151], a[176:179], a[24:27], v[148:151]
    v_mfma_f32_16x16x32_bf16 v[164:167], a[176:179], a[28:31], v[164:167]
    v_mfma_f32_16x16x32_bf16 v[152:155], a[180:183], a[24:27], v[152:155]
    v_mfma_f32_16x16x32_bf16 v[168:171], a[180:183], a[28:31], v[168:171]
    v_mfma_f32_16x16x32_bf16 v[156:159], a[184:187], a[24:27], v[156:159]
    v_mfma_f32_16x16x32_bf16 v[172:175], a[184:187], a[28:31], v[172:175]
    v_mfma_f32_16x16x32_bf16 v[160:163], a[188:191], a[24:27], v[160:163]
    v_mfma_f32_16x16x32_bf16 v[176:179], a[188:191], a[28:31], v[176:179]
    v_mfma_f32_16x16x32_bf16 v[148:151], a[192:195], a[32:35], v[148:151]
    v_mfma_f32_16x16x32_bf16 v[164:167], a[192:195], a[36:39], v[164:167]
    v_mfma_f32_16x16x32_bf16 v[152:155], a[196:199], a[32:35], v[152:155]
    v_mfma_f32_16x16x32_bf16 v[168:171], a[196:199], a[36:39], v[168:171]
    v_mfma_f32_16x16x32_bf16 v[156:159], a[200:203], a[32:35], v[156:159]
    v_mfma_f32_16x16x32_bf16 v[172:175], a[200:203], a[36:39], v[172:175]
    v_mfma_f32_16x16x32_bf16 v[160:163], a[204:207], a[32:35], v[160:163]
    v_mfma_f32_16x16x32_bf16 v[176:179], a[204:207], a[36:39], v[176:179]
    v_mfma_f32_16x16x32_bf16 v[148:151], a[208:211], a[40:43], v[148:151]
    v_mfma_f32_16x16x32_bf16 v[164:167], a[208:211], a[44:47], v[164:167]
    v_mfma_f32_16x16x32_bf16 v[152:155], a[212:215], a[40:43], v[152:155]
    v_mfma_f32_16x16x32_bf16 v[168:171], a[212:215], a[44:47], v[168:171]
    v_mfma_f32_16x16x32_bf16 v[156:159], a[216:219], a[40:43], v[156:159]
    v_mfma_f32_16x16x32_bf16 v[172:175], a[216:219], a[44:47], v[172:175]
    v_mfma_f32_16x16x32_bf16 v[160:163], a[220:223], a[40:43], v[160:163]
    v_mfma_f32_16x16x32_bf16 v[176:179], a[220:223], a[44:47], v[176:179]
    v_mfma_f32_16x16x32_bf16 v[148:151], a[224:227], a[48:51], v[148:151]
    v_mfma_f32_16x16x32_bf16 v[164:167], a[224:227], a[52:55], v[164:167]
    v_mfma_f32_16x16x32_bf16 v[152:155], a[228:231], a[48:51], v[152:155]
    v_mfma_f32_16x16x32_bf16 v[168:171], a[228:231], a[52:55], v[168:171]
    v_mfma_f32_16x16x32_bf16 v[156:159], a[232:235], a[48:51], v[156:159]
    v_mfma_f32_16x16x32_bf16 v[172:175], a[232:235], a[52:55], v[172:175]
    v_mfma_f32_16x16x32_bf16 v[160:163], a[236:239], a[48:51], v[160:163]
    v_mfma_f32_16x16x32_bf16 v[176:179], a[236:239], a[52:55], v[176:179]
    v_mfma_f32_16x16x32_bf16 v[148:151], a[240:243], a[56:59], v[148:151]
    v_mfma_f32_16x16x32_bf16 v[164:167], a[240:243], a[60:63], v[164:167]
    v_mfma_f32_16x16x32_bf16 v[152:155], a[244:247], a[56:59], v[152:155]
    v_mfma_f32_16x16x32_bf16 v[168:171], a[244:247], a[60:63], v[168:171]
    v_mfma_f32_16x16x32_bf16 v[156:159], a[248:251], a[56:59], v[156:159]
    v_mfma_f32_16x16x32_bf16 v[172:175], a[248:251], a[60:63], v[172:175]
    v_mfma_f32_16x16x32_bf16 v[160:163], a[252:255], a[56:59], v[160:163]
    v_mfma_f32_16x16x32_bf16 v[176:179], a[252:255], a[60:63], v[176:179]
    s_and_b32 s70, s48, 1
    s_lshr_b32 s71, s48, 1
    s_and_b32 s74, s50, 7
    s_lshl_b32 s67, s49, 3
    s_lshr_b32 s52, s50, 3
    s_lshl_b32 s52, s52, 2
    s_add_u32 s67, s67, s52
    s_lshl_b32 s52, s70, 1
    s_add_u32 s67, s67, s52
    s_mul_i32 s66, s71, 81920
    v_lshrrev_b32 v4, 2, v1
    v_and_b32 v4, 3, v4
    v_and_b32 v5, 1, v3
    v_lshlrev_b32 v5, 1, v5
    v_lshrrev_b32 v6, 1, v4
    v_or_b32 v5, v5, v6
    v_lshl_add_u32 v6, v3, 2, v4
    v_lshlrev_b32 v6, 7, v6
    v_and_b32 v7, 3, v1
    v_lshl_add_u32 v6, v7, 3, v6
    v_add_u32 v6, s66, v6
    v_xor_b32 v7, 0, v5
    v_lshl_add_u32 v16, v7, 5, v6
    v_xor_b32 v7, 1, v5
    v_lshl_add_u32 v17, v7, 5, v6
    v_xor_b32 v7, 2, v5
    v_lshl_add_u32 v18, v7, 5, v6
    v_xor_b32 v7, 3, v5
    v_lshl_add_u32 v19, v7, 5, v6
    s_mul_i32 s64, s71, 917504
    s_lshl_b32 s52, s74, 7
    s_add_u32 s64, s64, s52
    s_mul_i32 s75, s71, 28672
    s_lshl_b32 s54, s49, 7
    s_add_u32 s52, s54, 15767552
    v_lshlrev_b32 v8, 2, v2
    v_add_u32 v8, s52, v8
    s_cmp_lg_u32 s48, 0
    s_cbranch_scc1 L_wait_27
    s_mov_b32 s60, 400000
L_poll_28:
    buffer_load_dword v12, v8, s[40:43], 0 offen sc1
    s_waitcnt vmcnt(0)
    v_cmp_ne_u32 vcc, 0, v12
    s_nop 3
    s_cmp_eq_u64 vcc, -1
    s_cbranch_scc1 L_pout_29
    s_sub_u32 s60, s60, 1
    s_cmp_eq_u32 s60, 0
    s_cbranch_scc1 L_pout_29
    s_branch L_poll_28
L_pout_29:
L_wait_27:
    s_barrier
    s_mul_i32 s68, s67, 57344
    s_add_u32 s68, s68, 8388608
    s_add_u32 s68, s68, s75
    s_add_u32 s69, s68, 57344
    buffer_load_dwordx4 a[0:3], v27, s[40:43], s68 offen offset:0 sc1
    buffer_load_dwordx4 a[4:7], v27, s[40:43], s69 offen offset:0 sc1
    buffer_load_dwordx4 a[8:11], v27, s[40:43], s68 offen offset:1024 sc1
    buffer_load_dwordx4 a[12:15], v27, s[40:43], s69 offen offset:1024 sc1
    buffer_load_dwordx4 a[16:19], v27, s[40:43], s68 offen offset:2048 sc1
    buffer_load_dwordx4 a[20:23], v27, s[40:43], s69 offen offset:2048 sc1
    buffer_load_dwordx2 a[24:25], v26, s[40:43], s68 offen offset:3072 sc1
    buffer_load_dwordx2 a[26:27], v26, s[40:43], s68 offen offset:3584 sc1
    buffer_load_dwordx2 a[28:29], v26, s[40:43], s69 offen offset:3072 sc1
    buffer_load_dwordx2 a[30:31], v26, s[40:43], s69 offen offset:3584 sc1
    s_add_u32 s68, s68, 4096
    s_add_u32 s69, s69, 4096
    buffer_load_dwordx4 a[32:35], v27, s[40:43], s68 offen offset:0 sc1
    buffer_load_dwordx4 a[36:39], v27, s[40:43], s69 offen offset:0 sc1
    buffer_load_dwordx4 a[40:43], v27, s[40:43], s68 offen offset:1024 sc1
    buffer_load_dwordx4 a[44:47], v27, s[40:43], s69 offen offset:1024 sc1
    ds_read_b64_tr_b16 v[28:29], v16 offset:0
    ds_read_b64_tr_b16 v[30:31], v16 offset:2048
    ds_read_b64_tr_b16 v[32:33], v17 offset:0
    ds_read_b64_tr_b16 v[34:35], v17 offset:2048
    ds_read_b64_tr_b16 v[36:37], v18 offset:0
    ds_read_b64_tr_b16 v[38:39], v18 offset:2048
    ds_read_b64_tr_b16 v[40:41], v19 offset:0
    ds_read_b64_tr_b16 v[42:43], v19 offset:2048
    ds_read_b64_tr_b16 v[44:45], v16 offset:4096
    ds_read_b64_tr_b16 v[46:47], v16 offset:6144
    s_waitcnt vmcnt(12)
    s_waitcnt lgkmcnt(8)
    v_mfma_f32_16x16x32_bf16 v[52:55], v[28:31], a[0:3], 0
    ds_read_b64_tr_b16 v[48:49], v17 offset:4096
    v_mfma_f32_16x16x32_bf16 v[68:71], v[28:31], a[4:7], 0
    ds_read_b64_tr_b16 v[50:51], v17 offset:6144
    buffer_load_dwordx4 a[48:51], v27, s[40:43], s68 offen offset:2048 sc1
    buffer_load_dwordx4 a[52:55], v27, s[40:43], s69 offen offset:2048 sc1
    s_waitcnt lgkmcnt(8)
    v_mfma_f32_16x16x32_bf16 v[56:59], v[32:35], a[0:3], 0
    ds_read_b64_tr_b16 v[28:29], v18 offset:4096
    v_mfma_f32_16x16x32_bf16 v[72:75], v[32:35], a[4:7], 0
    ds_read_b64_tr_b16 v[30:31], v18 offset:6144
    s_waitcnt lgkmcnt(8)
    v_mfma_f32_16x16x32_bf16 v[60:63], v[36:39], a[0:3], 0
    ds_read_b64_tr_b16 v[32:33], v19 offset:4096
    v_mfma_f32_16x16x32_bf16 v[76:79], v[36:39], a[4:7], 0
    ds_read_b64_tr_b16 v[34:35], v19 offset:6144
    s_waitcnt lgkmcnt(8)
    v_mfma_f32_16x16x32_bf16 v[64:67], v[40:43], a[0:3], 0
    ds_read_b64_tr_b16 v[36:37], v16 offset:8192
    v_mfma_f32_16x16x32_bf16 v[80:83], v[40:43], a[4:7], 0
    ds_read_b64_tr_b16 v[38:39], v16 offset:10240
    s_waitcnt vmcnt(12)
    s_waitcnt lgkmcnt(8)
    v_mfma_f32_16x16x32_bf16 v[52:55], v[44:47], a[8:11], v[52:55]
    ds_read_b64_tr_b16 v[40:41], v17 offset:8192
    v_mfma_f32_16x16x32_bf16 v[68:71], v[44:47], a[12:15], v[68:71]
    ds_read_b64_tr_b16 v[42:43], v17 offset:10240
    buffer_load_dwordx4 a[56:59], v27, s[40:43], s68 offen offset:3072 sc1
    buffer_load_dwordx4 a[60:63], v27, s[40:43], s69 offen offset:3072 sc1
    s_waitcnt lgkmcnt(8)
    v_mfma_f32_16x16x32_bf16 v[56:59], v[48:51], a[8:11], v[56:59]
    ds_read_b64_tr_b16 v[44:45], v18 offset:8192
    v_mfma_f32_16x16x32_bf16 v[72:75], v[48:51], a[12:15], v[72:75]
    ds_read_b64_tr_b16 v[46:47], v18 offset:10240
    s_waitcnt lgkmcnt(8)
    v_mfma_f32_16x16x32_bf16 v[60:63], v[28:31], a[8:11], v[60:63]
    ds_read_b64_tr_b16 v[48:49], v19 offset:8192
    v_mfma_f32_16x16x32_bf16 v[76:79], v[28:31], a[12:15], v[76:79]
    ds_read_b64_tr_b16 v[50:51], v19 offset:10240
    s_waitcnt lgkmcnt(8)
    v_mfma_f32_16x16x32_bf16 v[64:67], v[32:35], a[8:11], v[64:67]
    ds_read_b64_tr_b16 v[28:29], v16 offset:12288
    v_mfma_f32_16x16x32_bf16 v[80:83], v[32:35], a[12:15], v[80:83]
    ds_read_b64_tr_b16 v[30:31], v16 offset:14336
    s_waitcnt vmcnt(12)
    s_waitcnt lgkmcnt(8)
    v_mfma_f32_16x16x32_bf16 v[52:55], v[36:39], a[16:19], v[52:55]
    ds_read_b64_tr_b16 v[32:33], v17 offset:12288
    v_mfma_f32_16x16x32_bf16 v[68:71], v[36:39], a[20:23], v[68:71]
    ds_read_b64_tr_b16 v[34:35], v17 offset:14336
    s_add_u32 s68, s68, 4096
    s_add_u32 s69, s69, 4096
    buffer_load_dwordx4 a[64:67], v27, s[40:43], s68 offen offset:0 sc1
    buffer_load_dwordx4 a[68:71], v27, s[40:43], s69 offen offset:0 sc1
    s_waitcnt lgkmcnt(8)
    v_mfma_f32_16x16x32_bf16 v[56:59], v[40:43], a[16:19], v[56:59]
    ds_read_b64_tr_b16 v[36:37], v18 offset:12288
    v_mfma_f32_16x16x32_bf16 v[72:75], v[40:43], a[20:23], v[72:75]
    ds_read_b64_tr_b16 v[38:39], v18 offset:14336
    s_waitcnt lgkmcnt(8)
    v_mfma_f32_16x16x32_bf16 v[60:63], v[44:47], a[16:19], v[60:63]
    ds_read_b64_tr_b16 v[40:41], v19 offset:12288
    v_mfma_f32_16x16x32_bf16 v[76:79], v[44:47], a[20:23], v[76:79]
    ds_read_b64_tr_b16 v[42:43], v19 offset:14336
    s_waitcnt lgkmcnt(8)
    v_mfma_f32_16x16x32_bf16 v[64:67], v[48:51], a[16:19], v[64:67]
    ds_read_b64_tr_b16 v[44:45], v16 offset:16384
    v_mfma_f32_16x16x32_bf16 v[80:83], v[48:51], a[20:23], v[80:83]
    ds_read_b64_tr_b16 v[46:47], v16 offset:18432
    s_waitcnt vmcnt(10)
    s_waitcnt lgkmcnt(8)
    v_mfma_f32_16x16x32_bf16 v[52:55], v[28:31], a[24:27], v[52:55]
    ds_read_b64_tr_b16 v[48:49], v17 offset:16384
    v_mfma_f32_16x16x32_bf16 v[68:71], v[28:31], a[28:31], v[68:71]
    ds_read_b64_tr_b16 v[50:51], v17 offset:18432
    buffer_load_dwordx4 a[72:75], v27, s[40:43], s68 offen offset:1024 sc1
    buffer_load_dwordx4 a[76:79], v27, s[40:43], s69 offen offset:1024 sc1
    s_waitcnt lgkmcnt(8)
    v_mfma_f32_16x16x32_bf16 v[56:59], v[32:35], a[24:27], v[56:59]
    ds_read_b64_tr_b16 v[28:29], v18 offset:16384
    v_mfma_f32_16x16x32_bf16 v[72:75], v[32:35], a[28:31], v[72:75]
    ds_read_b64_tr_b16 v[30:31], v18 offset:18432
    s_waitcnt lgkmcnt(8)
    v_mfma_f32_16x16x32_bf16 v[60:63], v[36:39], a[24:27], v[60:63]
    ds_read_b64_tr_b16 v[32:33], v19 offset:16384
    v_mfma_f32_16x16x32_bf16 v[76:79], v[36:39], a[28:31], v[76:79]
    ds_read_b64_tr_b16 v[34:35], v19 offset:18432
    s_waitcnt lgkmcnt(8)
    v_mfma_f32_16x16x32_bf16 v[64:67], v[40:43], a[24:27], v[64:67]
    ds_read_b64_tr_b16 v[36:37], v16 offset:20480
    v_mfma_f32_16x16x32_bf16 v[80:83], v[40:43], a[28:31], v[80:83]
    ds_read_b64_tr_b16 v[38:39], v16 offset:22528
    s_waitcnt vmcnt(10)
    s_waitcnt lgkmcnt(8)
    v_mfma_f32_16x16x32_bf16 v[52:55], v[44:47], a[32:35], v[52:55]
    ds_read_b64_tr_b16 v[40:41], v17 offset:20480
    v_mfma_f32_16x16x32_bf16 v[68:71], v[44:47], a[36:39], v[68:71]
    ds_read_b64_tr_b16 v[42:43], v17 offset:22528
    buffer_load_dwordx2 a[80:81], v26, s[40:43], s68 offen offset:2048 sc1
    buffer_load_dwordx2 a[82:83], v26, s[40:43], s68 offen offset:2560 sc1
    buffer_load_dwordx2 a[84:85], v26, s[40:43], s69 offen offset:2048 sc1
    buffer_load_dwordx2 a[86:87], v26, s[40:43], s69 offen offset:2560 sc1
    s_waitcnt lgkmcnt(8)
    v_mfma_f32_16x16x32_bf16 v[56:59], v[48:51], a[32:35], v[56:59]
    ds_read_b64_tr_b16 v[44:45], v18 offset:20480
    v_mfma_f32_16x16x32_bf16 v[72:75], v[48:51], a[36:39], v[72:75]
    ds_read_b64_tr_b16 v[46:47], v18 offset:22528
    s_waitcnt lgkmcnt(8)
    v_mfma_f32_16x16x32_bf16 v[60:63], v[28:31], a[32:35], v[60:63]
    ds_read_b64_tr_b16 v[48:49], v19 offset:20480
    v_mfma_f32_16x16x32_bf16 v[76:79], v[28:31], a[36:39], v[76:79]
    ds_read_b64_tr_b16 v[50:51], v19 offset:22528
    s_waitcnt lgkmcnt(8)
    v_mfma_f32_16x16x32_bf16 v[64:67], v[32:35], a[32:35], v[64:67]
    ds_read_b64_tr_b16 v[28:29], v16 offset:24576
    v_mfma_f32_16x16x32_bf16 v[80:83], v[32:35], a[36:39], v[80:83]
    ds_read_b64_tr_b16 v[30:31], v16 offset:26624
    s_waitcnt vmcnt(12)
    s_waitcnt lgkmcnt(8)
    v_mfma_f32_16x16x32_bf16 v[52:55], v[36:39], a[40:43], v[52:55]
    ds_read_b64_tr_b16 v[32:33], v17 offset:24576
    v_mfma_f32_16x16x32_bf16 v[68:71], v[36:39], a[44:47], v[68:71]
    ds_read_b64_tr_b16 v[34:35], v17 offset:26624
    buffer_load_dwordx4 a[88:91], v27, s[40:43], s68 offen offset:3072 sc1
    buffer_load_dwordx4 a[92:95], v27, s[40:43], s69 offen offset:3072 sc1
    s_waitcnt lgkmcnt(8)
    v_mfma_f32_16x16x32_bf16 v[56:59], v[40:43], a[40:43], v[56:59]
    ds_read_b64_tr_b16 v[36:37], v18 offset:24576
    v_mfma_f32_16x16x32_bf16 v[72:75], v[40:43], a[44:47], v[72:75]
    ds_read_b64_tr_b16 v[38:39], v18 offset:26624
    s_waitcnt lgkmcnt(8)
    v_mfma_f32_16x16x32_bf16 v[60:63], v[44:47], a[40:43], v[60:63]
    ds_read_b64_tr_b16 v[40:41], v19 offset:24576
    v_mfma_f32_16x16x32_bf16 v[76:79], v[44:47], a[44:47], v[76:79]
    ds_read_b64_tr_b16 v[42:43], v19 offset:26624
    s_waitcnt lgkmcnt(8)
    v_mfma_f32_16x16x32_bf16 v[64:67], v[48:51], a[40:43], v[64:67]
    ds_read_b64_tr_b16 v[44:45], v16 offset:28672
    v_mfma_f32_16x16x32_bf16 v[80:83], v[48:51], a[44:47], v[80:83]
    ds_read_b64_tr_b16 v[46:47], v16 offset:30720
    s_waitcnt vmcnt(12)
    s_waitcnt lgkmcnt(8)
    v_mfma_f32_16x16x32_bf16 v[52:55], v[28:31], a[48:51], v[52:55]
    ds_read_b64_tr_b16 v[48:49], v17 offset:28672
    v_mfma_f32_16x16x32_bf16 v[68:71], v[28:31], a[52:55], v[68:71]
    ds_read_b64_tr_b16 v[50:51], v17 offset:30720
    s_add_u32 s68, s68, 4096
    s_add_u32 s69, s69, 4096
    buffer_load_dwordx4 a[96:99], v27, s[40:43], s68 offen offset:0 sc1
    buffer_load_dwordx4 a[100:103], v27, s[40:43], s69 offen offset:0 sc1
    s_waitcnt lgkmcnt(8)
    v_mfma_f32_16x16x32_bf16 v[56:59], v[32:35], a[48:51], v[56:59]
    ds_read_b64_tr_b16 v[28:29], v18 offset:28672
    v_mfma_f32_16x16x32_bf16 v[72:75], v[32:35], a[52:55], v[72:75]
    ds_read_b64_tr_b16 v[30:31], v18 offset:30720
    s_barrier
    s_waitcnt lgkmcnt(8)
    v_mfma_f32_16x16x32_bf16 v[60:63], v[36:39], a[48:51], v[60:63]
    ds_read_b64_tr_b16 v[32:33], v19 offset:28672
    v_mfma_f32_16x16x32_bf16 v[76:79], v[36:39], a[52:55], v[76:79]
    ds_read_b64_tr_b16 v[34:35], v19 offset:30720
    s_waitcnt lgkmcnt(8)
    v_mfma_f32_16x16x32_bf16 v[64:67], v[40:43], a[48:51], v[64:67]
    ds_read_b64_tr_b16 v[36:37], v16 offset:32768
    v_mfma_f32_16x16x32_bf16 v[80:83], v[40:43], a[52:55], v[80:83]
    ds_read_b64_tr_b16 v[38:39], v16 offset:34816
    s_waitcnt vmcnt(12)
    s_waitcnt lgkmcnt(8)
    v_mfma_f32_16x16x32_bf16 v[52:55], v[44:47], a[56:59], v[52:55]
    ds_read_b64_tr_b16 v[40:41], v17 offset:32768
    v_mfma_f32_16x16x32_bf16 v[68:71], v[44:47], a[60:63], v[68:71]
    ds_read_b64_tr_b16 v[42:43], v17 offset:34816
    buffer_load_dwordx4 a[104:107], v27, s[40:43], s68 offen offset:1024 sc1
    buffer_load_dwordx4 a[108:111], v27, s[40:43], s69 offen offset:1024 sc1
    s_waitcnt lgkmcnt(8)
    v_mfma_f32_16x16x32_bf16 v[56:59], v[48:51], a[56:59], v[56:59]
    ds_read_b64_tr_b16 v[44:45], v18 offset:32768
    v_mfma_f32_16x16x32_bf16 v[72:75], v[48:51], a[60:63], v[72:75]
    ds_read_b64_tr_b16 v[46:47], v18 offset:34816
    s_waitcnt lgkmcnt(8)
    v_mfma_f32_16x16x32_bf16 v[60:63], v[28:31], a[56:59], v[60:63]
    ds_read_b64_tr_b16 v[48:49], v19 offset:32768
    v_mfma_f32_16x16x32_bf16 v[76:79], v[28:31], a[60:63], v[76:79]
    ds_read_b64_tr_b16 v[50:51], v19 offset:34816
    s_waitcnt lgkmcnt(8)
    v_mfma_f32_16x16x32_bf16 v[64:67], v[32:35], a[56:59], v[64:67]
    ds_read_b64_tr_b16 v[28:29], v16 offset:36864
    v_mfma_f32_16x16x32_bf16 v[80:83], v[32:35], a[60:63], v[80:83]
    ds_read_b64_tr_b16 v[30:31], v16 offset:38912
    s_barrier
    s_mul_i32 s72, s70, 131072
    s_add_u32 s72, s72, s64
    s_lshl_b32 s73, s70, 14
    s_add_u32 s73, s73, s66
    s_add_u32 m0, s73, 0
    s_add_u32 s6, s72, 655360
    buffer_load_dwordx4 v20, s[36:39], s6 offen offset:0 lds
    buffer_load_dwordx4 v21, s[36:39], s6 offen offset:1024 lds
    buffer_load_dwordx4 v22, s[36:39], s6 offen offset:2048 lds
    buffer_load_dwordx4 v23, s[36:39], s6 offen offset:3072 lds
    s_add_u32 m0, s73, 4096
    s_add_u32 s6, s72, 688128
    buffer_load_dwordx4 v20, s[36:39], s6 offen offset:0 lds
    buffer_load_dwordx4 v21, s[36:39], s6 offen offset:1024 lds
    buffer_load_dwordx4 v22, s[36:39], s6 offen offset:2048 lds
    buffer_load_dwordx4 v23, s[36:39], s6 offen offset:3072 lds
    s_add_u32 m0, s73, 8192
    s_add_u32 s6, s72, 720896
    buffer_load_dwordx4 v20, s[36:39], s6 offen offset:0 lds
    buffer_load_dwordx4 v21, s[36:39], s6 offen offset:1024 lds
    buffer_load_dwordx4 v22, s[36:39], s6 offen offset:2048 lds
    buffer_load_dwordx4 v23, s[36:39], s6 offen offset:3072 lds
    s_add_u32 m0, s73, 12288
    s_add_u32 s6, s72, 753664
    buffer_load_dwordx4 v20, s[36:39], s6 offen offset:0 lds
    buffer_load_dwordx4 v21, s[36:39], s6 offen offset:1024 lds
    buffer_load_dwordx4 v22, s[36:39], s6 offen offset:2048 lds
    buffer_load_dwordx4 v23, s[36:39], s6 offen offset:3072 lds
    s_waitcnt vmcnt(28)
    s_waitcnt lgkmcnt(8)
    v_mfma_f32_16x16x32_bf16 v[52:55], v[36:39], a[64:67], v[52:55]
    ds_read_b64_tr_b16 v[32:33], v17 offset:36864
    v_mfma_f32_16x16x32_bf16 v[68:71], v[36:39], a[68:71], v[68:71]
    ds_read_b64_tr_b16 v[34:35], v17 offset:38912
    buffer_load_dwordx4 a[112:115], v27, s[40:43], s68 offen offset:2048 sc1
    buffer_load_dwordx4 a[116:119], v27, s[40:43], s69 offen offset:2048 sc1
    s_waitcnt lgkmcnt(8)
    v_mfma_f32_16x16x32_bf16 v[56:59], v[40:43], a[64:67], v[56:59]
    ds_read_b64_tr_b16 v[36:37], v18 offset:36864
    v_mfma_f32_16x16x32_bf16 v[72:75], v[40:43], a[68:71], v[72:75]
    ds_read_b64_tr_b16 v[38:39], v18 offset:38912
    s_waitcnt lgkmcnt(8)
    v_mfma_f32_16x16x32_bf16 v[60:63], v[44:47], a[64:67], v[60:63]
    ds_read_b64_tr_b16 v[40:41], v19 offset:36864
    v_mfma_f32_16x16x32_bf16 v[76:79], v[44:47], a[68:71], v[76:79]
    ds_read_b64_tr_b16 v[42:43], v19 offset:38912
    s_waitcnt lgkmcnt(8)
    v_mfma_f32_16x16x32_bf16 v[64:67], v[48:51], a[64:67], v[64:67]
    ds_read_b64_tr_b16 v[44:45], v16 offset:40960
    v_mfma_f32_16x16x32_bf16 v[80:83], v[48:51], a[68:71], v[80:83]
    ds_read_b64_tr_b16 v[46:47], v16 offset:43008
    s_waitcnt vmcnt(28)
    s_waitcnt lgkmcnt(8)
    v_mfma_f32_16x16x32_bf16 v[52:55], v[28:31], a[72:75], v[52:55]
    ds_read_b64_tr_b16 v[48:49], v17 offset:40960
    v_mfma_f32_16x16x32_bf16 v[68:71], v[28:31], a[76:79], v[68:71]
    ds_read_b64_tr_b16 v[50:51], v17 offset:43008
    buffer_load_dwordx4 a[120:123], v27, s[40:43], s68 offen offset:3072 sc1
    buffer_load_dwordx4 a[124:127], v27, s[40:43], s69 offen offset:3072 sc1
    s_waitcnt lgkmcnt(8)
    v_mfma_f32_16x16x32_bf16 v[56:59], v[32:35], a[72:75], v[56:59]
    ds_read_b64_tr_b16 v[28:29], v18 offset:40960
    v_mfma_f32_16x16x32_bf16 v[72:75], v[32:35], a[76:79], v[72:75]
    ds_read_b64_tr_b16 v[30:31], v18 offset:43008
    s_waitcnt lgkmcnt(8)
    v_mfma_f32_16x16x32_bf16 v[60:63], v[36:39], a[72:75], v[60:63]
    ds_read_b64_tr_b16 v[32:33], v19 offset:40960
    v_mfma_f32_16x16x32_bf16 v[76:79], v[36:39], a[76:79], v[76:79]
    ds_read_b64_tr_b16 v[34:35], v19 offset:43008
    s_waitcnt lgkmcnt(8)
    v_mfma_f32_16x16x32_bf16 v[64:67], v[40:43], a[72:75], v[64:67]
    ds_read_b64_tr_b16 v[36:37], v16 offset:45056
    v_mfma_f32_16x16x32_bf16 v[80:83], v[40:43], a[76:79], v[80:83]
    ds_read_b64_tr_b16 v[38:39], v16 offset:47104
    s_waitcnt vmcnt(26)
    s_waitcnt lgkmcnt(8)
    v_mfma_f32_16x16x32_bf16 v[52:55], v[44:47], a[80:83], v[52:55]
    ds_read_b64_tr_b16 v[40:41], v17 offset:45056
    v_mfma_f32_16x16x32_bf16 v[68:71], v[44:47], a[84:87], v[68:71]
    ds_read_b64_tr_b16 v[42:43], v17 offset:47104
    s_add_u32 s68, s68, 4096
    s_add_u32 s69, s69, 4096
    buffer_load_dwordx4 a[128:131], v27, s[40:43], s68 offen offset:0 sc1
    buffer_load_dwordx4 a[132:135], v27, s[40:43], s69 offen offset:0 sc1
    s_waitcnt lgkmcnt(8)
    v_mfma_f32_16x16x32_bf16 v[56:59], v[48:51], a[80:83], v[56:59]
    ds_read_b64_tr_b16 v[44:45], v18 offset:45056
    v_mfma_f32_16x16x32_bf16 v[72:75], v[48:51], a[84:87], v[72:75]
    ds_read_b64_tr_b16 v[46:47], v18 offset:47104
    s_waitcnt lgkmcnt(8)
    v_mfma_f32_16x16x32_bf16 v[60:63], v[28:31], a[80:83], v[60:63]
    ds_read_b64_tr_b16 v[48:49], v19 offset:45056
    v_mfma_f32_16x16x32_bf16 v[76:79], v[28:31], a[84:87], v[76:79]
    ds_read_b64_tr_b16 v[50:51], v19 offset:47104
    s_waitcnt lgkmcnt(8)
    v_mfma_f32_16x16x32_bf16 v[64:67], v[32:35], a[80:83], v[64:67]
    ds_read_b64_tr_b16 v[28:29], v16 offset:49152
    v_mfma_f32_16x16x32_bf16 v[80:83], v[32:35], a[84:87], v[80:83]
    ds_read_b64_tr_b16 v[30:31], v16 offset:51200
    s_waitcnt vmcnt(26)
    s_waitcnt lgkmcnt(8)
    v_mfma_f32_16x16x32_bf16 v[52:55], v[36:39], a[88:91], v[52:55]
    ds_read_b64_tr_b16 v[32:33], v17 offset:49152
    v_mfma_f32_16x16x32_bf16 v[68:71], v[36:39], a[92:95], v[68:71]
    ds_read_b64_tr_b16 v[34:35], v17 offset:51200
    buffer_load_dwordx2 a[136:137], v26, s[40:43], s68 offen offset:1024 sc1
    buffer_load_dwordx2 a[138:139], v26, s[40:43], s68 offen offset:1536 sc1
    buffer_load_dwordx2 a[140:141], v26, s[40:43], s69 offen offset:1024 sc1
    buffer_load_dwordx2 a[142:143], v26, s[40:43], s69 offen offset:1536 sc1
    s_waitcnt lgkmcnt(8)
    v_mfma_f32_16x16x32_bf16 v[56:59], v[40:43], a[88:91], v[56:59]
    ds_read_b64_tr_b16 v[36:37], v18 offset:49152
    v_mfma_f32_16x16x32_bf16 v[72:75], v[40:43], a[92:95], v[72:75]
    ds_read_b64_tr_b16 v[38:39], v18 offset:51200
    s_waitcnt lgkmcnt(8)
    v_mfma_f32_16x16x32_bf16 v[60:63], v[44:47], a[88:91], v[60:63]
    ds_read_b64_tr_b16 v[40:41], v19 offset:49152
    v_mfma_f32_16x16x32_bf16 v[76:79], v[44:47], a[92:95], v[76:79]
    ds_read_b64_tr_b16 v[42:43], v19 offset:51200
    s_waitcnt lgkmcnt(8)
    v_mfma_f32_16x16x32_bf16 v[64:67], v[48:51], a[88:91], v[64:67]
    ds_read_b64_tr_b16 v[44:45], v16 offset:53248
    v_mfma_f32_16x16x32_bf16 v[80:83], v[48:51], a[92:95], v[80:83]
    ds_read_b64_tr_b16 v[46:47], v16 offset:55296
    s_waitcnt vmcnt(28)
    s_waitcnt lgkmcnt(8)
    v_mfma_f32_16x16x32_bf16 v[52:55], v[28:31], a[96:99], v[52:55]
    ds_read_b64_tr_b16 v[48:49], v17 offset:53248
    v_mfma_f32_16x16x32_bf16 v[68:71], v[28:31], a[100:103], v[68:71]
    ds_read_b64_tr_b16 v[50:51], v17 offset:55296
    buffer_load_dwordx4 a[144:147], v27, s[40:43], s68 offen offset:2048 sc1
    buffer_load_dwordx4 a[148:151], v27, s[40:43], s69 offen offset:2048 sc1
    s_waitcnt lgkmcnt(8)
    v_mfma_f32_16x16x32_bf16 v[56:59], v[32:35], a[96:99], v[56:59]
    ds_read_b64_tr_b16 v[28:29], v18 offset:53248
    v_mfma_f32_16x16x32_bf16 v[72:75], v[32:35], a[100:103], v[72:75]
    ds_read_b64_tr_b16 v[30:31], v18 offset:55296
    s_waitcnt lgkmcnt(8)
    v_mfma_f32_16x16x32_bf16 v[60:63], v[36:39], a[96:99], v[60:63]
    ds_read_b64_tr_b16 v[32:33], v19 offset:53248
    v_mfma_f32_16x16x32_bf16 v[76:79], v[36:39], a[100:103], v[76:79]
    ds_read_b64_tr_b16 v[34:35], v19 offset:55296
    s_waitcnt lgkmcnt(8)
    v_mfma_f32_16x16x32_bf16 v[64:67], v[40:43], a[96:99], v[64:67]
    ds_read_b64_tr_b16 v[36:37], v16 offset:57344
    v_mfma_f32_16x16x32_bf16 v[80:83], v[40:43], a[100:103], v[80:83]
    ds_read_b64_tr_b16 v[38:39], v16 offset:59392
    s_waitcnt vmcnt(28)
    s_waitcnt lgkmcnt(8)
    v_mfma_f32_16x16x32_bf16 v[52:55], v[44:47], a[104:107], v[52:55]
    ds_read_b64_tr_b16 v[40:41], v17 offset:57344
    v_mfma_f32_16x16x32_bf16 v[68:71], v[44:47], a[108:111], v[68:71]
    ds_read_b64_tr_b16 v[42:43], v17 offset:59392
    buffer_load_dwordx4 a[152:155], v27, s[40:43], s68 offen offset:3072 sc1
    buffer_load_dwordx4 a[156:159], v27, s[40:43], s69 offen offset:3072 sc1
    s_waitcnt lgkmcnt(8)
    v_mfma_f32_16x16x32_bf16 v[56:59], v[48:51], a[104:107], v[56:59]
    ds_read_b64_tr_b16 v[44:45], v18 offset:57344
    v_mfma_f32_16x16x32_bf16 v[72:75], v[48:51], a[108:111], v[72:75]
    ds_read_b64_tr_b16 v[46:47], v18 offset:59392
    s_waitcnt lgkmcnt(8)
    v_mfma_f32_16x16x32_bf16 v[60:63], v[28:31], a[104:107], v[60:63]
    ds_read_b64_tr_b16 v[48:49], v19 offset:57344
    v_mfma_f32_16x16x32_bf16 v[76:79], v[28:31], a[108:111], v[76:79]
    ds_read_b64_tr_b16 v[50:51], v19 offset:59392
    s_waitcnt lgkmcnt(8)
    v_mfma_f32_16x16x32_bf16 v[64:67], v[32:35], a[104:107], v[64:67]
    ds_read_b64_tr_b16 v[28:29], v16 offset:61440
    v_mfma_f32_16x16x32_bf16 v[80:83], v[32:35], a[108:111], v[80:83]
    ds_read_b64_tr_b16 v[30:31], v16 offset:63488
    s_waitcnt vmcnt(12)
    s_waitcnt lgkmcnt(8)
    v_mfma_f32_16x16x32_bf16 v[52:55], v[36:39], a[112:115], v[52:55]
    ds_read_b64_tr_b16 v[32:33], v17 offset:61440
    v_mfma_f32_16x16x32_bf16 v[68:71], v[36:39], a[116:119], v[68:71]
    ds_read_b64_tr_b16 v[34:35], v17 offset:63488
    s_add_u32 s68, s68, 4096
    s_add_u32 s69, s69, 4096
    buffer_load_dwordx4 a[160:163], v27, s[40:43], s68 offen offset:0 sc1
    buffer_load_dwordx4 a[164:167], v27, s[40:43], s69 offen offset:0 sc1
    s_waitcnt lgkmcnt(8)
    v_mfma_f32_16x16x32_bf16 v[56:59], v[40:43], a[112:115], v[56:59]
    ds_read_b64_tr_b16 v[36:37], v18 offset:61440
    v_mfma_f32_16x16x32_bf16 v[72:75], v[40:43], a[116:119], v[72:75]
    ds_read_b64_tr_b16 v[38:39], v18 offset:63488
    s_waitcnt lgkmcnt(8)
    v_mfma_f32_16x16x32_bf16 v[60:63], v[44:47], a[112:115], v[60:63]
    ds_read_b64_tr_b16 v[40:41], v19 offset:61440
    v_mfma_f32_16x16x32_bf16 v[76:79], v[44:47], a[116:119], v[76:79]
    ds_read_b64_tr_b16 v[42:43], v19 offset:63488
    s_waitcnt lgkmcnt(8)
    v_mfma_f32_16x16x32_bf16 v[64:67], v[48:51], a[112:115], v[64:67]
    v_add_u32 v16, 65536, v16
    v_add_u32 v17, 65536, v17
    v_add_u32 v18, 65536, v18
    v_add_u32 v19, 65536, v19
    ds_read_b64_tr_b16 v[44:45], v16 offset:0
    v_mfma_f32_16x16x32_bf16 v[80:83], v[48:51], a[116:119], v[80:83]
    ds_read_b64_tr_b16 v[46:47], v16 offset:2048
    s_waitcnt vmcnt(12)
    s_waitcnt lgkmcnt(8)
    v_mfma_f32_16x16x32_bf16 v[52:55], v[28:31], a[120:123], v[52:55]
    ds_read_b64_tr_b16 v[48:49], v17 offset:0
    v_mfma_f32_16x16x32_bf16 v[68:71], v[28:31], a[124:127], v[68:71]
    ds_read_b64_tr_b16 v[50:51], v17 offset:2048
    buffer_load_dwordx4 a[168:171], v27, s[40:43], s68 offen offset:1024 sc1
    buffer_load_dwordx4 a[172:175], v27, s[40:43], s69 offen offset:1024 sc1
    s_waitcnt lgkmcnt(8)
    v_mfma_f32_16x16x32_bf16 v[56:59], v[32:35], a[120:123], v[56:59]
    ds_read_b64_tr_b16 v[28:29], v18 offset:0
    v_mfma_f32_16x16x32_bf16 v[72:75], v[32:35], a[124:127], v[72:75]
    ds_read_b64_tr_b16 v[30:31], v18 offset:2048
    s_waitcnt lgkmcnt(8)
    v_mfma_f32_16x16x32_bf16 v[60:63], v[36:39], a[120:123], v[60:63]
    ds_read_b64_tr_b16 v[32:33], v19 offset:0
    v_mfma_f32_16x16x32_bf16 v[76:79], v[36:39], a[124:127], v[76:79]
    ds_read_b64_tr_b16 v[34:35], v19 offset:2048
    s_waitcnt lgkmcnt(8)
    v_mfma_f32_16x16x32_bf16 v[64:67], v[40:43], a[120:123], v[64:67]
    ds_read_b64_tr_b16 v[36:37], v16 offset:4096
    v_mfma_f32_16x16x32_bf16 v[80:83], v[40:43], a[124:127], v[80:83]
    ds_read_b64_tr_b16 v[38:39], v16 offset:6144
    s_waitcnt vmcnt(12)
    s_waitcnt lgkmcnt(8)
    v_mfma_f32_16x16x32_bf16 v[52:55], v[44:47], a[128:131], v[52:55]
    ds_read_b64_tr_b16 v[40:41], v17 offset:4096
    v_mfma_f32_16x16x32_bf16 v[68:71], v[44:47], a[132:135], v[68:71]
    ds_read_b64_tr_b16 v[42:43], v17 offset:6144
    buffer_load_dwordx4 a[176:179], v27, s[40:43], s68 offen offset:2048 sc1
    buffer_load_dwordx4 a[180:183], v27, s[40:43], s69 offen offset:2048 sc1
    s_waitcnt lgkmcnt(8)
    v_mfma_f32_16x16x32_bf16 v[56:59], v[48:51], a[128:131], v[56:59]
    ds_read_b64_tr_b16 v[44:45], v18 offset:4096
    v_mfma_f32_16x16x32_bf16 v[72:75], v[48:51], a[132:135], v[72:75]
    ds_read_b64_tr_b16 v[46:47], v18 offset:6144
    s_lshl_b32 s52, s67, 14
    s_lshl_b32 s53, s74, 1
    s_add_u32 s53, s53, s71
    s_lshl_b32 s53, s53, 10
    s_add_u32 s52, s52, s53
    s_add_u32 s54, s52, 4194304
    buffer_load_dwordx4 v[224:227], v27, s[40:43], s54 offen sc1
    s_add_u32 s54, s52, 4210688
    buffer_load_dwordx4 v[228:231], v27, s[40:43], s54 offen sc1
    s_lshl_b32 s52, s67, 6
    s_add_u32 s52, s52, 15794176
    v_lshlrev_b32 v4, 2, v2
    buffer_load_dword v100, v4, s[40:43], s52 offen offset:0 sc1
    buffer_load_dword v101, v4, s[40:43], s52 offen offset:64 sc1
    s_waitcnt lgkmcnt(8)
    v_mfma_f32_16x16x32_bf16 v[60:63], v[28:31], a[128:131], v[60:63]
    ds_read_b64_tr_b16 v[48:49], v19 offset:4096
    v_mfma_f32_16x16x32_bf16 v[76:79], v[28:31], a[132:135], v[76:79]
    ds_read_b64_tr_b16 v[50:51], v19 offset:6144
    s_waitcnt lgkmcnt(8)
    v_mfma_f32_16x16x32_bf16 v[64:67], v[32:35], a[128:131], v[64:67]
    ds_read_b64_tr_b16 v[28:29], v16 offset:8192
    v_mfma_f32_16x16x32_bf16 v[80:83], v[32:35], a[132:135], v[80:83]
    ds_read_b64_tr_b16 v[30:31], v16 offset:10240
    s_waitcnt vmcnt(14)
    s_waitcnt lgkmcnt(8)
    v_mfma_f32_16x16x32_bf16 v[52:55], v[36:39], a[136:139], v[52:55]
    ds_read_b64_tr_b16 v[32:33], v17 offset:8192
    v_mfma_f32_16x16x32_bf16 v[68:71], v[36:39], a[140:143], v[68:71]
    ds_read_b64_tr_b16 v[34:35], v17 offset:10240
    buffer_load_dwordx4 a[184:187], v27, s[40:43], s68 offen offset:3072 sc1
    buffer_load_dwordx4 a[188:191], v27, s[40:43], s69 offen offset:3072 sc1
    s_waitcnt lgkmcnt(8)
    v_mfma_f32_16x16x32_bf16 v[56:59], v[40:43], a[136:139], v[56:59]
    ds_read_b64_tr_b16 v[36:37], v18 offset:8192
    v_mfma_f32_16x16x32_bf16 v[72:75], v[40:43], a[140:143], v[72:75]
    ds_read_b64_tr_b16 v[38:39], v18 offset:10240
    s_waitcnt lgkmcnt(8)
    v_mfma_f32_16x16x32_bf16 v[60:63], v[44:47], a[136:139], v[60:63]
    ds_read_b64_tr_b16 v[40:41], v19 offset:8192
    v_mfma_f32_16x16x32_bf16 v[76:79], v[44:47], a[140:143], v[76:79]
    ds_read_b64_tr_b16 v[42:43], v19 offset:10240
    s_waitcnt lgkmcnt(8)
    v_mfma_f32_16x16x32_bf16 v[64:67], v[48:51], a[136:139], v[64:67]
    ds_read_b64_tr_b16 v[44:45], v16 offset:12288
    v_mfma_f32_16x16x32_bf16 v[80:83], v[48:51], a[140:143], v[80:83]
    ds_read_b64_tr_b16 v[46:47], v16 offset:14336
    s_waitcnt vmcnt(14)
    s_waitcnt lgkmcnt(8)
    v_mfma_f32_16x16x32_bf16 v[52:55], v[28:31], a[144:147], v[52:55]
    ds_read_b64_tr_b16 v[48:49], v17 offset:12288
    v_mfma_f32_16x16x32_bf16 v[68:71], v[28:31], a[148:151], v[68:71]
    ds_read_b64_tr_b16 v[50:51], v17 offset:14336
    s_add_u32 s68, s68, 4096
    s_add_u32 s69, s69, 4096
    buffer_load_dwordx2 a[192:193], v26, s[40:43], s68 offen offset:0 sc1
    buffer_load_dwordx2 a[194:195], v26, s[40:43], s68 offen offset:512 sc1
    buffer_load_dwordx2 a[196:197], v26, s[40:43], s69 offen offset:0 sc1
    buffer_load_dwordx2 a[198:199], v26, s[40:43], s69 offen offset:512 sc1
    s_waitcnt lgkmcnt(8)
    v_mfma_f32_16x16x32_bf16 v[56:59], v[32:35], a[144:147], v[56:59]
    ds_read_b64_tr_b16 v[28:29], v18 offset:12288
    v_mfma_f32_16x16x32_bf16 v[72:75], v[32:35], a[148:151], v[72:75]
    ds_read_b64_tr_b16 v[30:31], v18 offset:14336
    s_barrier
    s_waitcnt lgkmcnt(8)
    v_mfma_f32_16x16x32_bf16 v[60:63], v[36:39], a[144:147], v[60:63]
    ds_read_b64_tr_b16 v[32:33], v19 offset:12288
    v_mfma_f32_16x16x32_bf16 v[76:79], v[36:39], a[148:151], v[76:79]
    ds_read_b64_tr_b16 v[34:35], v19 offset:14336
    s_waitcnt lgkmcnt(8)
    v_mfma_f32_16x16x32_bf16 v[64:67], v[40:43], a[144:147], v[64:67]
    v_subrev_u32 v16, 65536, v16
    v_subrev_u32 v17, 65536, v17
    v_subrev_u32 v18, 65536, v18
    v_subrev_u32 v19, 65536, v19
    ds_read_b64_tr_b16 v[36:37], v16 offset:0
    v_mfma_f32_16x16x32_bf16 v[80:83], v[40:43], a[148:151], v[80:83]
    ds_read_b64_tr_b16 v[38:39], v16 offset:2048
    s_waitcnt vmcnt(16)
    s_waitcnt lgkmcnt(8)
    v_mfma_f32_16x16x32_bf16 v[52:55], v[44:47], a[152:155], v[52:55]
    ds_read_b64_tr_b16 v[40:41], v17 offset:0
    v_mfma_f32_16x16x32_bf16 v[68:71], v[44:47], a[156:159], v[68:71]
    ds_read_b64_tr_b16 v[42:43], v17 offset:2048
    buffer_load_dwordx4 a[200:203], v27, s[40:43], s68 offen offset:1024 sc1
    buffer_load_dwordx4 a[204:207], v27, s[40:43], s69 offen offset:1024 sc1
    s_waitcnt lgkmcnt(8)
    v_mfma_f32_16x16x32_bf16 v[56:59], v[48:51], a[152:155], v[56:59]
    ds_read_b64_tr_b16 v[44:45], v18 offset:0
    v_mfma_f32_16x16x32_bf16 v[72:75], v[48:51], a[156:159], v[72:75]
    ds_read_b64_tr_b16 v[46:47], v18 offset:2048
    s_waitcnt lgkmcnt(8)
    v_mfma_f32_16x16x32_bf16 v[60:63], v[28:31], a[152:155], v[60:63]
    ds_read_b64_tr_b16 v[48:49], v19 offset:0
    v_mfma_f32_16x16x32_bf16 v[76:79], v[28:31], a[156:159], v[76:79]
    ds_read_b64_tr_b16 v[50:51], v19 offset:2048
    s_waitcnt lgkmcnt(8)
    v_mfma_f32_16x16x32_bf16 v[64:67], v[32:35], a[152:155], v[64:67]
    ds_read_b64_tr_b16 v[28:29], v16 offset:4096
    v_mfma_f32_16x16x32_bf16 v[80:83], v[32:35], a[156:159], v[80:83]
    ds_read_b64_tr_b16 v[30:31], v16 offset:6144
    s_waitcnt vmcnt(16)
    s_waitcnt lgkmcnt(8)
    v_mfma_f32_16x16x32_bf16 v[52:55], v[36:39], a[160:163], v[52:55]
    ds_read_b64_tr_b16 v[32:33], v17 offset:4096
    v_mfma_f32_16x16x32_bf16 v[68:71], v[36:39], a[164:167], v[68:71]
    ds_read_b64_tr_b16 v[34:35], v17 offset:6144
    buffer_load_dwordx4 a[208:211], v27, s[40:43], s68 offen offset:2048 sc1
    buffer_load_dwordx4 a[212:215], v27, s[40:43], s69 offen offset:2048 sc1
    s_waitcnt lgkmcnt(8)
    v_mfma_f32_16x16x32_bf16 v[56:59], v[40:43], a[160:163], v[56:59]
    ds_read_b64_tr_b16 v[36:37], v18 offset:4096
    v_mfma_f32_16x16x32_bf16 v[72:75], v[40:43], a[164:167], v[72:75]
    ds_read_b64_tr_b16 v[38:39], v18 offset:6144
    s_waitcnt lgkmcnt(8)
    v_mfma_f32_16x16x32_bf16 v[60:63], v[44:47], a[160:163], v[60:63]
    ds_read_b64_tr_b16 v[40:41], v19 offset:4096
    v_mfma_f32_16x16x32_bf16 v[76:79], v[44:47], a[164:167], v[76:79]
    ds_read_b64_tr_b16 v[42:43], v19 offset:6144
    s_waitcnt lgkmcnt(8)
    v_mfma_f32_16x16x32_bf16 v[64:67], v[48:51], a[160:163], v[64:67]
    ds_read_b64_tr_b16 v[44:45], v16 offset:8192
    v_mfma_f32_16x16x32_bf16 v[80:83], v[48:51], a[164:167], v[80:83]
    ds_read_b64_tr_b16 v[46:47], v16 offset:10240
    s_waitcnt vmcnt(16)
    s_waitcnt lgkmcnt(8)
    v_mfma_f32_16x16x32_bf16 v[52:55], v[28:31], a[168:171], v[52:55]
    ds_read_b64_tr_b16 v[48:49], v17 offset:8192
    v_mfma_f32_16x16x32_bf16 v[68:71], v[28:31], a[172:175], v[68:71]
    ds_read_b64_tr_b16 v[50:51], v17 offset:10240
    buffer_load_dwordx4 a[216:219], v27, s[40:43], s68 offen offset:3072 sc1
    buffer_load_dwordx4 a[220:223], v27, s[40:43], s69 offen offset:3072 sc1
    s_waitcnt lgkmcnt(8)
    v_mfma_f32_16x16x32_bf16 v[56:59], v[32:35], a[168:171], v[56:59]
    ds_read_b64_tr_b16 v[28:29], v18 offset:8192
    v_mfma_f32_16x16x32_bf16 v[72:75], v[32:35], a[172:175], v[72:75]
    ds_read_b64_tr_b16 v[30:31], v18 offset:10240
    s_waitcnt lgkmcnt(8)
    v_mfma_f32_16x16x32_bf16 v[60:63], v[36:39], a[168:171], v[60:63]
    ds_read_b64_tr_b16 v[32:33], v19 offset:8192
    v_mfma_f32_16x16x32_bf16 v[76:79], v[36:39], a[172:175], v[76:79]
    ds_read_b64_tr_b16 v[34:35], v19 offset:10240
    s_waitcnt lgkmcnt(8)
    v_mfma_f32_16x16x32_bf16 v[64:67], v[40:43], a[168:171], v[64:67]
    ds_read_b64_tr_b16 v[36:37], v16 offset:12288
    v_mfma_f32_16x16x32_bf16 v[80:83], v[40:43], a[172:175], v[80:83]
    ds_read_b64_tr_b16 v[38:39], v16 offset:14336
    s_waitcnt vmcnt(16)
    s_waitcnt lgkmcnt(8)
    v_mfma_f32_16x16x32_bf16 v[52:55], v[44:47], a[176:179], v[52:55]
    ds_read_b64_tr_b16 v[40:41], v17 offset:12288
    v_mfma_f32_16x16x32_bf16 v[68:71], v[44:47], a[180:183], v[68:71]
    ds_read_b64_tr_b16 v[42:43], v17 offset:14336
    s_waitcnt lgkmcnt(8)
    v_mfma_f32_16x16x32_bf16 v[56:59], v[48:51], a[176:179], v[56:59]
    ds_read_b64_tr_b16 v[44:45], v18 offset:12288
    v_mfma_f32_16x16x32_bf16 v[72:75], v[48:51], a[180:183], v[72:75]
    ds_read_b64_tr_b16 v[46:47], v18 offset:14336
    s_waitcnt lgkmcnt(8)
    v_mfma_f32_16x16x32_bf16 v[60:63], v[28:31], a[176:179], v[60:63]
    ds_read_b64_tr_b16 v[48:49], v19 offset:12288
    v_mfma_f32_16x16x32_bf16 v[76:79], v[28:31], a[180:183], v[76:79]
    ds_read_b64_tr_b16 v[50:51], v19 offset:14336
    s_waitcnt lgkmcnt(8)
    v_mfma_f32_16x16x32_bf16 v[64:67], v[32:35], a[176:179], v[64:67]
    ds_read_b64_tr_b16 v[28:29], v16 offset:16384
    v_mfma_f32_16x16x32_bf16 v[80:83], v[32:35], a[180:183], v[80:83]
    ds_read_b64_tr_b16 v[30:31], v16 offset:18432
    s_waitcnt vmcnt(10)
    s_waitcnt lgkmcnt(8)
    v_mfma_f32_16x16x32_bf16 v[52:55], v[36:39], a[184:187], v[52:55]
    ds_read_b64_tr_b16 v[32:33], v17 offset:16384
    v_mfma_f32_16x16x32_bf16 v[68:71], v[36:39], a[188:191], v[68:71]
    ds_read_b64_tr_b16 v[34:35], v17 offset:18432
    s_waitcnt lgkmcnt(8)
    v_mfma_f32_16x16x32_bf16 v[56:59], v[40:43], a[184:187], v[56:59]
    ds_read_b64_tr_b16 v[36:37], v18 offset:16384
    v_mfma_f32_16x16x32_bf16 v[72:75], v[40:43], a[188:191], v[72:75]
    ds_read_b64_tr_b16 v[38:39], v18 offset:18432
    s_waitcnt lgkmcnt(8)
    v_mfma_f32_16x16x32_bf16 v[60:63], v[44:47], a[184:187], v[60:63]
    ds_read_b64_tr_b16 v[40:41], v19 offset:16384
    v_mfma_f32_16x16x32_bf16 v[76:79], v[44:47], a[188:191], v[76:79]
    ds_read_b64_tr_b16 v[42:43], v19 offset:18432
    s_waitcnt lgkmcnt(8)
    v_mfma_f32_16x16x32_bf16 v[64:67], v[48:51], a[184:187], v[64:67]
    ds_read_b64_tr_b16 v[44:45], v16 offset:20480
    v_mfma_f32_16x16x32_bf16 v[80:83], v[48:51], a[188:191], v[80:83]
    ds_read_b64_tr_b16 v[46:47], v16 offset:22528
    s_waitcnt vmcnt(6)
    s_waitcnt lgkmcnt(8)
    v_mfma_f32_16x16x32_bf16 v[52:55], v[28:31], a[192:195], v[52:55]
    ds_read_b64_tr_b16 v[48:49], v17 offset:20480
    v_mfma_f32_16x16x32_bf16 v[68:71], v[28:31], a[196:199], v[68:71]
    ds_read_b64_tr_b16 v[50:51], v17 offset:22528
    s_waitcnt lgkmcnt(8)
    v_mfma_f32_16x16x32_bf16 v[56:59], v[32:35], a[192:195], v[56:59]
    ds_read_b64_tr_b16 v[28:29], v18 offset:20480
    v_mfma_f32_16x16x32_bf16 v[72:75], v[32:35], a[196:199], v[72:75]
    ds_read_b64_tr_b16 v[30:31], v18 offset:22528
    s_waitcnt lgkmcnt(8)
    v_mfma_f32_16x16x32_bf16 v[60:63], v[36:39], a[192:195], v[60:63]
    ds_read_b64_tr_b16 v[32:33], v19 offset:20480
    v_mfma_f32_16x16x32_bf16 v[76:79], v[36:39], a[196:199], v[76:79]
    ds_read_b64_tr_b16 v[34:35], v19 offset:22528
    s_waitcnt lgkmcnt(8)
    v_mfma_f32_16x16x32_bf16 v[64:67], v[40:43], a[192:195], v[64:67]
    ds_read_b64_tr_b16 v[36:37], v16 offset:24576
    v_mfma_f32_16x16x32_bf16 v[80:83], v[40:43], a[196:199], v[80:83]
    ds_read_b64_tr_b16 v[38:39], v16 offset:26624
    s_waitcnt vmcnt(4)
    s_waitcnt lgkmcnt(8)
    v_mfma_f32_16x16x32_bf16 v[52:55], v[44:47], a[200:203], v[52:55]
    ds_read_b64_tr_b16 v[40:41], v17 offset:24576
    v_mfma_f32_16x16x32_bf16 v[68:71], v[44:47], a[204:207], v[68:71]
    ds_read_b64_tr_b16 v[42:43], v17 offset:26624
    s_waitcnt lgkmcnt(8)
    v_mfma_f32_16x16x32_bf16 v[56:59], v[48:51], a[200:203], v[56:59]
    ds_read_b64_tr_b16 v[44:45], v18 offset:24576
    v_mfma_f32_16x16x32_bf16 v[72:75], v[48:51], a[204:207], v[72:75]
    ds_read_b64_tr_b16 v[46:47], v18 offset:26624
    s_waitcnt lgkmcnt(8)
    v_mfma_f32_16x16x32_bf16 v[60:63], v[28:31], a[200:203], v[60:63]
    ds_read_b64_tr_b16 v[48:49], v19 offset:24576
    v_mfma_f32_16x16x32_bf16 v[76:79], v[28:31], a[204:207], v[76:79]
    ds_read_b64_tr_b16 v[50:51], v19 offset:26624
    s_waitcnt lgkmcnt(8)
    v_mfma_f32_16x16x32_bf16 v[64:67], v[32:35], a[200:203], v[64:67]
    ds_read_b64_tr_b16 v[28:29], v16 offset:28672
    v_mfma_f32_16x16x32_bf16 v[80:83], v[32:35], a[204:207], v[80:83]
    ds_read_b64_tr_b16 v[30:31], v16 offset:30720
    s_waitcnt vmcnt(2)
    s_waitcnt lgkmcnt(8)
    v_mfma_f32_16x16x32_bf16 v[52:55], v[36:39], a[208:211], v[52:55]
    ds_read_b64_tr_b16 v[32:33], v17 offset:28672
    v_mfma_f32_16x16x32_bf16 v[68:71], v[36:39], a[212:215], v[68:71]
    ds_read_b64_tr_b16 v[34:35], v17 offset:30720
    s_waitcnt lgkmcnt(8)
    v_mfma_f32_16x16x32_bf16 v[56:59], v[40:43], a[208:211], v[56:59]
    ds_read_b64_tr_b16 v[36:37], v18 offset:28672
    v_mfma_f32_16x16x32_bf16 v[72:75], v[40:43], a[212:215], v[72:75]
    ds_read_b64_tr_b16 v[38:39], v18 offset:30720
    s_waitcnt lgkmcnt(8)
    v_mfma_f32_16x16x32_bf16 v[60:63], v[44:47], a[208:211], v[60:63]
    ds_read_b64_tr_b16 v[40:41], v19 offset:28672
    v_mfma_f32_16x16x32_bf16 v[76:79], v[44:47], a[212:215], v[76:79]
    ds_read_b64_tr_b16 v[42:43], v19 offset:30720
    s_waitcnt lgkmcnt(8)
    v_mfma_f32_16x16x32_bf16 v[64:67], v[48:51], a[208:211], v[64:67]
    v_mfma_f32_16x16x32_bf16 v[80:83], v[48:51], a[212:215], v[80:83]
    s_waitcnt vmcnt(0)
    s_waitcnt lgkmcnt(6)
    v_mfma_f32_16x16x32_bf16 v[52:55], v[28:31], a[216:219], v[52:55]
    v_mfma_f32_16x16x32_bf16 v[68:71], v[28:31], a[220:223], v[68:71]
    s_waitcnt lgkmcnt(4)
    v_mfma_f32_16x16x32_bf16 v[56:59], v[32:35], a[216:219], v[56:59]
    v_mfma_f32_16x16x32_bf16 v[72:75], v[32:35], a[220:223], v[72:75]
    s_waitcnt lgkmcnt(2)
    v_mfma_f32_16x16x32_bf16 v[60:63], v[36:39], a[216:219], v[60:63]
    v_mfma_f32_16x16x32_bf16 v[76:79], v[36:39], a[220:223], v[76:79]
    s_waitcnt lgkmcnt(0)
    v_mfma_f32_16x16x32_bf16 v[64:67], v[40:43], a[216:219], v[64:67]
    v_mfma_f32_16x16x32_bf16 v[80:83], v[40:43], a[220:223], v[80:83]
    s_barrier
    s_mul_i32 s52, s48, 8192
    s_add_u32 s52, s52, 0
    v_add_u32 v4, s52, v27
    s_xor_b32 s53, s48, 2
    s_mul_i32 s53, s53, 8192
    s_add_u32 s53, s53, 0
    v_add_u32 v5, s53, v27
    s_cmp_eq_u32 s71, 1
    s_cbranch_scc1 L_kh1_30
    ds_write_b128 v4, v[60:63] offset:0
    ds_write_b128 v4, v[64:67] offset:1024
    ds_write_b128 v4, v[76:79] offset:2048
    ds_write_b128 v4, v[80:83] offset:3072
    ds_write_b128 v4, v[156:159] offset:4096
    ds_write_b128 v4, v[160:163] offset:5120
    ds_write_b128 v4, v[172:175] offset:6144
    ds_write_b128 v4, v[176:179] offset:7168
    s_branch L_khd_31
L_kh1_30:
    ds_write_b128 v4, v[52:55] offset:0
    ds_write_b128 v4, v[56:59] offset:1024
    ds_write_b128 v4, v[68:71] offset:2048
    ds_write_b128 v4, v[72:75] offset:3072
    ds_write_b128 v4, v[148:151] offset:4096
    ds_write_b128 v4, v[152:155] offset:5120
    ds_write_b128 v4, v[164:167] offset:6144
    ds_write_b128 v4, v[168:171] offset:7168
    s_nop 1
    v_mov_b32 v52, v60
    v_mov_b32 v53, v61
    v_mov_b32 v54, v62
    v_mov_b32 v55, v63
    v_mov_b32 v56, v64
    v_mov_b32 v57, v65
    v_mov_b32 v58, v66
    v_mov_b32 v59, v67
    v_mov_b32 v68, v76
    v_mov_b32 v69, v77
    v_mov_b32 v70, v78
    v_mov_b32 v71, v79
    v_mov_b32 v72, v80
    v_mov_b32 v73, v81
    v_mov_b32 v74, v82
    v_mov_b32 v75, v83
    v_mov_b32 v148, v156
    v_mov_b32 v149, v157
    v_mov_b32 v150, v158
    v_mov_b32 v151, v159
    v_mov_b32 v152, v160
    v_mov_b32 v153, v161
    v_mov_b32 v154, v162
    v_mov_b32 v155, v163
    v_mov_b32 v164, v172
    v_mov_b32 v165, v173
    v_mov_b32 v166, v174
    v_mov_b32 v167, v175
    v_mov_b32 v168, v176
    v_mov_b32 v169, v177
    v_mov_b32 v170, v178
    v_mov_b32 v171, v179
L_khd_31:
    s_waitcnt lgkmcnt(0)
    s_barrier
    ds_read_b128 v[104:107], v5 offset:0
    ds_read_b128 v[108:111], v5 offset:1024
    ds_read_b128 v[112:115], v5 offset:2048
    ds_read_b128 v[116:119], v5 offset:3072
    ds_read_b128 v[120:123], v5 offset:4096
    ds_read_b128 v[124:127], v5 offset:5120
    ds_read_b128 v[128:131], v5 offset:6144
    ds_read_b128 v[132:135], v5 offset:7168
    s_waitcnt lgkmcnt(0)
    v_pk_add_f32 v[52:53], v[52:53], v[104:105]
    v_pk_add_f32 v[54:55], v[54:55], v[106:107]
    v_pk_add_f32 v[56:57], v[56:57], v[108:109]
    v_pk_add_f32 v[58:59], v[58:59], v[110:111]
    v_pk_add_f32 v[68:69], v[68:69], v[112:113]
    v_pk_add_f32 v[70:71], v[70:71], v[114:115]
    v_pk_add_f32 v[72:73], v[72:73], v[116:117]
    v_pk_add_f32 v[74:75], v[74:75], v[118:119]
    v_pk_add_f32 v[148:149], v[148:149], v[120:121]
    v_pk_add_f32 v[150:151], v[150:151], v[122:123]
    v_pk_add_f32 v[152:153], v[152:153], v[124:125]
    v_pk_add_f32 v[154:155], v[154:155], v[126:127]
    v_pk_add_f32 v[164:165], v[164:165], v[128:129]
    v_pk_add_f32 v[166:167], v[166:167], v[130:131]
    v_pk_add_f32 v[168:169], v[168:169], v[132:133]
    v_pk_add_f32 v[170:171], v[170:171], v[134:135]
    s_mov_b32 s44, s26
    s_and_b32 s45, s27, 0xffff
    s_mov_b32 s46, 0x200000
    s_mov_b32 s47, 0x20000
    v_and_b32 v6, 1, v3
    v_lshlrev_b32 v6, 5, v6
    v_lshrrev_b32 v7, 1, v3
    v_lshl_add_u32 v6, v7, 4, v6
    v_lshl_add_u32 v6, v2, 10, v6
    s_lshl_b32 s52, s67, 14
    s_lshl_b32 s53, s74, 7
    s_add_u32 s52, s52, s53
    s_lshl_b32 s53, s71, 6
    s_add_u32 s52, s52, s53
    v_sub_f32 v104, 1.0, v100
    v_lshlrev_b32 v144, 16, v224
    v_and_b32 v145, 0xffff0000, v224
    v_lshlrev_b32 v146, 16, v225
    v_and_b32 v147, 0xffff0000, v225
    v_add_f32 v52, v52, v144
    v_mul_f32 v52, v52, v104
    v_fma_f32 v52, v148, v100, v52
    v_add_f32 v53, v53, v145
    v_mul_f32 v53, v53, v104
    v_fma_f32 v53, v149, v100, v53
    v_add_f32 v54, v54, v146
    v_mul_f32 v54, v54, v104
    v_fma_f32 v54, v150, v100, v54
    v_add_f32 v55, v55, v147
    v_mul_f32 v55, v55, v104
    v_fma_f32 v55, v151, v100, v55
    v_cvt_pk_bf16_f32 v136, v52, v53
    v_cvt_pk_bf16_f32 v137, v54, v55
    v_lshlrev_b32 v144, 16, v226
    v_and_b32 v145, 0xffff0000, v226
    v_lshlrev_b32 v146, 16, v227
    v_and_b32 v147, 0xffff0000, v227
    v_add_f32 v56, v56, v144
    v_mul_f32 v56, v56, v104
    v_fma_f32 v56, v152, v100, v56
    v_add_f32 v57, v57, v145
    v_mul_f32 v57, v57, v104
    v_fma_f32 v57, v153, v100, v57
    v_add_f32 v58, v58, v146
    v_mul_f32 v58, v58, v104
    v_fma_f32 v58, v154, v100, v58
    v_add_f32 v59, v59, v147
    v_mul_f32 v59, v59, v104
    v_fma_f32 v59, v155, v100, v59
    v_cvt_pk_bf16_f32 v138, v56, v57
    v_cvt_pk_bf16_f32 v139, v58, v59
    s_nop 0
    v_permlane16_swap_b32 v136, v138
    v_permlane16_swap_b32 v137, v139
    s_add_u32 s54, s52, 0
    buffer_store_dwordx4 v[136:139], v6, s[44:47], s54 offen
    v_sub_f32 v104, 1.0, v101
    v_lshlrev_b32 v144, 16, v228
    v_and_b32 v145, 0xffff0000, v228
    v_lshlrev_b32 v146, 16, v229
    v_and_b32 v147, 0xffff0000, v229
    v_add_f32 v68, v68, v144
    v_mul_f32 v68, v68, v104
    v_fma_f32 v68, v164, v101, v68
    v_add_f32 v69, v69, v145
    v_mul_f32 v69, v69, v104
    v_fma_f32 v69, v165, v101, v69
    v_add_f32 v70, v70, v146
    v_mul_f32 v70, v70, v104
    v_fma_f32 v70, v166, v101, v70
    v_add_f32 v71, v71, v147
    v_mul_f32 v71, v71, v104
    v_fma_f32 v71, v167, v101, v71
    v_cvt_pk_bf16_f32 v140, v68, v69
    v_cvt_pk_bf16_f32 v141, v70, v71
    v_lshlrev_b32 v144, 16, v230
    v_and_b32 v145, 0xffff0000, v230
    v_lshlrev_b32 v146, 16, v231
    v_and_b32 v147, 0xffff0000, v231
    v_add_f32 v72, v72, v144
    v_mul_f32 v72, v72, v104
    v_fma_f32 v72, v168, v101, v72
    v_add_f32 v73, v73, v145
    v_mul_f32 v73, v73, v104
    v_fma_f32 v73, v169, v101, v73
    v_add_f32 v74, v74, v146
    v_mul_f32 v74, v74, v104
    v_fma_f32 v74, v170, v101, v74
    v_add_f32 v75, v75, v147
    v_mul_f32 v75, v75, v104
    v_fma_f32 v75, v171, v101, v75
    v_cvt_pk_bf16_f32 v142, v72, v73
    v_cvt_pk_bf16_f32 v143, v74, v75
    s_nop 0
    v_permlane16_swap_b32 v140, v142
    v_permlane16_swap_b32 v141, v143
    s_add_u32 s54, s52, 16384
    buffer_store_dwordx4 v[140:143], v6, s[44:47], s54 offen
L_end:
    s_endpgm
.section .rodata,"a"
.p2align 6
.amdhsa_kernel gated_mix__linear_attn_block__mixer_s_mlp__prompt_kernel
  .amdhsa_next_free_vgpr 512
  .amdhsa_next_free_sgpr 102
  .amdhsa_accum_offset 256
  .amdhsa_group_segment_fixed_size 0
  .amdhsa_kernarg_size 96
  .amdhsa_user_sgpr_count 2
  .amdhsa_user_sgpr_kernarg_segment_ptr 1
  .amdhsa_system_sgpr_workgroup_id_x 1
  .amdhsa_float_denorm_mode_32 3
  .amdhsa_float_denorm_mode_16_64 3
.end_amdhsa_kernel
```
